```python
import torch

def _softmax(x, axis=-1):
    return torch.softmax(x, dim=axis)
def _gelu(x):
    return torch.nn.functional.gelu(x, approximate="tanh")
def _silu(x):
    return torch.nn.functional.silu(x)
def _sigmoid(x):
    return torch.sigmoid(x)
def _layernorm(x, axis=-1, eps=1e-5):
    m = x.mean(dim=axis, keepdim=True)
    v = x.var(dim=axis, keepdim=True, unbiased=False)
    return (x - m) / torch.sqrt(v + eps)
def _scatter_add(tgt, idx, src, axis=0):
    return tgt.clone().index_add_(axis, idx, src)
def _segment_sum(src, seg, n):
    out = torch.zeros((n,) + src.shape[1:], dtype=src.dtype)
    return out.index_add_(0, seg, src)
def _pad(x, pw):
    flat = tuple(v for pair in reversed(pw) for v in pair)
    return torch.nn.functional.pad(x, flat)

kernel_name = 'parallel_sum__sliding_local_dilated__dense_activation_silu__prompt'

def setup_inputs():

    _w = (lambda a: (lambda t: t.to(torch.bfloat16) if t.is_floating_point() else t)(torch.as_tensor(a)))
    def _A_setup():
        B, S, D = 1, 2048, 640
        return {
            "x": _w((lambda *s: torch.randn(*s, dtype=torch.bfloat16) * 0.05)(B, S, D)),
            "wqkv": _w((lambda *s: torch.randn(*s, dtype=torch.bfloat16) * 0.05)(D, 3 * D)),
            "wo": _w((lambda *s: torch.randn(*s, dtype=torch.bfloat16) * 0.05)(D, D)),
        }
    _A_in = _A_setup()

    def _B_setup():
        B, S, D, F = 1, 2048, 640, 1536
        return {
            "x": _w((lambda *s: torch.randn(*s, dtype=torch.bfloat16) * 0.05)(B, S, D)),
            "w1": _w((lambda *s: torch.randn(*s, dtype=torch.bfloat16) * 3.2)(D, F) * (D ** -0.5)),
            "w2": _w((lambda *s: torch.randn(*s, dtype=torch.bfloat16) * 0.4)(F, D) * (F ** -0.5)),
        }
    _B_in = _B_setup()

    return {
        "A_x": _A_in["x"],
        "A_wqkv": _A_in["wqkv"],
        "A_wo": _A_in["wo"],
        "B_x": _B_in["x"],
        "B_w1": _B_in["w1"],
        "B_w2": _B_in["w2"],
    }

def reference(A_x, A_wqkv, A_wo, B_x, B_w1, B_w2):
    def _A_ref(x, wqkv, wo):
        B, S, D = x.shape
        H = 32; Dh = D // H
        W, dil = 8, 2
        qkv = (lambda x, *d: x.permute(*d))((x @ wqkv).reshape(B, S, 3, H, Dh), 2, 0, 3, 1, 4)
        q, k, v = qkv[0], qkv[1], qkv[2]
        scale = Dh ** -0.5
        pos = torch.arange(S)
        off = torch.arange(W) * dil
        idx = pos[:, None] - off[None, :]
        mask = idx >= 0
        idx_c = torch.where(mask, idx, 0).reshape(-1)
        kg = k[:, :, idx_c, :].reshape(B, H, S, W, Dh)
        vg = v[:, :, idx_c, :].reshape(B, H, S, W, Dh)
        logits = torch.einsum("bhsd,bhswd->bhsw", q, kg) * scale
        logits = torch.where(mask[None, None, :, :], logits, -1e9)
        attn = _softmax(logits, axis=-1)
        o = torch.einsum("bhsw,bhswd->bhsd", attn, vg)
        return (lambda x, *d: x.permute(*d))(o, 0, 2, 1, 3).reshape(B, S, D) @ wo

    def _B_ref(x, w1, w2):
        h = torch.einsum("bsd,df->bsf", x, w1)
        h = _silu(h)
        out = torch.einsum("bsf,fd->bsd", h, w2)
        return out

    x = A_x
    xn = _layernorm(x, axis=-1)
    return x + _A_ref(xn, A_wqkv, A_wo) + _B_ref(xn, B_w1, B_w2)
```

```asm
; @launch grid=(256,1,1) block=(512,1,1) lds=163840
.amdgcn_target "amdgcn-amd-amdhsa--gfx950"
.text
.globl parallel_sum__sliding_local_dilated__dense_activation_silu__prompt_kernel
.p2align 8
.type parallel_sum__sliding_local_dilated__dense_activation_silu__prompt_kernel,@function
parallel_sum__sliding_local_dilated__dense_activation_silu__prompt_kernel:
L_code0:
  s_memrealtime s[88:89]
  s_cmp_ge_u32 s2, 256
  s_cbranch_scc1 L_exit
  s_load_dwordx16 s[32:47], s[0:1], 0
  s_load_dwordx2 s[48:49], s[0:1], 64
  v_lshrrev_b32 v236, 6, v0
  v_and_b32 v1, 63, v0
  v_readfirstlane_b32 s63, v236
  s_cmp_lt_u32 s2, 128
  s_cbranch_scc1 L_attn
  v_lshrrev_b32 v238, 5, v1
  v_and_b32 v239, 31, v1
  s_and_b32 s81, s2, 3
  s_lshl_b32 s82, s81, 7
  s_and_b32 s83, s2, 0x78
  v_mul_u32_u24 v216, 2560, v238
  s_add_u32 s82, s82, s83
  s_add_u32 s77, s82, s63
  s_bfe_u32 s83, s2, 0x10002
  v_lshl_add_u32 v214, v239, 4, v216
  s_lshl_b32 s82, s77, 2
  s_add_u32 s82, s82, s83
  s_mulk_i32 s82, 1280
  s_mov_b32 s80, s82
  s_mov_b32 s6, 2621440
  s_mov_b32 s7, 0x20000
  v_lshl_add_u32 v215, v239, 3, v216
  s_waitcnt lgkmcnt(0)
  s_mov_b64 s[4:5], s[32:33]
  buffer_load_dwordx4 v[176:179], v214, s[4:7], s80 offen
  s_bfe_u32 s82, s2, 0x40003
  s_min_u32 s82, s82, 14
  s_mul_i32 s84, s82, 43
  s_lshr_b32 s84, s84, 7
  s_mul_i32 s84, s84, 7
  s_add_u32 s84, s84, s82
  s_mul_i32 s85, s81, 5
  s_lshr_b32 s85, s85, 1
  s_add_u32 s84, s84, s85
  s_mul_i32 s85, s81, 6
  s_add_u32 s85, s85, s82
  s_sub_u32 s85, s85, 9
  s_cmp_lt_u32 s82, 9
  s_cselect_b64 s[12:13], s[34:35], s[40:41]
  s_cselect_b32 s84, s84, s85
  s_cselect_b32 s85, 0, 30
  s_cselect_b32 s86, 15, 12
  s_lshl_b32 s86, s86, 8
  v_lshrrev_b32 v216, 3, v1
  v_mul_u32_u24 v216, s86, v216
  v_and_b32 v237, 7, v1
  v_lshl_add_u32 v216, v237, 4, v216
  s_lshl_b32 s76, s86, 7
  s_mul_i32 s14, s76, 5
  s_mov_b32 s15, 0x20000
  s_lshl_b32 s81, s83, 3
  s_add_u32 s82, s81, s63
  s_lshl_b32 s82, s82, 3
  s_mul_i32 s82, s82, s86
  s_lshl_b32 s87, s84, 7
  s_add_u32 s87, s87, s82
  buffer_load_dwordx4 v[16:19], v216, s[12:15], s87 offen
  s_add_u32 s87, s87, s76
  buffer_load_dwordx4 v[20:23], v216, s[12:15], s87 offen
  s_add_u32 s87, s87, s76
  buffer_load_dwordx4 v[24:27], v216, s[12:15], s87 offen
  s_add_u32 s87, s87, s76
  buffer_load_dwordx4 v[180:183], v214, s[4:7], s80 offen offset:512
  buffer_load_dwordx4 v[28:31], v216, s[12:15], s87 offen
  s_add_u32 s87, s87, s76
  buffer_load_dwordx2 v[184:185], v215, s[4:7], s80 offen offset:1024
  buffer_load_dwordx4 v[44:47], v216, s[12:15], s87 offen
  s_add_u32 s87, s87, s76
  v_lshlrev_b32 v221, 4, v238
  v_lshl_add_u32 v221, v239, 25, v221
  s_lshl_b32 s82, s83, 9
  s_add_u32 s77, s77, s82
  s_lshl_b32 s77, s77, 5
  s_add_u32 s77, s77, 9502720
  s_add_u32 s85, s85, s84
  s_lshl_b32 s85, s85, 3
  s_add_u32 s85, s85, s63
  s_lshl_b32 s85, s85, 7
  s_add_u32 s78, s81, s85
  s_add_u32 s78, s78, 9568256
  s_load_dword s100, s[48:49], s77
  s_load_dword s101, s[48:49], s78
  s_getpc_b64 s[90:91]
L_pc_1:
  s_sub_u32 s90, s90, L_pc_1-L_code0
  s_subb_u32 s91, s91, 0
  s_and_b32 s81, s2, 0xf8
  s_add_u32 s81, s81, s63
  s_lshl_b32 s81, s81, 6
  s_min_u32 s85, s81, L_exit-L_code0
  s_load_dword s100, s[90:91], s85
  s_add_u32 s81, s81, 16384
  s_min_u32 s85, s81, L_exit-L_code0
  s_load_dword s101, s[90:91], s85
  s_add_u32 s81, s81, 16384
  s_min_u32 s85, s81, L_exit-L_code0
  s_load_dword s100, s[90:91], s85
  s_add_u32 s81, s81, 16384
  s_branch L_mlp
L_attn:
  s_and_b32 s73, s2, 7
  s_lshr_b32 s81, s2, 3
  s_and_b32 s64, s81, 7
  s_and_b32 s82, s2, 4
  s_lshl_b32 s82, s82, 1
  s_or_b32 s64, s64, s82
  s_and_b32 s65, s2, 3
  s_lshl_b32 s65, s65, 1
  s_bfe_u32 s82, s2, 0x10006
  s_or_b32 s65, s65, s82
  s_lshr_b32 s66, s63, 2
  s_and_b32 s67, s63, 3
  v_lshrrev_b32 v236, 3, v1
  s_and_b32 s82, s63, 1
  s_lshl_b32 s82, s82, 2
  v_lshrrev_b32 v237, 4, v1
  v_or_b32 v237, s82, v237
  v_and_b32 v238, 7, v1
  v_xor_b32 v237, v237, v238
  s_lshl_b32 s82, s63, 3
  v_add_u32 v236, s82, v236
  v_mul_u32_u24 v236, 2560, v236
  v_lshl_add_u32 v168, v237, 4, v236
  s_and_b32 s82, s64, 7
  s_mul_i32 s50, s82, 327680
  s_lshr_b32 s83, s64, 3
  s_mul_i32 s83, s83, 1280
  s_add_u32 s50, s50, s83
  s_add_u32 s51, s50, 163840
  s_mov_b32 s54, 128
  s_lshl_b32 s83, s63, 10
  s_add_u32 s57, s83, 2048
  s_add_u32 s58, s83, 10240
  s_add_u32 s59, s83, 18432
  s_add_u32 s60, s83, 26624
  s_add_u32 s61, s83, 34816
  s_add_u32 s62, s83, 43008
  s_lshl_b32 s84, s63, 6
  s_waitcnt lgkmcnt(0)
  s_mov_b32 s4, s32
  s_mov_b32 s5, s33
  s_mov_b32 s6, 2621440
  s_mov_b32 s7, 0x20000
  s_mov_b32 s85, s50
  s_add_u32 m0, s57, 0
  s_nop 0
  buffer_load_dwordx4 v168, s[4:7], s50 offen lds
  s_add_u32 s50, s50, s54
  s_add_u32 m0, s58, 0
  s_nop 0
  buffer_load_dwordx4 v168, s[4:7], s51 offen lds
  s_add_u32 s51, s51, s54
  v_add_u32 v236, s84, v1
  v_add_u32 v236, 0, v236
  v_mul_u32_u24 v237, 2185, v236
  v_lshrrev_b32 v237, 16, v237
  v_mul_u32_u24 v238, 30, v237
  v_sub_u32 v236, v236, v238
  v_and_b32 v238, 35, v237
  v_bfe_u32 v239, v237, 2, 2
  v_lshl_add_u32 v238, v239, 3, v238
  v_bfe_u32 v239, v237, 4, 1
  v_lshl_add_u32 v238, v239, 2, v238
  v_mul_u32_u24 v169, 3840, v238
  v_mul_u32_u24 v237, 26, v236
  v_lshrrev_b32 v237, 8, v237
  v_mul_u32_u24 v237, 1120, v237
  v_lshl_add_u32 v236, v236, 4, v237
  v_add_u32 v169, v169, v236
  v_add_u32 v236, s84, v1
  v_add_u32 v236, 512, v236
  v_mul_u32_u24 v237, 2185, v236
  v_lshrrev_b32 v237, 16, v237
  v_mul_u32_u24 v238, 30, v237
  v_sub_u32 v236, v236, v238
  v_and_b32 v238, 35, v237
  v_bfe_u32 v239, v237, 2, 2
  v_lshl_add_u32 v238, v239, 3, v238
  v_bfe_u32 v239, v237, 4, 1
  v_lshl_add_u32 v238, v239, 2, v238
  v_mul_u32_u24 v170, 3840, v238
  v_mul_u32_u24 v237, 26, v236
  v_lshrrev_b32 v237, 8, v237
  v_mul_u32_u24 v237, 1120, v237
  v_lshl_add_u32 v236, v236, 4, v237
  v_add_u32 v170, v170, v236
  v_add_u32 v236, s84, v1
  v_add_u32 v236, 1024, v236
  v_mul_u32_u24 v237, 2185, v236
  v_lshrrev_b32 v237, 16, v237
  v_mul_u32_u24 v238, 30, v237
  v_sub_u32 v236, v236, v238
  v_and_b32 v238, 35, v237
  v_bfe_u32 v239, v237, 2, 2
  v_lshl_add_u32 v238, v239, 3, v238
  v_bfe_u32 v239, v237, 4, 1
  v_lshl_add_u32 v238, v239, 2, v238
  v_mul_u32_u24 v171, 3840, v238
  v_mul_u32_u24 v237, 26, v236
  v_lshrrev_b32 v237, 8, v237
  v_mul_u32_u24 v237, 1120, v237
  v_lshl_add_u32 v236, v236, 4, v237
  v_add_u32 v171, v171, v236
  v_add_u32 v236, s84, v1
  v_add_u32 v236, 1536, v236
  v_mul_u32_u24 v237, 2185, v236
  v_lshrrev_b32 v237, 16, v237
  v_mul_u32_u24 v238, 30, v237
  v_sub_u32 v236, v236, v238
  v_and_b32 v238, 35, v237
  v_bfe_u32 v239, v237, 2, 2
  v_lshl_add_u32 v238, v239, 3, v238
  v_bfe_u32 v239, v237, 4, 1
  v_lshl_add_u32 v238, v239, 2, v238
  v_mul_u32_u24 v172, 3840, v238
  v_mul_u32_u24 v237, 26, v236
  v_lshrrev_b32 v237, 8, v237
  v_mul_u32_u24 v237, 1120, v237
  v_lshl_add_u32 v236, v236, 4, v237
  v_add_u32 v172, v172, v236
  s_mul_i32 s52, s65, 160
  s_mov_b32 s53, s52
  s_mov_b32 s55, 245760
  s_mov_b32 s56, 245760
  s_mov_b32 s4, s32
  s_mov_b32 s5, s33
  s_mov_b32 s6, 2621440
  s_mov_b32 s7, 0x20000
  s_mov_b32 s8, s34
  s_mov_b32 s9, s35
  s_mov_b32 s10, 2457600
  s_mov_b32 s11, 0x20000
  s_mov_b32 s12, s34
  s_mov_b32 s13, s35
  s_mov_b32 s14, 2457600
  s_mov_b32 s15, 0x20000
  s_cmp_lt_u32 s63, 6
  s_cbranch_scc1 L_a_go
  s_mov_b32 s12, s32
  s_mov_b32 s13, s33
  s_mov_b32 s14, 2621440
  v_mov_b32 v172, v168
  s_mov_b32 s56, 128
  s_sub_u32 s62, s83, 6144
  s_sub_u32 s53, s85, 163840
  s_cmp_eq_u32 s82, 0
  s_cselect_b32 s53, s85, s53
  s_cmp_eq_u32 s63, 6
  s_cselect_b32 s14, 0, s14
L_a_go:
  s_mov_b32 s20, s46
  s_mov_b32 s21, s47
  s_mov_b32 s22, 256
  s_mov_b32 s23, 0x20000
  s_or_b32 s81, s2, s63
  s_cmp_lg_u32 s81, 0
  s_cbranch_scc1 L_non_2
  s_or_b32 s81, s88, 1
  v_mov_b32 v236, s81
  s_mov_b64 exec, 1
  buffer_store_dword v236, off, s[20:23], 0 sc1
  s_mov_b64 exec, -1
L_non_2:
  s_add_u32 m0, s59, 0
  s_nop 0
  buffer_load_dwordx4 v169, s[8:11], s52 offen lds
  s_add_u32 m0, s60, 0
  s_nop 0
  buffer_load_dwordx4 v170, s[8:11], s52 offen lds
  s_add_u32 m0, s61, 0
  s_nop 0
  buffer_load_dwordx4 v171, s[8:11], s52 offen lds
  s_add_u32 s52, s52, s55
  s_add_u32 m0, s62, 0
  s_nop 0
  buffer_load_dwordx4 v172, s[12:15], s53 offen lds
  s_add_u32 s53, s53, s56
  s_getpc_b64 s[90:91]
L_pc_3:
  s_sub_u32 s90, s90, L_pc_3-L_code0
  s_subb_u32 s91, s91, 0
  s_and_b32 s81, s2, 0xf8
  s_add_u32 s81, s81, s63
  s_lshl_b32 s81, s81, 6
  s_min_u32 s85, s81, L_exit-L_code0
  s_load_dword s100, s[90:91], s85
  s_add_u32 s81, s81, 16384
  s_min_u32 s85, s81, L_exit-L_code0
  s_load_dword s101, s[90:91], s85
  s_add_u32 s81, s81, 16384
  s_min_u32 s85, s81, L_exit-L_code0
  s_load_dword s100, s[90:91], s85
  s_add_u32 s81, s81, 16384
  v_lshrrev_b32 v5, 4, v1
  v_and_b32 v6, 15, v1
  v_lshlrev_b32 v2, 4, v1
  v_lshrrev_b32 v236, 1, v6
  v_xor_b32 v236, v236, v5
  v_lshlrev_b32 v236, 4, v236
  v_lshl_add_u32 v236, v6, 7, v236
  s_lshl_b32 s81, s66, 13
  v_add_u32 v8, s81, v236
  v_xor_b32 v9, 64, v8
  v_lshrrev_b32 v236, 2, v1
  v_and_b32 v237, 3, v1
  v_bfe_u32 v238, v1, 3, 2
  v_lshlrev_b32 v7, 7, v236
  v_lshl_add_u32 v7, v238, 5, v7
  v_lshl_add_u32 v7, v237, 3, v7
  v_mul_u32_u24 v236, 480, v236
  s_mul_i32 s81, s67, 40
  s_add_u32 s81, s81, 18432
  v_add_u32 v236, s81, v236
  v_lshl_add_u32 v12, v237, 3, v236
  v_min_u32 v237, 2, v237
  v_mul_u32_u24 v238, 160, v237
  v_add3_u32 v14, v236, v238, 32
  s_mov_b32 s90, 0x77777777
  s_mov_b32 s91, 0x77777777
  v_add_u32 v236, 0, v14
  v_cndmask_b32 v209, 0, v236, s[90:91]
  v_add_u32 v219, 0x10000, v209
  v_add_u32 v236, 7680, v14
  v_cndmask_b32 v216, 0, v236, s[90:91]
  v_add_u32 v220, 0x10000, v216
  v_add_u32 v236, 15360, v14
  v_cndmask_b32 v217, 0, v236, s[90:91]
  v_add_u32 v230, 0x10000, v217
  v_add_u32 v236, 23040, v14
  v_cndmask_b32 v218, 0, v236, s[90:91]
  v_add_u32 v231, 0x10000, v218
  s_lshl_b32 s74, s63, 11
  v_add_u32 v7, s74, v7
  s_bfe_u32 s81, s2, 0x30003
  s_lshr_b32 s82, s81, 2
  s_add_u32 s82, s82, 8
  s_and_b32 s83, s81, 3
  s_lshl_b32 s83, s83, 1
  s_bitcmp1_b32 s2, 6
  s_cselect_b32 s68, s82, s81
  s_cselect_b32 s75, s83, 6
  s_lshl_b32 s69, s73, 4
  s_mov_b32 s16, s48
  s_mov_b32 s17, s49
  s_mov_b32 s18, 10223616
  s_mov_b32 s19, 0x20000
  s_mov_b32 s24, s44
  s_mov_b32 s25, s45
  s_mov_b32 s26, 2621440
  s_mov_b32 s27, 0x20000
  s_mov_b32 s38, 819200
  s_mov_b32 s39, 0x20000
  s_mov_b32 s40, s42
  s_mov_b32 s41, s43
  s_mov_b32 s42, 1966080
  s_mov_b32 s43, 0x20000
  s_mul_i32 s81, s63, 1360
  s_add_u32 s81, s81, 152064
  v_min_u32 v236, 4, v1
  v_mul_u32_u24 v236, 272, v236
  v_add_u32 v236, s81, v236
  v_mov_b32 v16, 0
  v_mov_b32 v17, 0
  ds_write_b64 v236, v[16:17]
  v_lshlrev_b32 v238, 2, v5
  v_sub_u32 v238, v6, v238
  v_mov_b32 v254, 0xf149f2ca
  v_mov_b32 v252, 0
  v_mov_b32 v253, 0
  s_and_b32 s81, s64, 7
  s_or_b32 s81, s81, s66
  s_cmp_eq_u32 s81, 0
  s_cselect_b64 s[90:91], 0, -1
  v_subrev_u32 v236, 0, v238
  v_cmp_gt_u32 s[88:89], 8, v236
  v_mov_b32 v237, 0xffff
  v_cmp_gt_i32 vcc, -8, v236
  v_cndmask_b32 v240, v254, 0, s[88:89]
  v_cndmask_b32 v237, 0, v237, s[88:89]
  v_or_b32 v252, v252, v237
  v_cndmask_b32 v244, v254, 0, vcc
  v_cndmask_b32 v248, v254, v244, s[90:91]
  v_subrev_u32 v236, 1, v238
  v_cmp_gt_u32 s[88:89], 8, v236
  v_mov_b32 v237, 0xffff0000
  v_cmp_gt_i32 vcc, -8, v236
  v_cndmask_b32 v241, v254, 0, s[88:89]
  v_cndmask_b32 v237, 0, v237, s[88:89]
  v_or_b32 v252, v252, v237
  v_cndmask_b32 v245, v254, 0, vcc
  v_cndmask_b32 v249, v254, v245, s[90:91]
  v_subrev_u32 v236, 2, v238
  v_cmp_gt_u32 s[88:89], 8, v236
  v_mov_b32 v237, 0xffff
  v_cmp_gt_i32 vcc, -8, v236
  v_cndmask_b32 v242, v254, 0, s[88:89]
  v_cndmask_b32 v237, 0, v237, s[88:89]
  v_or_b32 v253, v253, v237
  v_cndmask_b32 v246, v254, 0, vcc
  v_cndmask_b32 v250, v254, v246, s[90:91]
  v_subrev_u32 v236, 3, v238
  v_cmp_gt_u32 s[88:89], 8, v236
  v_mov_b32 v237, 0xffff0000
  v_cmp_gt_i32 vcc, -8, v236
  v_cndmask_b32 v243, v254, 0, s[88:89]
  v_cndmask_b32 v237, 0, v237, s[88:89]
  v_or_b32 v253, v253, v237
  v_cndmask_b32 v247, v254, 0, vcc
  v_cndmask_b32 v251, v254, v247, s[90:91]
  v_mov_b32 v254, 0x3ea52b5c
  v_lshrrev_b32 v236, 2, v6
  v_min_u32 v236, 2, v236
  v_and_or_b32 v237, v6, 3, 16
  v_cmp_eq_u32 s[88:89], 3, v5
  s_lshl_b32 s81, s65, 2
  s_add_u32 s81, s81, s67
  s_mul_i32 s81, s81, 20
  v_cndmask_b32 v236, v5, v236, s[88:89]
  v_cndmask_b32 v237, v6, v237, s[88:89]
  v_mul_u32_u24 v236, 640, v236
  v_add3_u32 v239, v236, v237, s81
  v_add_u32 v10, 0x10000, v8
  v_add_u32 v11, 0x10000, v9
  v_add_u32 v13, 0x10000, v12
  v_add_u32 v15, 0x10000, v14
  v_lshlrev_b32 v238, 2, v1
  v_add_u32 v224, 149760, v238
  s_lshl_b32 s81, s67, 8
  s_cmp_eq_u32 s66, 0
  s_cbranch_scc1 L_crow_4
  v_lshlrev_b32 v222, 4, v239
  v_add_u32 v222, 9568256, v222
  s_add_u32 s81, s81, 148736
  v_add_u32 v223, s81, v238
  v_mov_b32 v225, 1.0
  s_branch L_cend_5
L_crow_4:
  s_lshl_b32 s82, s67, 6
  v_add_u32 v236, s82, v1
  v_cmp_gt_u32 vcc, 0x90, v236
  v_min_u32 v236, 0x8f, v236
  s_add_u32 s81, s81, 147456
  v_add_u32 v237, s81, v238
  v_cndmask_b32 v223, v224, v237, vcc
  v_add_u32 v224, 640, v223
  s_and_b32 s81, s64, 7
  s_lshl_b32 s81, s81, 7
  s_sub_u32 s81, s81, 16
  v_add_u32 v236, s81, v236
  v_max_i32 v236, 0, v236
  s_lshr_b32 s81, s64, 3
  s_lshl_b32 s81, s81, 14
  s_add_u32 s81, s81, 9502720
  v_lshl_add_u32 v222, v236, 4, s81
  v_mov_b32 v225, 0
L_cend_5:
  v_lshrrev_b32 v236, 3, v1
  v_lshlrev_b32 v237, 1, v5
  v_and_b32 v238, 7, v1
  v_xor_b32 v237, v237, v238
  v_lshlrev_b32 v237, 4, v237
  v_mul_u32_u24 v3, 1280, v236
  v_add_u32 v3, v3, v237
  v_lshrrev_b32 v238, 5, v1
  v_mul_u32_u24 v238, 20480, v238
  v_add_u32 v4, v3, v238
  s_lshl_b32 s81, s68, 7
  s_mul_i32 s71, s63, 245760
  s_add_u32 s71, s71, s81
  s_mul_i32 s72, s63, 102400
  s_add_u32 s72, s72, s81
  s_lshl_b32 s81, s64, 3
  s_add_u32 s81, s81, s65
  s_lshl_b32 s81, s81, 7
  s_add_u32 s34, s81, 9437184
  v_and_b32 v236, 3, v1
  v_lshlrev_b32 v236, 2, v236
  v_add_u32 v236, 162816, v236
  v_mov_b32 v237, 0
  ds_write_b32 v236, v237
  s_lshl_b32 s35, s69, 3
  s_add_u32 s35, s35, s63
  s_mul_i32 s35, s35, 9216
  s_mov_b32 s81, s68
  s_and_b32 s81, s81, 1
  s_add_u32 s82, s81, s75
  s_and_b32 s83, s82, 6
  s_add_u32 s96, s82, s83
  s_mul_i32 s44, s96, 73728
  s_add_u32 s44, s44, s35
  s_add_u32 s46, s44, 147456
  s_add_u32 s81, s81, 1
  s_cmp_eq_u32 s81, 2
  s_cselect_b32 s81, 0, s81
  s_add_u32 s82, s81, s75
  s_and_b32 s83, s82, 6
  s_add_u32 s97, s82, s83
  s_mul_i32 s45, s97, 73728
  s_add_u32 s45, s45, s35
  s_add_u32 s47, s45, 147456
  s_and_b32 s84, s69, 63
  s_mul_i32 s84, s84, 40960
  s_lshr_b32 s81, s69, 6
  s_mul_i32 s81, s81, 1280
  s_add_u32 s84, s84, s81
  s_lshl_b32 s81, s68, 7
  s_add_u32 s84, s84, s81
  s_cmp_eq_u32 s66, 1
  s_cselect_b32 s81, s97, s96
  s_cselect_b32 s82, 0, 0
  s_add_u32 s81, s81, s82
  s_mul_i32 s81, s81, 40960
  s_add_u32 s28, s81, s84
  s_cmp_eq_u32 s66, 1
  s_cselect_b32 s81, s97, s96
  s_cselect_b32 s82, 2, 2
  s_add_u32 s81, s81, s82
  s_mul_i32 s81, s81, 40960
  s_add_u32 s29, s81, s84
  s_and_b32 s83, s2, 127
  s_mul_i32 s81, s83, 6
  s_add_u32 s81, s81, s63
  s_mul_i32 s81, s81, 2560
  s_lshl_b32 s82, s83, 1
  s_add_u32 s82, s82, s63
  s_sub_u32 s82, s82, 6
  s_mul_i32 s82, s82, 3328
  s_cmp_lt_u32 s63, 6
  s_cselect_b32 s96, s40, s36
  s_cselect_b32 s97, s41, s37
  s_cselect_b32 s98, s42, s38
  s_mov_b32 s99, 0x20000
  s_cselect_b32 s3, s81, s82
  s_cselect_b32 s82, 20, 26
  v_lshlrev_b32 v234, 7, v1
  v_mov_b32 v236, 0x40000000
  v_cmp_gt_u32 s[90:91], s82, v1
  s_nop 1
  v_cndmask_b32 v234, v236, v234, s[90:91]
  s_add_u32 m0, s57, 49152
  s_nop 0
  buffer_load_dwordx4 v168, s[4:7], s50 offen lds
  s_add_u32 s50, s50, s54
  s_add_u32 m0, s58, 49152
  s_nop 0
  buffer_load_dwordx4 v168, s[4:7], s51 offen lds
  s_add_u32 s51, s51, s54
  s_add_u32 m0, s59, 49152
  s_nop 0
  buffer_load_dwordx4 v169, s[8:11], s52 offen lds
  s_cmp_eq_u32 s66, 1
  s_cbranch_scc1 L_a1
  s_waitcnt vmcnt(3) lgkmcnt(0)
  s_barrier
  ds_read_b128 v[96:99], v8 offset:0
  ds_read_b64_tr_b16 v[116:117], v12 offset:0
  ds_read_b64_tr_b16 v[118:119], v12 offset:7680
  ds_read_b64_tr_b16 v[120:121], v12 offset:160
  ds_read_b64_tr_b16 v[122:123], v12 offset:7840
  ds_read_b64_tr_b16 v[124:125], v12 offset:320
  ds_read_b64_tr_b16 v[126:127], v12 offset:8000
  ds_read_b64_tr_b16 v[128:129], v209 offset:0
  ds_read_b64_tr_b16 v[130:131], v216 offset:0
  ds_read_b128 v[100:103], v8 offset:2048
  ds_read_b128 v[104:107], v8 offset:4096
  ds_read_b128 v[108:111], v8 offset:6144
  ds_read_b128 v[112:115], v8 offset:8192
  s_waitcnt lgkmcnt(0)
  v_mfma_f32_16x16x32_bf16 v[32:35], v[116:119], v[100:103], 0
  ds_read_b128 v[132:135], v9 offset:0
  s_add_u32 m0, s60, 49152
  v_mfma_f32_16x16x32_bf16 v[36:39], v[120:123], v[100:103], 0
  buffer_load_dwordx4 v170, s[8:11], s52 offen lds
  ds_read_b64_tr_b16 v[152:153], v12 offset:15360
  s_add_u32 m0, s61, 49152
  v_mfma_f32_16x16x32_bf16 v[44:47], v[128:131], v[100:103], 0
  buffer_load_dwordx4 v171, s[8:11], s52 offen lds
  s_add_u32 s52, s52, s55
  ds_read_b64_tr_b16 v[154:155], v12 offset:23040
  v_mfma_f32_16x16x32_bf16 v[40:43], v[100:103], v[124:127], 0
  ds_read_b64_tr_b16 v[156:157], v12 offset:15520
  s_add_u32 m0, s62, 49152
  v_mfma_f32_16x16x32_bf16 v[56:59], v[104:107], v[124:127], 0
  buffer_load_dwordx4 v172, s[12:15], s53 offen lds
  s_add_u32 s53, s53, s56
  ds_read_b64_tr_b16 v[158:159], v12 offset:23200
  v_mfma_f32_16x16x32_bf16 v[60:63], v[128:131], v[104:107], 0
  ds_read_b64_tr_b16 v[160:161], v12 offset:15680
  s_add_u32 m0, s57, 98304
  v_mfma_f32_16x16x32_bf16 v[52:55], v[120:123], v[104:107], 0
  buffer_load_dwordx4 v168, s[4:7], s50 offen lds
  s_add_u32 s50, s50, s54
  ds_read_b64_tr_b16 v[162:163], v12 offset:23360
  v_mfma_f32_16x16x32_bf16 v[48:51], v[116:119], v[104:107], 0
  ds_read_b64_tr_b16 v[164:165], v217 offset:0
  s_add_u32 m0, s58, 98304
  v_mfma_f32_16x16x32_bf16 v[64:67], v[116:119], v[108:111], 0
  buffer_load_dwordx4 v168, s[4:7], s51 offen lds
  s_add_u32 s51, s51, s54
  ds_read_b64_tr_b16 v[166:167], v218 offset:0
  v_mfma_f32_16x16x32_bf16 v[68:71], v[120:123], v[108:111], 0
  ds_read_b128 v[136:139], v9 offset:2048
  s_add_u32 m0, s59, 98304
  v_mfma_f32_16x16x32_bf16 v[76:79], v[128:131], v[108:111], 0
  buffer_load_dwordx4 v169, s[8:11], s52 offen lds
  ds_read_b128 v[140:143], v9 offset:4096
  v_mfma_f32_16x16x32_bf16 v[72:75], v[108:111], v[124:127], 0
  ds_read_b128 v[144:147], v9 offset:6144
  s_add_u32 m0, s60, 98304
  v_mfma_f32_16x16x32_bf16 v[88:91], v[112:115], v[124:127], 0
  buffer_load_dwordx4 v170, s[8:11], s52 offen lds
  ds_read_b128 v[148:151], v9 offset:8192
  v_mfma_f32_16x16x32_bf16 v[92:95], v[128:131], v[112:115], 0
  s_add_u32 m0, s61, 98304
  v_mfma_f32_16x16x32_bf16 v[84:87], v[120:123], v[112:115], 0
  buffer_load_dwordx4 v171, s[8:11], s52 offen lds
  s_add_u32 s52, s52, s55
  v_mfma_f32_16x16x32_bf16 v[80:83], v[116:119], v[112:115], 0
  s_add_u32 m0, s62, 98304
  v_mfma_f32_16x16x32_bf16 v[20:23], v[120:123], v[96:99], 0
  buffer_load_dwordx4 v172, s[12:15], s53 offen lds
  s_add_u32 s53, s53, s56
  v_mfma_f32_16x16x32_bf16 v[28:31], v[128:131], v[96:99], 0
  v_mfma_f32_16x16x32_bf16 v[24:27], v[96:99], v[124:127], 0
  s_waitcnt vmcnt(6) lgkmcnt(0)
  s_barrier
  s_setprio 3
  v_mfma_f32_16x16x32_bf16 v[32:35], v[152:155], v[136:139], v[32:35]
  ds_read_b128 v[96:99], v8 offset:49152
  s_add_u32 m0, s57, 0
  v_mfma_f32_16x16x32_bf16 v[36:39], v[156:159], v[136:139], v[36:39]
  buffer_load_dwordx4 v168, s[4:7], s50 offen lds
  s_add_u32 s50, s50, s54
  ds_read_b64_tr_b16 v[116:117], v12 offset:49152
  v_mfma_f32_16x16x32_bf16 v[44:47], v[164:167], v[136:139], v[44:47]
  ds_read_b64_tr_b16 v[118:119], v12 offset:56832
  v_mfma_f32_16x16x32_bf16 v[40:43], v[136:139], v[160:163], v[40:43]
  ds_read_b64_tr_b16 v[120:121], v12 offset:49312
  v_mfma_f32_16x16x32_bf16 v[56:59], v[140:143], v[160:163], v[56:59]
  ds_read_b64_tr_b16 v[122:123], v12 offset:56992
  v_mfma_f32_16x16x32_bf16 v[60:63], v[164:167], v[140:143], v[60:63]
  ds_read_b64_tr_b16 v[124:125], v12 offset:49472
  s_add_u32 m0, s58, 0
  v_mfma_f32_16x16x32_bf16 v[52:55], v[156:159], v[140:143], v[52:55]
  buffer_load_dwordx4 v168, s[4:7], s51 offen lds
  s_add_u32 s51, s51, s54
  ds_read_b64_tr_b16 v[126:127], v12 offset:57152
  v_mfma_f32_16x16x32_bf16 v[48:51], v[152:155], v[140:143], v[48:51]
  ds_read_b64_tr_b16 v[128:129], v209 offset:49152
  v_mfma_f32_16x16x32_bf16 v[64:67], v[152:155], v[144:147], v[64:67]
  ds_read_b64_tr_b16 v[130:131], v216 offset:49152
  s_setprio 2
  v_mfma_f32_16x16x32_bf16 v[68:71], v[156:159], v[144:147], v[68:71]
  ds_read_b128 v[100:103], v8 offset:51200
  v_mfma_f32_16x16x32_bf16 v[76:79], v[164:167], v[144:147], v[76:79]
  ds_read_b128 v[104:107], v8 offset:53248
  v_mfma_f32_16x16x32_bf16 v[72:75], v[144:147], v[160:163], v[72:75]
  ds_read_b128 v[108:111], v8 offset:55296
  s_add_u32 m0, s59, 0
  v_mfma_f32_16x16x32_bf16 v[88:91], v[148:151], v[160:163], v[88:91]
  buffer_load_dwordx4 v169, s[8:11], s52 offen lds
  ds_read_b128 v[112:115], v8 offset:57344
  v_mfma_f32_16x16x32_bf16 v[92:95], v[164:167], v[148:151], v[92:95]
  v_mfma_f32_16x16x32_bf16 v[84:87], v[156:159], v[148:151], v[84:87]
  v_mfma_f32_16x16x32_bf16 v[80:83], v[152:155], v[148:151], v[80:83]
  v_mfma_f32_16x16x32_bf16 v[20:23], v[156:159], v[132:135], v[20:23]
  v_mfma_f32_16x16x32_bf16 v[28:31], v[164:167], v[132:135], v[28:31]
  v_mfma_f32_16x16x32_bf16 v[24:27], v[132:135], v[160:163], v[24:27]
  s_waitcnt lgkmcnt(0)
  s_setprio 1
  v_mfma_f32_16x16x32_bf16 v[32:35], v[116:119], v[100:103], v[32:35]
  ds_read_b128 v[132:135], v9 offset:49152
  s_add_u32 m0, s60, 0
  v_mfma_f32_16x16x32_bf16 v[36:39], v[120:123], v[100:103], v[36:39]
  buffer_load_dwordx4 v170, s[8:11], s52 offen lds
  ds_read_b64_tr_b16 v[152:153], v12 offset:64512
  v_mfma_f32_16x16x32_bf16 v[44:47], v[128:131], v[100:103], v[44:47]
  ds_read_b64_tr_b16 v[154:155], v13 offset:6656
  v_mfma_f32_16x16x32_bf16 v[40:43], v[100:103], v[124:127], v[40:43]
  ds_read_b64_tr_b16 v[156:157], v12 offset:64672
  v_mfma_f32_16x16x32_bf16 v[56:59], v[104:107], v[124:127], v[56:59]
  ds_read_b64_tr_b16 v[158:159], v13 offset:6816
  s_add_u32 m0, s61, 0
  v_mfma_f32_16x16x32_bf16 v[60:63], v[128:131], v[104:107], v[60:63]
  buffer_load_dwordx4 v171, s[8:11], s52 offen lds
  s_add_u32 s52, s52, s55
  ds_read_b64_tr_b16 v[160:161], v12 offset:64832
  v_mfma_f32_16x16x32_bf16 v[52:55], v[120:123], v[104:107], v[52:55]
  ds_read_b64_tr_b16 v[162:163], v13 offset:6976
  v_mfma_f32_16x16x32_bf16 v[48:51], v[116:119], v[104:107], v[48:51]
  ds_read_b64_tr_b16 v[164:165], v217 offset:49152
  v_mfma_f32_16x16x32_bf16 v[64:67], v[116:119], v[108:111], v[64:67]
  ds_read_b64_tr_b16 v[166:167], v218 offset:49152
  s_add_u32 m0, s62, 0
  s_setprio 0
  v_mfma_f32_16x16x32_bf16 v[68:71], v[120:123], v[108:111], v[68:71]
  buffer_load_dwordx4 v172, s[12:15], s53 offen lds
  s_add_u32 s53, s53, s56
  ds_read_b128 v[136:139], v9 offset:51200
  v_mfma_f32_16x16x32_bf16 v[76:79], v[128:131], v[108:111], v[76:79]
  ds_read_b128 v[140:143], v9 offset:53248
  v_mfma_f32_16x16x32_bf16 v[72:75], v[108:111], v[124:127], v[72:75]
  ds_read_b128 v[144:147], v9 offset:55296
  v_mfma_f32_16x16x32_bf16 v[88:91], v[112:115], v[124:127], v[88:91]
  ds_read_b128 v[148:151], v9 offset:57344
  v_mfma_f32_16x16x32_bf16 v[92:95], v[128:131], v[112:115], v[92:95]
  v_mfma_f32_16x16x32_bf16 v[84:87], v[120:123], v[112:115], v[84:87]
  v_mfma_f32_16x16x32_bf16 v[80:83], v[116:119], v[112:115], v[80:83]
  v_mfma_f32_16x16x32_bf16 v[20:23], v[120:123], v[96:99], v[20:23]
  v_mfma_f32_16x16x32_bf16 v[28:31], v[128:131], v[96:99], v[28:31]
  v_mfma_f32_16x16x32_bf16 v[24:27], v[96:99], v[124:127], v[24:27]
  s_waitcnt vmcnt(6) lgkmcnt(0)
  s_barrier
  s_setprio 3
  v_mfma_f32_16x16x32_bf16 v[32:35], v[152:155], v[136:139], v[32:35]
  ds_read_b128 v[96:99], v10 offset:32768
  s_add_u32 m0, s57, 49152
  v_mfma_f32_16x16x32_bf16 v[36:39], v[156:159], v[136:139], v[36:39]
  buffer_load_dwordx4 v168, s[4:7], s50 offen lds
  s_add_u32 s50, s50, s54
  ds_read_b64_tr_b16 v[116:117], v13 offset:32768
  v_mfma_f32_16x16x32_bf16 v[44:47], v[164:167], v[136:139], v[44:47]
  ds_read_b64_tr_b16 v[118:119], v13 offset:40448
  v_mfma_f32_16x16x32_bf16 v[40:43], v[136:139], v[160:163], v[40:43]
  ds_read_b64_tr_b16 v[120:121], v13 offset:32928
  v_mfma_f32_16x16x32_bf16 v[56:59], v[140:143], v[160:163], v[56:59]
  ds_read_b64_tr_b16 v[122:123], v13 offset:40608
  s_add_u32 m0, s58, 49152
  v_mfma_f32_16x16x32_bf16 v[60:63], v[164:167], v[140:143], v[60:63]
  buffer_load_dwordx4 v168, s[4:7], s51 offen lds
  s_add_u32 s51, s51, s54
  ds_read_b64_tr_b16 v[124:125], v13 offset:33088
  v_mfma_f32_16x16x32_bf16 v[52:55], v[156:159], v[140:143], v[52:55]
  ds_read_b64_tr_b16 v[126:127], v13 offset:40768
  v_mfma_f32_16x16x32_bf16 v[48:51], v[152:155], v[140:143], v[48:51]
  ds_read_b64_tr_b16 v[128:129], v219 offset:32768
  v_mfma_f32_16x16x32_bf16 v[64:67], v[152:155], v[144:147], v[64:67]
  ds_read_b64_tr_b16 v[130:131], v220 offset:32768
  s_add_u32 m0, s59, 49152
  s_setprio 2
  v_mfma_f32_16x16x32_bf16 v[68:71], v[156:159], v[144:147], v[68:71]
  buffer_load_dwordx4 v169, s[8:11], s52 offen lds
  ds_read_b128 v[100:103], v10 offset:34816
  v_mfma_f32_16x16x32_bf16 v[76:79], v[164:167], v[144:147], v[76:79]
  ds_read_b128 v[104:107], v10 offset:36864
  v_mfma_f32_16x16x32_bf16 v[72:75], v[144:147], v[160:163], v[72:75]
  ds_read_b128 v[108:111], v10 offset:38912
  v_mfma_f32_16x16x32_bf16 v[88:91], v[148:151], v[160:163], v[88:91]
  ds_read_b128 v[112:115], v10 offset:40960
  s_add_u32 m0, s60, 49152
  v_mfma_f32_16x16x32_bf16 v[92:95], v[164:167], v[148:151], v[92:95]
  buffer_load_dwordx4 v170, s[8:11], s52 offen lds
  v_mfma_f32_16x16x32_bf16 v[84:87], v[156:159], v[148:151], v[84:87]
  v_mfma_f32_16x16x32_bf16 v[80:83], v[152:155], v[148:151], v[80:83]
  v_mfma_f32_16x16x32_bf16 v[20:23], v[156:159], v[132:135], v[20:23]
  v_mfma_f32_16x16x32_bf16 v[28:31], v[164:167], v[132:135], v[28:31]
  v_mfma_f32_16x16x32_bf16 v[24:27], v[132:135], v[160:163], v[24:27]
  s_waitcnt lgkmcnt(0)
  s_setprio 1
  v_mfma_f32_16x16x32_bf16 v[32:35], v[116:119], v[100:103], v[32:35]
  ds_read_b128 v[132:135], v11 offset:32768
  s_add_u32 m0, s61, 49152
  v_mfma_f32_16x16x32_bf16 v[36:39], v[120:123], v[100:103], v[36:39]
  buffer_load_dwordx4 v171, s[8:11], s52 offen lds
  s_add_u32 s52, s52, s55
  ds_read_b64_tr_b16 v[152:153], v13 offset:48128
  v_mfma_f32_16x16x32_bf16 v[44:47], v[128:131], v[100:103], v[44:47]
  ds_read_b64_tr_b16 v[154:155], v13 offset:55808
  v_mfma_f32_16x16x32_bf16 v[40:43], v[100:103], v[124:127], v[40:43]
  ds_read_b64_tr_b16 v[156:157], v13 offset:48288
  v_mfma_f32_16x16x32_bf16 v[56:59], v[104:107], v[124:127], v[56:59]
  ds_read_b64_tr_b16 v[158:159], v13 offset:55968
  s_add_u32 m0, s62, 49152
  v_mfma_f32_16x16x32_bf16 v[60:63], v[128:131], v[104:107], v[60:63]
  buffer_load_dwordx4 v172, s[12:15], s53 offen lds
  s_add_u32 s53, s53, s56
  ds_read_b64_tr_b16 v[160:161], v13 offset:48448
  v_mfma_f32_16x16x32_bf16 v[52:55], v[120:123], v[104:107], v[52:55]
  ds_read_b64_tr_b16 v[162:163], v13 offset:56128
  v_mfma_f32_16x16x32_bf16 v[48:51], v[116:119], v[104:107], v[48:51]
  ds_read_b64_tr_b16 v[164:165], v230 offset:32768
  v_mfma_f32_16x16x32_bf16 v[64:67], v[116:119], v[108:111], v[64:67]
  ds_read_b64_tr_b16 v[166:167], v231 offset:32768
  s_setprio 0
  v_mfma_f32_16x16x32_bf16 v[68:71], v[120:123], v[108:111], v[68:71]
  buffer_load_dword v235, v234, s[96:99], s3 offen
  ds_read_b128 v[136:139], v11 offset:34816
  v_mfma_f32_16x16x32_bf16 v[76:79], v[128:131], v[108:111], v[76:79]
  ds_read_b128 v[140:143], v11 offset:36864
  v_mfma_f32_16x16x32_bf16 v[72:75], v[108:111], v[124:127], v[72:75]
  ds_read_b128 v[144:147], v11 offset:38912
  v_mfma_f32_16x16x32_bf16 v[88:91], v[112:115], v[124:127], v[88:91]
  ds_read_b128 v[148:151], v11 offset:40960
  v_mfma_f32_16x16x32_bf16 v[92:95], v[128:131], v[112:115], v[92:95]
  v_mfma_f32_16x16x32_bf16 v[84:87], v[120:123], v[112:115], v[84:87]
  v_mfma_f32_16x16x32_bf16 v[80:83], v[116:119], v[112:115], v[80:83]
  v_mfma_f32_16x16x32_bf16 v[20:23], v[120:123], v[96:99], v[20:23]
  v_mfma_f32_16x16x32_bf16 v[28:31], v[128:131], v[96:99], v[28:31]
  v_mfma_f32_16x16x32_bf16 v[24:27], v[96:99], v[124:127], v[24:27]
  s_waitcnt vmcnt(7) lgkmcnt(0)
  s_barrier
  s_setprio 3
  v_mfma_f32_16x16x32_bf16 v[32:35], v[152:155], v[136:139], v[32:35]
  ds_read_b128 v[96:99], v8 offset:0
  v_mfma_f32_16x16x32_bf16 v[36:39], v[156:159], v[136:139], v[36:39]
  buffer_load_dword v208, off, s[20:23], 0 sc1
  ds_read_b64_tr_b16 v[116:117], v12 offset:0
  v_mfma_f32_16x16x32_bf16 v[44:47], v[164:167], v[136:139], v[44:47]
  ds_read_b64_tr_b16 v[118:119], v12 offset:7680
  v_mfma_f32_16x16x32_bf16 v[40:43], v[136:139], v[160:163], v[40:43]
  ds_read_b64_tr_b16 v[120:121], v12 offset:160
  v_mfma_f32_16x16x32_bf16 v[56:59], v[140:143], v[160:163], v[56:59]
  ds_read_b64_tr_b16 v[122:123], v12 offset:7840
  s_add_u32 m0, s57, 98304
  v_mfma_f32_16x16x32_bf16 v[60:63], v[164:167], v[140:143], v[60:63]
  buffer_load_dwordx4 v168, s[4:7], s50 offen lds
  s_add_u32 s50, s50, s54
  ds_read_b64_tr_b16 v[124:125], v12 offset:320
  v_mfma_f32_16x16x32_bf16 v[52:55], v[156:159], v[140:143], v[52:55]
  ds_read_b64_tr_b16 v[126:127], v12 offset:8000
  v_mfma_f32_16x16x32_bf16 v[48:51], v[152:155], v[140:143], v[48:51]
  ds_read_b64_tr_b16 v[128:129], v209 offset:0
  v_mfma_f32_16x16x32_bf16 v[64:67], v[152:155], v[144:147], v[64:67]
  ds_read_b64_tr_b16 v[130:131], v216 offset:0
  s_add_u32 m0, s58, 98304
  s_setprio 2
  v_mfma_f32_16x16x32_bf16 v[68:71], v[156:159], v[144:147], v[68:71]
  buffer_load_dwordx4 v168, s[4:7], s51 offen lds
  s_add_u32 s51, s51, s54
  ds_read_b128 v[100:103], v8 offset:2048
  v_mfma_f32_16x16x32_bf16 v[76:79], v[164:167], v[144:147], v[76:79]
  ds_read_b128 v[104:107], v8 offset:4096
  v_mfma_f32_16x16x32_bf16 v[72:75], v[144:147], v[160:163], v[72:75]
  ds_read_b128 v[108:111], v8 offset:6144
  v_mfma_f32_16x16x32_bf16 v[88:91], v[148:151], v[160:163], v[88:91]
  ds_read_b128 v[112:115], v8 offset:8192
  s_add_u32 m0, s59, 98304
  v_mfma_f32_16x16x32_bf16 v[92:95], v[164:167], v[148:151], v[92:95]
  buffer_load_dwordx4 v169, s[8:11], s52 offen lds
  v_mfma_f32_16x16x32_bf16 v[84:87], v[156:159], v[148:151], v[84:87]
  v_mfma_f32_16x16x32_bf16 v[80:83], v[152:155], v[148:151], v[80:83]
  v_mfma_f32_16x16x32_bf16 v[20:23], v[156:159], v[132:135], v[20:23]
  v_mfma_f32_16x16x32_bf16 v[28:31], v[164:167], v[132:135], v[28:31]
  v_mfma_f32_16x16x32_bf16 v[24:27], v[132:135], v[160:163], v[24:27]
  s_waitcnt lgkmcnt(0)
  s_setprio 1
  v_mfma_f32_16x16x32_bf16 v[32:35], v[116:119], v[100:103], v[32:35]
  ds_read_b128 v[132:135], v9 offset:0
  s_add_u32 m0, s60, 98304
  v_mfma_f32_16x16x32_bf16 v[36:39], v[120:123], v[100:103], v[36:39]
  buffer_load_dwordx4 v170, s[8:11], s52 offen lds
  ds_read_b64_tr_b16 v[152:153], v12 offset:15360
  v_mfma_f32_16x16x32_bf16 v[44:47], v[128:131], v[100:103], v[44:47]
  ds_read_b64_tr_b16 v[154:155], v12 offset:23040
  v_mfma_f32_16x16x32_bf16 v[40:43], v[100:103], v[124:127], v[40:43]
  ds_read_b64_tr_b16 v[156:157], v12 offset:15520
  v_mfma_f32_16x16x32_bf16 v[56:59], v[104:107], v[124:127], v[56:59]
  ds_read_b64_tr_b16 v[158:159], v12 offset:23200
  s_add_u32 m0, s61, 98304
  v_mfma_f32_16x16x32_bf16 v[60:63], v[128:131], v[104:107], v[60:63]
  buffer_load_dwordx4 v171, s[8:11], s52 offen lds
  s_add_u32 s52, s52, s55
  ds_read_b64_tr_b16 v[160:161], v12 offset:15680
  v_mfma_f32_16x16x32_bf16 v[52:55], v[120:123], v[104:107], v[52:55]
  ds_read_b64_tr_b16 v[162:163], v12 offset:23360
  v_mfma_f32_16x16x32_bf16 v[48:51], v[116:119], v[104:107], v[48:51]
  ds_read_b64_tr_b16 v[164:165], v217 offset:0
  v_mfma_f32_16x16x32_bf16 v[64:67], v[116:119], v[108:111], v[64:67]
  ds_read_b64_tr_b16 v[166:167], v218 offset:0
  s_add_u32 m0, s62, 98304
  s_setprio 0
  v_mfma_f32_16x16x32_bf16 v[68:71], v[120:123], v[108:111], v[68:71]
  buffer_load_dwordx4 v172, s[12:15], s53 offen lds
  s_add_u32 s53, s53, s56
  ds_read_b128 v[136:139], v9 offset:2048
  v_mfma_f32_16x16x32_bf16 v[76:79], v[128:131], v[108:111], v[76:79]
  ds_read_b128 v[140:143], v9 offset:4096
  v_mfma_f32_16x16x32_bf16 v[72:75], v[108:111], v[124:127], v[72:75]
  ds_read_b128 v[144:147], v9 offset:6144
  v_mfma_f32_16x16x32_bf16 v[88:91], v[112:115], v[124:127], v[88:91]
  ds_read_b128 v[148:151], v9 offset:8192
  v_mfma_f32_16x16x32_bf16 v[92:95], v[128:131], v[112:115], v[92:95]
  v_mfma_f32_16x16x32_bf16 v[84:87], v[120:123], v[112:115], v[84:87]
  v_mfma_f32_16x16x32_bf16 v[80:83], v[116:119], v[112:115], v[80:83]
  v_mfma_f32_16x16x32_bf16 v[20:23], v[120:123], v[96:99], v[20:23]
  v_mfma_f32_16x16x32_bf16 v[28:31], v[128:131], v[96:99], v[28:31]
  v_mfma_f32_16x16x32_bf16 v[24:27], v[96:99], v[124:127], v[24:27]
  s_waitcnt vmcnt(8) lgkmcnt(0)
  s_barrier
  s_setprio 3
  v_mfma_f32_16x16x32_bf16 v[32:35], v[152:155], v[136:139], v[32:35]
  ds_read_b128 v[96:99], v8 offset:49152
  s_add_u32 m0, s57, 0
  v_mfma_f32_16x16x32_bf16 v[36:39], v[156:159], v[136:139], v[36:39]
  buffer_load_dwordx4 v168, s[4:7], s50 offen lds
  s_add_u32 s50, s50, s54
  ds_read_b64_tr_b16 v[116:117], v12 offset:49152
  v_mfma_f32_16x16x32_bf16 v[44:47], v[164:167], v[136:139], v[44:47]
  ds_read_b64_tr_b16 v[118:119], v12 offset:56832
  v_mfma_f32_16x16x32_bf16 v[40:43], v[136:139], v[160:163], v[40:43]
  ds_read_b64_tr_b16 v[120:121], v12 offset:49312
  v_mfma_f32_16x16x32_bf16 v[56:59], v[140:143], v[160:163], v[56:59]
  ds_read_b64_tr_b16 v[122:123], v12 offset:56992
  v_mfma_f32_16x16x32_bf16 v[60:63], v[164:167], v[140:143], v[60:63]
  ds_read_b64_tr_b16 v[124:125], v12 offset:49472
  s_add_u32 m0, s58, 0
  v_mfma_f32_16x16x32_bf16 v[52:55], v[156:159], v[140:143], v[52:55]
  buffer_load_dwordx4 v168, s[4:7], s51 offen lds
  s_add_u32 s51, s51, s54
  ds_read_b64_tr_b16 v[126:127], v12 offset:57152
  v_mfma_f32_16x16x32_bf16 v[48:51], v[152:155], v[140:143], v[48:51]
  ds_read_b64_tr_b16 v[128:129], v209 offset:49152
  v_mfma_f32_16x16x32_bf16 v[64:67], v[152:155], v[144:147], v[64:67]
  ds_read_b64_tr_b16 v[130:131], v216 offset:49152
  s_setprio 2
  v_mfma_f32_16x16x32_bf16 v[68:71], v[156:159], v[144:147], v[68:71]
  ds_read_b128 v[100:103], v8 offset:51200
  v_mfma_f32_16x16x32_bf16 v[76:79], v[164:167], v[144:147], v[76:79]
  ds_read_b128 v[104:107], v8 offset:53248
  v_mfma_f32_16x16x32_bf16 v[72:75], v[144:147], v[160:163], v[72:75]
  ds_read_b128 v[108:111], v8 offset:55296
  s_add_u32 m0, s59, 0
  v_mfma_f32_16x16x32_bf16 v[88:91], v[148:151], v[160:163], v[88:91]
  buffer_load_dwordx4 v169, s[8:11], s52 offen lds
  ds_read_b128 v[112:115], v8 offset:57344
  v_mfma_f32_16x16x32_bf16 v[92:95], v[164:167], v[148:151], v[92:95]
  v_mfma_f32_16x16x32_bf16 v[84:87], v[156:159], v[148:151], v[84:87]
  v_mfma_f32_16x16x32_bf16 v[80:83], v[152:155], v[148:151], v[80:83]
  v_mfma_f32_16x16x32_bf16 v[20:23], v[156:159], v[132:135], v[20:23]
  v_mfma_f32_16x16x32_bf16 v[28:31], v[164:167], v[132:135], v[28:31]
  v_mfma_f32_16x16x32_bf16 v[24:27], v[132:135], v[160:163], v[24:27]
  s_waitcnt lgkmcnt(0)
  s_setprio 1
  v_mfma_f32_16x16x32_bf16 v[32:35], v[116:119], v[100:103], v[32:35]
  ds_read_b128 v[132:135], v9 offset:49152
  s_add_u32 m0, s60, 0
  v_mfma_f32_16x16x32_bf16 v[36:39], v[120:123], v[100:103], v[36:39]
  buffer_load_dwordx4 v170, s[8:11], s52 offen lds
  ds_read_b64_tr_b16 v[152:153], v12 offset:64512
  v_mfma_f32_16x16x32_bf16 v[44:47], v[128:131], v[100:103], v[44:47]
  ds_read_b64_tr_b16 v[154:155], v13 offset:6656
  v_mfma_f32_16x16x32_bf16 v[40:43], v[100:103], v[124:127], v[40:43]
  ds_read_b64_tr_b16 v[156:157], v12 offset:64672
  v_mfma_f32_16x16x32_bf16 v[56:59], v[104:107], v[124:127], v[56:59]
  ds_read_b64_tr_b16 v[158:159], v13 offset:6816
  s_add_u32 m0, s61, 0
  v_mfma_f32_16x16x32_bf16 v[60:63], v[128:131], v[104:107], v[60:63]
  buffer_load_dwordx4 v171, s[8:11], s52 offen lds
  s_add_u32 s52, s52, s55
  ds_read_b64_tr_b16 v[160:161], v12 offset:64832
  v_mfma_f32_16x16x32_bf16 v[52:55], v[120:123], v[104:107], v[52:55]
  ds_read_b64_tr_b16 v[162:163], v13 offset:6976
  v_mfma_f32_16x16x32_bf16 v[48:51], v[116:119], v[104:107], v[48:51]
  ds_read_b64_tr_b16 v[164:165], v217 offset:49152
  v_mfma_f32_16x16x32_bf16 v[64:67], v[116:119], v[108:111], v[64:67]
  ds_read_b64_tr_b16 v[166:167], v218 offset:49152
  s_add_u32 m0, s62, 0
  s_setprio 0
  v_mfma_f32_16x16x32_bf16 v[68:71], v[120:123], v[108:111], v[68:71]
  buffer_load_dwordx4 v172, s[12:15], s53 offen lds
  s_add_u32 s53, s53, s56
  ds_read_b128 v[136:139], v9 offset:51200
  v_mfma_f32_16x16x32_bf16 v[76:79], v[128:131], v[108:111], v[76:79]
  ds_read_b128 v[140:143], v9 offset:53248
  v_mfma_f32_16x16x32_bf16 v[72:75], v[108:111], v[124:127], v[72:75]
  ds_read_b128 v[144:147], v9 offset:55296
  v_mfma_f32_16x16x32_bf16 v[88:91], v[112:115], v[124:127], v[88:91]
  ds_read_b128 v[148:151], v9 offset:57344
  v_mfma_f32_16x16x32_bf16 v[92:95], v[128:131], v[112:115], v[92:95]
  v_mfma_f32_16x16x32_bf16 v[84:87], v[120:123], v[112:115], v[84:87]
  v_mfma_f32_16x16x32_bf16 v[80:83], v[116:119], v[112:115], v[80:83]
  v_mfma_f32_16x16x32_bf16 v[20:23], v[120:123], v[96:99], v[20:23]
  v_mfma_f32_16x16x32_bf16 v[28:31], v[128:131], v[96:99], v[28:31]
  v_mfma_f32_16x16x32_bf16 v[24:27], v[96:99], v[124:127], v[24:27]
  s_waitcnt vmcnt(6) lgkmcnt(0)
  s_barrier
  s_setprio 3
  v_mfma_f32_16x16x32_bf16 v[32:35], v[152:155], v[136:139], v[32:35]
  ds_read_b128 v[96:99], v10 offset:32768
  v_cmp_eq_u32 vcc, 0, v208
  s_cbranch_vccnz L_slow_6
L_back_7:
  v_readfirstlane_b32 s70, v208
  s_add_u32 m0, s57, 49152
  v_mfma_f32_16x16x32_bf16 v[36:39], v[156:159], v[136:139], v[36:39]
  buffer_load_dwordx4 v168, s[4:7], s50 offen lds
  s_add_u32 s50, s50, s54
  ds_read_b64_tr_b16 v[116:117], v13 offset:32768
  v_mfma_f32_16x16x32_bf16 v[44:47], v[164:167], v[136:139], v[44:47]
  ds_read_b64_tr_b16 v[118:119], v13 offset:40448
  v_mfma_f32_16x16x32_bf16 v[40:43], v[136:139], v[160:163], v[40:43]
  ds_read_b64_tr_b16 v[120:121], v13 offset:32928
  v_mfma_f32_16x16x32_bf16 v[56:59], v[140:143], v[160:163], v[56:59]
  ds_read_b64_tr_b16 v[122:123], v13 offset:40608
  v_mfma_f32_16x16x32_bf16 v[60:63], v[164:167], v[140:143], v[60:63]
  ds_read_b64_tr_b16 v[124:125], v13 offset:33088
  s_add_u32 m0, s58, 49152
  v_mfma_f32_16x16x32_bf16 v[52:55], v[156:159], v[140:143], v[52:55]
  buffer_load_dwordx4 v168, s[4:7], s51 offen lds
  s_add_u32 s51, s51, s54
  ds_read_b64_tr_b16 v[126:127], v13 offset:40768
  v_mfma_f32_16x16x32_bf16 v[48:51], v[152:155], v[140:143], v[48:51]
  ds_read_b64_tr_b16 v[128:129], v219 offset:32768
  v_mfma_f32_16x16x32_bf16 v[64:67], v[152:155], v[144:147], v[64:67]
  ds_read_b64_tr_b16 v[130:131], v220 offset:32768
  s_setprio 2
  v_mfma_f32_16x16x32_bf16 v[68:71], v[156:159], v[144:147], v[68:71]
  ds_read_b128 v[100:103], v10 offset:34816
  v_mfma_f32_16x16x32_bf16 v[76:79], v[164:167], v[144:147], v[76:79]
  ds_read_b128 v[104:107], v10 offset:36864
  v_mfma_f32_16x16x32_bf16 v[72:75], v[144:147], v[160:163], v[72:75]
  ds_read_b128 v[108:111], v10 offset:38912
  s_add_u32 m0, s59, 49152
  v_mfma_f32_16x16x32_bf16 v[88:91], v[148:151], v[160:163], v[88:91]
  buffer_load_dwordx4 v169, s[8:11], s52 offen lds
  ds_read_b128 v[112:115], v10 offset:40960
  v_mfma_f32_16x16x32_bf16 v[92:95], v[164:167], v[148:151], v[92:95]
  v_mfma_f32_16x16x32_bf16 v[84:87], v[156:159], v[148:151], v[84:87]
  v_mfma_f32_16x16x32_bf16 v[80:83], v[152:155], v[148:151], v[80:83]
  v_mfma_f32_16x16x32_bf16 v[20:23], v[156:159], v[132:135], v[20:23]
  v_mfma_f32_16x16x32_bf16 v[28:31], v[164:167], v[132:135], v[28:31]
  v_mfma_f32_16x16x32_bf16 v[24:27], v[132:135], v[160:163], v[24:27]
  s_waitcnt lgkmcnt(0)
  s_setprio 1
  v_mfma_f32_16x16x32_bf16 v[32:35], v[116:119], v[100:103], v[32:35]
  ds_read_b128 v[132:135], v11 offset:32768
  s_add_u32 m0, s60, 49152
  v_mfma_f32_16x16x32_bf16 v[36:39], v[120:123], v[100:103], v[36:39]
  buffer_load_dwordx4 v170, s[8:11], s52 offen lds
  ds_read_b64_tr_b16 v[152:153], v13 offset:48128
  v_mfma_f32_16x16x32_bf16 v[44:47], v[128:131], v[100:103], v[44:47]
  ds_read_b64_tr_b16 v[154:155], v13 offset:55808
  v_mfma_f32_16x16x32_bf16 v[40:43], v[100:103], v[124:127], v[40:43]
  ds_read_b64_tr_b16 v[156:157], v13 offset:48288
  v_mfma_f32_16x16x32_bf16 v[56:59], v[104:107], v[124:127], v[56:59]
  ds_read_b64_tr_b16 v[158:159], v13 offset:55968
  s_add_u32 m0, s61, 49152
  v_mfma_f32_16x16x32_bf16 v[60:63], v[128:131], v[104:107], v[60:63]
  buffer_load_dwordx4 v171, s[8:11], s52 offen lds
  s_add_u32 s52, s52, s55
  ds_read_b64_tr_b16 v[160:161], v13 offset:48448
  v_mfma_f32_16x16x32_bf16 v[52:55], v[120:123], v[104:107], v[52:55]
  ds_read_b64_tr_b16 v[162:163], v13 offset:56128
  v_mfma_f32_16x16x32_bf16 v[48:51], v[116:119], v[104:107], v[48:51]
  ds_read_b64_tr_b16 v[164:165], v230 offset:32768
  v_mfma_f32_16x16x32_bf16 v[64:67], v[116:119], v[108:111], v[64:67]
  ds_read_b64_tr_b16 v[166:167], v231 offset:32768
  s_add_u32 m0, s62, 49152
  s_setprio 0
  v_mfma_f32_16x16x32_bf16 v[68:71], v[120:123], v[108:111], v[68:71]
  buffer_load_dwordx4 v172, s[12:15], s53 offen lds
  s_add_u32 s53, s53, s56
  ds_read_b128 v[136:139], v11 offset:34816
  v_mfma_f32_16x16x32_bf16 v[76:79], v[128:131], v[108:111], v[76:79]
  ds_read_b128 v[140:143], v11 offset:36864
  v_mfma_f32_16x16x32_bf16 v[72:75], v[108:111], v[124:127], v[72:75]
  ds_read_b128 v[144:147], v11 offset:38912
  v_mfma_f32_16x16x32_bf16 v[88:91], v[112:115], v[124:127], v[88:91]
  ds_read_b128 v[148:151], v11 offset:40960
  v_mfma_f32_16x16x32_bf16 v[92:95], v[128:131], v[112:115], v[92:95]
  v_mfma_f32_16x16x32_bf16 v[84:87], v[120:123], v[112:115], v[84:87]
  v_mfma_f32_16x16x32_bf16 v[80:83], v[116:119], v[112:115], v[80:83]
  v_mfma_f32_16x16x32_bf16 v[20:23], v[120:123], v[96:99], v[20:23]
  v_mfma_f32_16x16x32_bf16 v[28:31], v[128:131], v[96:99], v[28:31]
  v_mfma_f32_16x16x32_bf16 v[24:27], v[96:99], v[124:127], v[24:27]
  s_waitcnt vmcnt(6) lgkmcnt(0)
  s_barrier
  s_setprio 3
  v_mfma_f32_16x16x32_bf16 v[32:35], v[152:155], v[136:139], v[32:35]
  ds_read_b128 v[96:99], v8 offset:0
  v_mfma_f32_16x16x32_bf16 v[36:39], v[156:159], v[136:139], v[36:39]
  buffer_load_dwordx4 v[226:229], v222, s[16:19], 0 offen sc1
  ds_read_b64_tr_b16 v[116:117], v12 offset:0
  v_mfma_f32_16x16x32_bf16 v[44:47], v[164:167], v[136:139], v[44:47]
  ds_read_b64_tr_b16 v[118:119], v12 offset:7680
  v_mfma_f32_16x16x32_bf16 v[40:43], v[136:139], v[160:163], v[40:43]
  ds_read_b64_tr_b16 v[120:121], v12 offset:160
  v_mfma_f32_16x16x32_bf16 v[56:59], v[140:143], v[160:163], v[56:59]
  ds_read_b64_tr_b16 v[122:123], v12 offset:7840
  s_add_u32 m0, s57, 98304
  v_mfma_f32_16x16x32_bf16 v[60:63], v[164:167], v[140:143], v[60:63]
  buffer_load_dwordx4 v168, s[4:7], s50 offen lds
  s_add_u32 s50, s50, s54
  ds_read_b64_tr_b16 v[124:125], v12 offset:320
  v_mfma_f32_16x16x32_bf16 v[52:55], v[156:159], v[140:143], v[52:55]
  ds_read_b64_tr_b16 v[126:127], v12 offset:8000
  v_mfma_f32_16x16x32_bf16 v[48:51], v[152:155], v[140:143], v[48:51]
  ds_read_b64_tr_b16 v[128:129], v209 offset:0
  v_mfma_f32_16x16x32_bf16 v[64:67], v[152:155], v[144:147], v[64:67]
  ds_read_b64_tr_b16 v[130:131], v216 offset:0
  s_add_u32 m0, s58, 98304
  s_setprio 2
  v_mfma_f32_16x16x32_bf16 v[68:71], v[156:159], v[144:147], v[68:71]
  buffer_load_dwordx4 v168, s[4:7], s51 offen lds
  s_add_u32 s51, s51, s54
  ds_read_b128 v[100:103], v8 offset:2048
  v_mfma_f32_16x16x32_bf16 v[76:79], v[164:167], v[144:147], v[76:79]
  ds_read_b128 v[104:107], v8 offset:4096
  v_mfma_f32_16x16x32_bf16 v[72:75], v[144:147], v[160:163], v[72:75]
  ds_read_b128 v[108:111], v8 offset:6144
  v_mfma_f32_16x16x32_bf16 v[88:91], v[148:151], v[160:163], v[88:91]
  ds_read_b128 v[112:115], v8 offset:8192
  s_add_u32 m0, s59, 98304
  v_mfma_f32_16x16x32_bf16 v[92:95], v[164:167], v[148:151], v[92:95]
  buffer_load_dwordx4 v169, s[8:11], s52 offen lds
  v_mfma_f32_16x16x32_bf16 v[84:87], v[156:159], v[148:151], v[84:87]
  v_mfma_f32_16x16x32_bf16 v[80:83], v[152:155], v[148:151], v[80:83]
  v_mfma_f32_16x16x32_bf16 v[20:23], v[156:159], v[132:135], v[20:23]
  v_mfma_f32_16x16x32_bf16 v[28:31], v[164:167], v[132:135], v[28:31]
  v_mfma_f32_16x16x32_bf16 v[24:27], v[132:135], v[160:163], v[24:27]
  s_waitcnt lgkmcnt(0)
  s_setprio 1
  v_mfma_f32_16x16x32_bf16 v[32:35], v[116:119], v[100:103], v[32:35]
  ds_read_b128 v[132:135], v9 offset:0
  s_add_u32 m0, s60, 98304
  v_mfma_f32_16x16x32_bf16 v[36:39], v[120:123], v[100:103], v[36:39]
  buffer_load_dwordx4 v170, s[8:11], s52 offen lds
  ds_read_b64_tr_b16 v[152:153], v12 offset:15360
  v_mfma_f32_16x16x32_bf16 v[44:47], v[128:131], v[100:103], v[44:47]
  ds_read_b64_tr_b16 v[154:155], v12 offset:23040
  v_mfma_f32_16x16x32_bf16 v[40:43], v[100:103], v[124:127], v[40:43]
  ds_read_b64_tr_b16 v[156:157], v12 offset:15520
  v_mfma_f32_16x16x32_bf16 v[56:59], v[104:107], v[124:127], v[56:59]
  ds_read_b64_tr_b16 v[158:159], v12 offset:23200
  s_add_u32 m0, s61, 98304
  v_mfma_f32_16x16x32_bf16 v[60:63], v[128:131], v[104:107], v[60:63]
  buffer_load_dwordx4 v171, s[8:11], s52 offen lds
  s_add_u32 s52, s52, s55
  ds_read_b64_tr_b16 v[160:161], v12 offset:15680
  v_mfma_f32_16x16x32_bf16 v[52:55], v[120:123], v[104:107], v[52:55]
  ds_read_b64_tr_b16 v[162:163], v12 offset:23360
  v_mfma_f32_16x16x32_bf16 v[48:51], v[116:119], v[104:107], v[48:51]
  ds_read_b64_tr_b16 v[164:165], v217 offset:0
  v_mfma_f32_16x16x32_bf16 v[64:67], v[116:119], v[108:111], v[64:67]
  ds_read_b64_tr_b16 v[166:167], v218 offset:0
  s_add_u32 m0, s62, 98304
  s_setprio 0
  v_mfma_f32_16x16x32_bf16 v[68:71], v[120:123], v[108:111], v[68:71]
  buffer_load_dwordx4 v172, s[12:15], s53 offen lds
  s_add_u32 s53, s53, s56
  ds_read_b128 v[136:139], v9 offset:2048
  v_mfma_f32_16x16x32_bf16 v[76:79], v[128:131], v[108:111], v[76:79]
  ds_read_b128 v[140:143], v9 offset:4096
  v_mfma_f32_16x16x32_bf16 v[72:75], v[108:111], v[124:127], v[72:75]
  ds_read_b128 v[144:147], v9 offset:6144
  v_mfma_f32_16x16x32_bf16 v[88:91], v[112:115], v[124:127], v[88:91]
  ds_read_b128 v[148:151], v9 offset:8192
  v_mfma_f32_16x16x32_bf16 v[92:95], v[128:131], v[112:115], v[92:95]
  v_mfma_f32_16x16x32_bf16 v[84:87], v[120:123], v[112:115], v[84:87]
  v_mfma_f32_16x16x32_bf16 v[80:83], v[116:119], v[112:115], v[80:83]
  v_mfma_f32_16x16x32_bf16 v[20:23], v[120:123], v[96:99], v[20:23]
  v_mfma_f32_16x16x32_bf16 v[28:31], v[128:131], v[96:99], v[28:31]
  v_mfma_f32_16x16x32_bf16 v[24:27], v[96:99], v[124:127], v[24:27]
  s_waitcnt vmcnt(7) lgkmcnt(0)
  s_barrier
  s_setprio 3
  v_mfma_f32_16x16x32_bf16 v[32:35], v[152:155], v[136:139], v[32:35]
  ds_read_b128 v[96:99], v8 offset:49152
  s_add_u32 m0, s57, 0
  v_mfma_f32_16x16x32_bf16 v[36:39], v[156:159], v[136:139], v[36:39]
  buffer_load_dwordx4 v168, s[4:7], s50 offen lds
  ds_read_b64_tr_b16 v[116:117], v12 offset:49152
  v_mfma_f32_16x16x32_bf16 v[44:47], v[164:167], v[136:139], v[44:47]
  ds_read_b64_tr_b16 v[118:119], v12 offset:56832
  v_mfma_f32_16x16x32_bf16 v[40:43], v[136:139], v[160:163], v[40:43]
  ds_read_b64_tr_b16 v[120:121], v12 offset:49312
  v_mfma_f32_16x16x32_bf16 v[56:59], v[140:143], v[160:163], v[56:59]
  ds_read_b64_tr_b16 v[122:123], v12 offset:56992
  v_mfma_f32_16x16x32_bf16 v[60:63], v[164:167], v[140:143], v[60:63]
  ds_read_b64_tr_b16 v[124:125], v12 offset:49472
  s_add_u32 m0, s58, 0
  v_mfma_f32_16x16x32_bf16 v[52:55], v[156:159], v[140:143], v[52:55]
  buffer_load_dwordx4 v168, s[4:7], s51 offen lds
  ds_read_b64_tr_b16 v[126:127], v12 offset:57152
  v_mfma_f32_16x16x32_bf16 v[48:51], v[152:155], v[140:143], v[48:51]
  ds_read_b64_tr_b16 v[128:129], v209 offset:49152
  v_mfma_f32_16x16x32_bf16 v[64:67], v[152:155], v[144:147], v[64:67]
  ds_read_b64_tr_b16 v[130:131], v216 offset:49152
  s_setprio 2
  v_mfma_f32_16x16x32_bf16 v[68:71], v[156:159], v[144:147], v[68:71]
  ds_read_b128 v[100:103], v8 offset:51200
  v_mfma_f32_16x16x32_bf16 v[76:79], v[164:167], v[144:147], v[76:79]
  ds_read_b128 v[104:107], v8 offset:53248
  v_mfma_f32_16x16x32_bf16 v[72:75], v[144:147], v[160:163], v[72:75]
  ds_read_b128 v[108:111], v8 offset:55296
  s_add_u32 m0, s59, 0
  v_mfma_f32_16x16x32_bf16 v[88:91], v[148:151], v[160:163], v[88:91]
  buffer_load_dwordx4 v169, s[8:11], s52 offen lds
  ds_read_b128 v[112:115], v8 offset:57344
  v_mfma_f32_16x16x32_bf16 v[92:95], v[164:167], v[148:151], v[92:95]
  v_mfma_f32_16x16x32_bf16 v[84:87], v[156:159], v[148:151], v[84:87]
  v_mfma_f32_16x16x32_bf16 v[80:83], v[152:155], v[148:151], v[80:83]
  v_mfma_f32_16x16x32_bf16 v[20:23], v[156:159], v[132:135], v[20:23]
  v_mfma_f32_16x16x32_bf16 v[28:31], v[164:167], v[132:135], v[28:31]
  v_mfma_f32_16x16x32_bf16 v[24:27], v[132:135], v[160:163], v[24:27]
  s_waitcnt lgkmcnt(0)
  s_setprio 1
  v_mfma_f32_16x16x32_bf16 v[32:35], v[116:119], v[100:103], v[32:35]
  ds_read_b128 v[132:135], v9 offset:49152
  s_add_u32 m0, s60, 0
  v_mfma_f32_16x16x32_bf16 v[36:39], v[120:123], v[100:103], v[36:39]
  buffer_load_dwordx4 v170, s[8:11], s52 offen lds
  ds_read_b64_tr_b16 v[152:153], v12 offset:64512
  v_mfma_f32_16x16x32_bf16 v[44:47], v[128:131], v[100:103], v[44:47]
  ds_read_b64_tr_b16 v[154:155], v13 offset:6656
  v_mfma_f32_16x16x32_bf16 v[40:43], v[100:103], v[124:127], v[40:43]
  ds_read_b64_tr_b16 v[156:157], v12 offset:64672
  v_mfma_f32_16x16x32_bf16 v[56:59], v[104:107], v[124:127], v[56:59]
  ds_read_b64_tr_b16 v[158:159], v13 offset:6816
  s_add_u32 m0, s61, 0
  v_mfma_f32_16x16x32_bf16 v[60:63], v[128:131], v[104:107], v[60:63]
  buffer_load_dwordx4 v171, s[8:11], s52 offen lds
  ds_read_b64_tr_b16 v[160:161], v12 offset:64832
  v_mfma_f32_16x16x32_bf16 v[52:55], v[120:123], v[104:107], v[52:55]
  ds_read_b64_tr_b16 v[162:163], v13 offset:6976
  v_mfma_f32_16x16x32_bf16 v[48:51], v[116:119], v[104:107], v[48:51]
  ds_read_b64_tr_b16 v[164:165], v217 offset:49152
  v_mfma_f32_16x16x32_bf16 v[64:67], v[116:119], v[108:111], v[64:67]
  ds_read_b64_tr_b16 v[166:167], v218 offset:49152
  s_add_u32 m0, s62, 0
  s_setprio 0
  v_mfma_f32_16x16x32_bf16 v[68:71], v[120:123], v[108:111], v[68:71]
  buffer_load_dwordx4 v172, s[12:15], s53 offen lds
  ds_read_b128 v[136:139], v9 offset:51200
  v_mfma_f32_16x16x32_bf16 v[76:79], v[128:131], v[108:111], v[76:79]
  ds_read_b128 v[140:143], v9 offset:53248
  v_mfma_f32_16x16x32_bf16 v[72:75], v[108:111], v[124:127], v[72:75]
  ds_read_b128 v[144:147], v9 offset:55296
  v_mfma_f32_16x16x32_bf16 v[88:91], v[112:115], v[124:127], v[88:91]
  ds_read_b128 v[148:151], v9 offset:57344
  v_mfma_f32_16x16x32_bf16 v[92:95], v[128:131], v[112:115], v[92:95]
  v_mfma_f32_16x16x32_bf16 v[84:87], v[120:123], v[112:115], v[84:87]
  v_mfma_f32_16x16x32_bf16 v[80:83], v[116:119], v[112:115], v[80:83]
  v_mfma_f32_16x16x32_bf16 v[20:23], v[120:123], v[96:99], v[20:23]
  v_mfma_f32_16x16x32_bf16 v[28:31], v[128:131], v[96:99], v[28:31]
  v_mfma_f32_16x16x32_bf16 v[24:27], v[96:99], v[124:127], v[24:27]
  s_waitcnt vmcnt(6) lgkmcnt(0)
  s_barrier
  s_setprio 3
  v_mfma_f32_16x16x32_bf16 v[32:35], v[152:155], v[136:139], v[32:35]
  ds_read_b128 v[96:99], v10 offset:32768
  s_waitcnt vmcnt(12)
  v_cmp_ne_u32 vcc, s70, v227
  v_cmp_ne_u32 s[88:89], s70, v229
  s_nop 1
  s_or_b64 vcc, vcc, s[88:89]
  s_cbranch_vccnz L_slow_9
L_back_10:
  s_add_u32 m0, s74, 49152
  s_add_u32 s86, s71, 40960
  v_mfma_f32_16x16x32_bf16 v[36:39], v[156:159], v[136:139], v[36:39]
  buffer_load_dwordx4 v3, s[40:43], s86 offen lds
  ds_read_b64_tr_b16 v[116:117], v13 offset:32768
  ds_write_b32 v224, v228
  v_fmac_f32 v226, v225, v228
  v_mfma_f32_16x16x32_bf16 v[44:47], v[164:167], v[136:139], v[44:47]
  ds_read_b64_tr_b16 v[118:119], v13 offset:40448
  ds_write_b32 v223, v226
  v_mfma_f32_16x16x32_bf16 v[40:43], v[136:139], v[160:163], v[40:43]
  ds_read_b64_tr_b16 v[120:121], v13 offset:32928
  v_mfma_f32_16x16x32_bf16 v[56:59], v[140:143], v[160:163], v[56:59]
  ds_read_b64_tr_b16 v[122:123], v13 offset:40608
  v_mfma_f32_16x16x32_bf16 v[60:63], v[164:167], v[140:143], v[60:63]
  ds_read_b64_tr_b16 v[124:125], v13 offset:33088
  s_add_u32 m0, s74, 50176
  s_add_u32 s86, s71, 102400
  v_mfma_f32_16x16x32_bf16 v[52:55], v[156:159], v[140:143], v[52:55]
  buffer_load_dwordx4 v3, s[40:43], s86 offen lds
  ds_read_b64_tr_b16 v[126:127], v13 offset:40768
  v_mfma_f32_16x16x32_bf16 v[48:51], v[152:155], v[140:143], v[48:51]
  ds_read_b64_tr_b16 v[128:129], v219 offset:32768
  v_mfma_f32_16x16x32_bf16 v[64:67], v[152:155], v[144:147], v[64:67]
  ds_read_b64_tr_b16 v[130:131], v220 offset:32768
  s_setprio 2
  v_mfma_f32_16x16x32_bf16 v[68:71], v[156:159], v[144:147], v[68:71]
  ds_read_b128 v[100:103], v10 offset:34816
  v_mfma_f32_16x16x32_bf16 v[76:79], v[164:167], v[144:147], v[76:79]
  ds_read_b128 v[104:107], v10 offset:36864
  v_mfma_f32_16x16x32_bf16 v[72:75], v[144:147], v[160:163], v[72:75]
  ds_read_b128 v[108:111], v10 offset:38912
  s_add_u32 m0, s74, 65536
  s_add_u32 s86, s71, 51200
  v_mfma_f32_16x16x32_bf16 v[88:91], v[148:151], v[160:163], v[88:91]
  buffer_load_dwordx4 v3, s[40:43], s86 offen lds
  ds_read_b128 v[112:115], v10 offset:40960
  v_mfma_f32_16x16x32_bf16 v[92:95], v[164:167], v[148:151], v[92:95]
  v_mfma_f32_16x16x32_bf16 v[84:87], v[156:159], v[148:151], v[84:87]
  v_mfma_f32_16x16x32_bf16 v[80:83], v[152:155], v[148:151], v[80:83]
  v_mfma_f32_16x16x32_bf16 v[20:23], v[156:159], v[132:135], v[20:23]
  v_mfma_f32_16x16x32_bf16 v[28:31], v[164:167], v[132:135], v[28:31]
  v_mfma_f32_16x16x32_bf16 v[24:27], v[132:135], v[160:163], v[24:27]
  s_waitcnt lgkmcnt(0)
  s_setprio 1
  v_mfma_f32_16x16x32_bf16 v[32:35], v[116:119], v[100:103], v[32:35]
  ds_read_b128 v[132:135], v11 offset:32768
  s_add_u32 m0, s74, 66560
  s_add_u32 s86, s71, 112640
  v_mfma_f32_16x16x32_bf16 v[36:39], v[120:123], v[100:103], v[36:39]
  buffer_load_dwordx4 v3, s[40:43], s86 offen lds
  ds_read_b64_tr_b16 v[152:153], v13 offset:48128
  v_mfma_f32_16x16x32_bf16 v[44:47], v[128:131], v[100:103], v[44:47]
  ds_read_b64_tr_b16 v[154:155], v13 offset:55808
  v_mfma_f32_16x16x32_bf16 v[40:43], v[100:103], v[124:127], v[40:43]
  ds_read_b64_tr_b16 v[156:157], v13 offset:48288
  v_mfma_f32_16x16x32_bf16 v[56:59], v[104:107], v[124:127], v[56:59]
  ds_read_b64_tr_b16 v[158:159], v13 offset:55968
  s_add_u32 m0, s74, 81920
  s_add_u32 s86, s71, 163840
  v_mfma_f32_16x16x32_bf16 v[60:63], v[128:131], v[104:107], v[60:63]
  buffer_load_dwordx4 v3, s[40:43], s86 offen lds
  ds_read_b64_tr_b16 v[160:161], v13 offset:48448
  v_mfma_f32_16x16x32_bf16 v[52:55], v[120:123], v[104:107], v[52:55]
  ds_read_b64_tr_b16 v[162:163], v13 offset:56128
  v_mfma_f32_16x16x32_bf16 v[48:51], v[116:119], v[104:107], v[48:51]
  ds_read_b64_tr_b16 v[164:165], v230 offset:32768
  v_mfma_f32_16x16x32_bf16 v[64:67], v[116:119], v[108:111], v[64:67]
  ds_read_b64_tr_b16 v[166:167], v231 offset:32768
  s_add_u32 m0, s74, 82944
  s_add_u32 s86, s71, 225280
  s_setprio 0
  v_mfma_f32_16x16x32_bf16 v[68:71], v[120:123], v[108:111], v[68:71]
  buffer_load_dwordx4 v3, s[40:43], s86 offen lds
  ds_read_b128 v[136:139], v11 offset:34816
  v_mfma_f32_16x16x32_bf16 v[76:79], v[128:131], v[108:111], v[76:79]
  ds_read_b128 v[140:143], v11 offset:36864
  v_mfma_f32_16x16x32_bf16 v[72:75], v[108:111], v[124:127], v[72:75]
  ds_read_b128 v[144:147], v11 offset:38912
  v_mfma_f32_16x16x32_bf16 v[88:91], v[112:115], v[124:127], v[88:91]
  ds_read_b128 v[148:151], v11 offset:40960
  v_mfma_f32_16x16x32_bf16 v[92:95], v[128:131], v[112:115], v[92:95]
  v_mfma_f32_16x16x32_bf16 v[84:87], v[120:123], v[112:115], v[84:87]
  v_mfma_f32_16x16x32_bf16 v[80:83], v[116:119], v[112:115], v[80:83]
  v_mfma_f32_16x16x32_bf16 v[20:23], v[120:123], v[96:99], v[20:23]
  v_mfma_f32_16x16x32_bf16 v[28:31], v[128:131], v[96:99], v[28:31]
  v_mfma_f32_16x16x32_bf16 v[24:27], v[96:99], v[124:127], v[24:27]
  s_waitcnt vmcnt(6) lgkmcnt(0)
  s_barrier
  s_setprio 3
  v_mfma_f32_16x16x32_bf16 v[32:35], v[152:155], v[136:139], v[32:35]
  ds_read_b128 v[96:99], v8 offset:0
  s_add_u32 m0, s74, 98304
  s_add_u32 s86, s71, 174080
  v_mfma_f32_16x16x32_bf16 v[36:39], v[156:159], v[136:139], v[36:39]
  buffer_load_dwordx4 v3, s[40:43], s86 offen lds
  ds_read_b64_tr_b16 v[116:117], v12 offset:0
  v_mfma_f32_16x16x32_bf16 v[44:47], v[164:167], v[136:139], v[44:47]
  ds_read_b64_tr_b16 v[118:119], v12 offset:7680
  v_mfma_f32_16x16x32_bf16 v[40:43], v[136:139], v[160:163], v[40:43]
  ds_read_b64_tr_b16 v[120:121], v12 offset:160
  v_mfma_f32_16x16x32_bf16 v[56:59], v[140:143], v[160:163], v[56:59]
  ds_read_b64_tr_b16 v[122:123], v12 offset:7840
  v_mfma_f32_16x16x32_bf16 v[60:63], v[164:167], v[140:143], v[60:63]
  ds_read_b64_tr_b16 v[124:125], v12 offset:320
  s_add_u32 m0, s74, 99328
  s_add_u32 s86, s71, 235520
  v_mfma_f32_16x16x32_bf16 v[52:55], v[156:159], v[140:143], v[52:55]
  buffer_load_dwordx4 v3, s[40:43], s86 offen lds
  ds_read_b64_tr_b16 v[126:127], v12 offset:8000
  v_mfma_f32_16x16x32_bf16 v[48:51], v[152:155], v[140:143], v[48:51]
  ds_read_b64_tr_b16 v[128:129], v209 offset:0
  v_mfma_f32_16x16x32_bf16 v[64:67], v[152:155], v[144:147], v[64:67]
  ds_read_b64_tr_b16 v[130:131], v216 offset:0
  s_setprio 2
  v_mfma_f32_16x16x32_bf16 v[68:71], v[156:159], v[144:147], v[68:71]
  ds_read_b128 v[100:103], v8 offset:2048
  v_mfma_f32_16x16x32_bf16 v[76:79], v[164:167], v[144:147], v[76:79]
  ds_read_b128 v[104:107], v8 offset:4096
  v_mfma_f32_16x16x32_bf16 v[72:75], v[144:147], v[160:163], v[72:75]
  ds_read_b128 v[108:111], v8 offset:6144
  s_add_u32 m0, s74, 114688
  s_add_u32 s86, s71, 0
  v_mfma_f32_16x16x32_bf16 v[88:91], v[148:151], v[160:163], v[88:91]
  buffer_load_dwordx4 v3, s[40:43], s86 offen lds
  ds_read_b128 v[112:115], v8 offset:8192
  v_mfma_f32_16x16x32_bf16 v[92:95], v[164:167], v[148:151], v[92:95]
  v_mfma_f32_16x16x32_bf16 v[84:87], v[156:159], v[148:151], v[84:87]
  v_mfma_f32_16x16x32_bf16 v[80:83], v[152:155], v[148:151], v[80:83]
  v_mfma_f32_16x16x32_bf16 v[20:23], v[156:159], v[132:135], v[20:23]
  v_mfma_f32_16x16x32_bf16 v[28:31], v[164:167], v[132:135], v[28:31]
  v_mfma_f32_16x16x32_bf16 v[24:27], v[132:135], v[160:163], v[24:27]
  s_waitcnt lgkmcnt(0)
  s_setprio 1
  v_mfma_f32_16x16x32_bf16 v[32:35], v[116:119], v[100:103], v[32:35]
  ds_read_b128 v[132:135], v9 offset:0
  s_add_u32 m0, s74, 115712
  s_add_u32 s86, s71, 10240
  v_mfma_f32_16x16x32_bf16 v[36:39], v[120:123], v[100:103], v[36:39]
  buffer_load_dwordx4 v3, s[40:43], s86 offen lds
  ds_read_b64_tr_b16 v[152:153], v12 offset:15360
  v_mfma_f32_16x16x32_bf16 v[44:47], v[128:131], v[100:103], v[44:47]
  ds_read_b64_tr_b16 v[154:155], v12 offset:23040
  v_mfma_f32_16x16x32_bf16 v[40:43], v[100:103], v[124:127], v[40:43]
  ds_read_b64_tr_b16 v[156:157], v12 offset:15520
  v_mfma_f32_16x16x32_bf16 v[56:59], v[104:107], v[124:127], v[56:59]
  ds_read_b64_tr_b16 v[158:159], v12 offset:23200
  s_add_u32 m0, s74, 131072
  s_add_u32 s86, s71, 20480
  v_mfma_f32_16x16x32_bf16 v[60:63], v[128:131], v[104:107], v[60:63]
  buffer_load_dwordx4 v3, s[40:43], s86 offen lds
  ds_read_b64_tr_b16 v[160:161], v12 offset:15680
  v_mfma_f32_16x16x32_bf16 v[52:55], v[120:123], v[104:107], v[52:55]
  ds_read_b64_tr_b16 v[162:163], v12 offset:23360
  v_mfma_f32_16x16x32_bf16 v[48:51], v[116:119], v[104:107], v[48:51]
  ds_read_b64_tr_b16 v[164:165], v217 offset:0
  v_mfma_f32_16x16x32_bf16 v[64:67], v[116:119], v[108:111], v[64:67]
  ds_read_b64_tr_b16 v[166:167], v218 offset:0
  s_add_u32 m0, s74, 132096
  s_add_u32 s86, s71, 30720
  s_setprio 0
  v_mfma_f32_16x16x32_bf16 v[68:71], v[120:123], v[108:111], v[68:71]
  buffer_load_dwordx4 v3, s[40:43], s86 offen lds
  ds_read_b128 v[136:139], v9 offset:2048
  v_mfma_f32_16x16x32_bf16 v[76:79], v[128:131], v[108:111], v[76:79]
  ds_read_b128 v[140:143], v9 offset:4096
  v_mfma_f32_16x16x32_bf16 v[72:75], v[108:111], v[124:127], v[72:75]
  ds_read_b128 v[144:147], v9 offset:6144
  v_mfma_f32_16x16x32_bf16 v[88:91], v[112:115], v[124:127], v[88:91]
  ds_read_b128 v[148:151], v9 offset:8192
  v_mfma_f32_16x16x32_bf16 v[92:95], v[128:131], v[112:115], v[92:95]
  v_mfma_f32_16x16x32_bf16 v[84:87], v[120:123], v[112:115], v[84:87]
  v_mfma_f32_16x16x32_bf16 v[80:83], v[116:119], v[112:115], v[80:83]
  v_mfma_f32_16x16x32_bf16 v[20:23], v[120:123], v[96:99], v[20:23]
  v_mfma_f32_16x16x32_bf16 v[28:31], v[128:131], v[96:99], v[28:31]
  v_mfma_f32_16x16x32_bf16 v[24:27], v[96:99], v[124:127], v[24:27]
  s_waitcnt lgkmcnt(0)
  s_barrier
  s_setprio 1
  v_mfma_f32_16x16x32_bf16 v[84:87], v[156:159], v[148:151], v[84:87]
  s_lshl_b32 s86, s67, 8
  s_add_u32 s86, s86, 148736
  v_lshl_add_u32 v14, v5, 4, s86
  v_lshl_add_u32 v15, v6, 2, s86
  s_add_u32 m0, s74, 0
  s_add_u32 s86, s71, 61440
  v_mfma_f32_16x16x32_bf16 v[88:91], v[148:151], v[160:163], v[88:91]
  buffer_load_dwordx4 v3, s[40:43], s86 offen lds
  ds_read_b128 v[106:109], v14
  ds_read_b128 v[110:113], v14 offset:64
  v_mfma_f32_16x16x32_bf16 v[92:95], v[164:167], v[148:151], v[92:95]
  ds_read_b128 v[114:117], v14 offset:192
  ds_read_b32 v118, v15 offset:128
  v_mfma_f32_16x16x32_bf16 v[32:35], v[152:155], v[136:139], v[32:35]
  s_lshl_b32 s86, s66, 8
  s_add_u32 s86, s86, 147456
  v_lshl_add_u32 v14, v6, 2, s86
  v_lshl_add_u32 v15, v5, 4, s86
  v_mfma_f32_16x16x32_bf16 v[36:39], v[156:159], v[136:139], v[36:39]
  ds_read2_b32 v[96:97], v14 offset0:0 offset1:160
  s_mul_i32 s86, s67, 3072
  s_add_u32 s86, s86, 32768
  v_add_u32 v13, s86, v2
  s_add_u32 m0, s74, 1024
  s_add_u32 s86, s71, 71680
  v_mfma_f32_16x16x32_bf16 v[44:47], v[164:167], v[136:139], v[44:47]
  buffer_load_dwordx4 v3, s[40:43], s86 offen lds
  ds_write_b128 v13, v[84:87] offset:0
  s_nop 0
  ds_write_b128 v13, v[88:91] offset:1024
  s_nop 0
  v_mfma_f32_16x16x32_bf16 v[40:43], v[136:139], v[160:163], v[40:43]
  ds_write_b128 v13, v[92:95] offset:2048
  s_nop 0
  ds_read2_b32 v[98:99], v14 offset0:16 offset1:176
  v_mfma_f32_16x16x32_bf16 v[56:59], v[140:143], v[160:163], v[56:59]
  ds_read2_b32 v[100:101], v14 offset0:32 offset1:192
  ds_read2_b32 v[102:103], v14 offset0:48 offset1:208
  v_mfma_f32_16x16x32_bf16 v[60:63], v[164:167], v[140:143], v[60:63]
  ds_read2_b32 v[104:105], v14 offset0:64 offset1:224
  ds_read_b128 v[120:123], v15 offset:64
  s_add_u32 m0, s74, 16384
  s_add_u32 s86, s71, 81920
  s_setprio 0
  v_mfma_f32_16x16x32_bf16 v[52:55], v[156:159], v[140:143], v[52:55]
  buffer_load_dwordx4 v3, s[40:43], s86 offen lds
  ds_read_b128 v[124:127], v15 offset:704
  v_mfma_f32_16x16x32_bf16 v[48:51], v[152:155], v[140:143], v[48:51]
  v_mfma_f32_16x16x32_bf16 v[64:67], v[152:155], v[144:147], v[64:67]
  v_mfma_f32_16x16x32_bf16 v[68:71], v[156:159], v[144:147], v[68:71]
  s_add_u32 m0, s74, 17408
  s_add_u32 s86, s71, 92160
  v_mfma_f32_16x16x32_bf16 v[76:79], v[164:167], v[144:147], v[76:79]
  buffer_load_dwordx4 v3, s[40:43], s86 offen lds
  v_mfma_f32_16x16x32_bf16 v[72:75], v[144:147], v[160:163], v[72:75]
  v_mfma_f32_16x16x32_bf16 v[80:83], v[152:155], v[148:151], v[80:83]
  v_mfma_f32_16x16x32_bf16 v[20:23], v[156:159], v[132:135], v[20:23]
  v_mfma_f32_16x16x32_bf16 v[28:31], v[164:167], v[132:135], v[28:31]
  v_mfma_f32_16x16x32_bf16 v[24:27], v[132:135], v[160:163], v[24:27]
  s_waitcnt lgkmcnt(6)
  s_barrier
  s_branch L_aepi
L_a1:
  s_waitcnt vmcnt(3) lgkmcnt(0)
  s_barrier
  ds_read_b128 v[100:103], v8 offset:2048
  ds_read_b64_tr_b16 v[116:117], v12 offset:0
  ds_read_b64_tr_b16 v[118:119], v12 offset:7680
  ds_read_b64_tr_b16 v[120:121], v12 offset:160
  ds_read_b64_tr_b16 v[122:123], v12 offset:7840
  ds_read_b64_tr_b16 v[124:125], v12 offset:320
  ds_read_b64_tr_b16 v[126:127], v12 offset:8000
  ds_read_b64_tr_b16 v[128:129], v209 offset:0
  ds_read_b64_tr_b16 v[130:131], v216 offset:0
  ds_read_b128 v[104:107], v8 offset:4096
  ds_read_b128 v[108:111], v8 offset:6144
  ds_read_b128 v[112:115], v8 offset:8192
  s_waitcnt lgkmcnt(0)
  v_mfma_f32_16x16x32_bf16 v[32:35], v[116:119], v[100:103], 0
  ds_read_b128 v[136:139], v9 offset:2048
  s_add_u32 m0, s60, 49152
  v_mfma_f32_16x16x32_bf16 v[36:39], v[120:123], v[100:103], 0
  buffer_load_dwordx4 v170, s[8:11], s52 offen lds
  ds_read_b64_tr_b16 v[152:153], v12 offset:15360
  s_add_u32 m0, s61, 49152
  v_mfma_f32_16x16x32_bf16 v[44:47], v[128:131], v[100:103], 0
  buffer_load_dwordx4 v171, s[8:11], s52 offen lds
  s_add_u32 s52, s52, s55
  ds_read_b64_tr_b16 v[154:155], v12 offset:23040
  v_mfma_f32_16x16x32_bf16 v[40:43], v[100:103], v[124:127], 0
  ds_read_b64_tr_b16 v[156:157], v12 offset:15520
  s_add_u32 m0, s62, 49152
  v_mfma_f32_16x16x32_bf16 v[56:59], v[104:107], v[124:127], 0
  buffer_load_dwordx4 v172, s[12:15], s53 offen lds
  s_add_u32 s53, s53, s56
  ds_read_b64_tr_b16 v[158:159], v12 offset:23200
  s_add_u32 m0, s57, 98304
  v_mfma_f32_16x16x32_bf16 v[60:63], v[128:131], v[104:107], 0
  buffer_load_dwordx4 v168, s[4:7], s50 offen lds
  s_add_u32 s50, s50, s54
  ds_read_b64_tr_b16 v[160:161], v12 offset:15680
  v_mfma_f32_16x16x32_bf16 v[52:55], v[120:123], v[104:107], 0
  ds_read_b64_tr_b16 v[162:163], v12 offset:23360
  s_add_u32 m0, s58, 98304
  v_mfma_f32_16x16x32_bf16 v[48:51], v[116:119], v[104:107], 0
  buffer_load_dwordx4 v168, s[4:7], s51 offen lds
  s_add_u32 s51, s51, s54
  ds_read_b64_tr_b16 v[164:165], v217 offset:0
  s_add_u32 m0, s59, 98304
  v_mfma_f32_16x16x32_bf16 v[64:67], v[116:119], v[108:111], 0
  buffer_load_dwordx4 v169, s[8:11], s52 offen lds
  ds_read_b64_tr_b16 v[166:167], v218 offset:0
  v_mfma_f32_16x16x32_bf16 v[68:71], v[120:123], v[108:111], 0
  ds_read_b128 v[140:143], v9 offset:4096
  s_add_u32 m0, s60, 98304
  v_mfma_f32_16x16x32_bf16 v[76:79], v[128:131], v[108:111], 0
  buffer_load_dwordx4 v170, s[8:11], s52 offen lds
  ds_read_b128 v[144:147], v9 offset:6144
  s_add_u32 m0, s61, 98304
  v_mfma_f32_16x16x32_bf16 v[72:75], v[108:111], v[124:127], 0
  buffer_load_dwordx4 v171, s[8:11], s52 offen lds
  s_add_u32 s52, s52, s55
  ds_read_b128 v[148:151], v9 offset:8192
  v_mfma_f32_16x16x32_bf16 v[88:91], v[112:115], v[124:127], 0
  s_add_u32 m0, s62, 98304
  v_mfma_f32_16x16x32_bf16 v[92:95], v[128:131], v[112:115], 0
  buffer_load_dwordx4 v172, s[12:15], s53 offen lds
  s_add_u32 s53, s53, s56
  v_mfma_f32_16x16x32_bf16 v[84:87], v[120:123], v[112:115], 0
  v_mfma_f32_16x16x32_bf16 v[80:83], v[116:119], v[112:115], 0
  s_waitcnt vmcnt(6) lgkmcnt(0)
  s_barrier
  s_setprio 3
  v_mfma_f32_16x16x32_bf16 v[32:35], v[152:155], v[136:139], v[32:35]
  ds_read_b128 v[100:103], v8 offset:51200
  s_add_u32 m0, s57, 0
  v_mfma_f32_16x16x32_bf16 v[36:39], v[156:159], v[136:139], v[36:39]
  buffer_load_dwordx4 v168, s[4:7], s50 offen lds
  s_add_u32 s50, s50, s54
  ds_read_b64_tr_b16 v[116:117], v12 offset:49152
  v_mfma_f32_16x16x32_bf16 v[44:47], v[164:167], v[136:139], v[44:47]
  ds_read_b64_tr_b16 v[118:119], v12 offset:56832
  v_mfma_f32_16x16x32_bf16 v[40:43], v[136:139], v[160:163], v[40:43]
  ds_read_b64_tr_b16 v[120:121], v12 offset:49312
  v_mfma_f32_16x16x32_bf16 v[56:59], v[140:143], v[160:163], v[56:59]
  ds_read_b64_tr_b16 v[122:123], v12 offset:56992
  s_add_u32 m0, s58, 0
  v_mfma_f32_16x16x32_bf16 v[60:63], v[164:167], v[140:143], v[60:63]
  buffer_load_dwordx4 v168, s[4:7], s51 offen lds
  s_add_u32 s51, s51, s54
  ds_read_b64_tr_b16 v[124:125], v12 offset:49472
  v_mfma_f32_16x16x32_bf16 v[52:55], v[156:159], v[140:143], v[52:55]
  ds_read_b64_tr_b16 v[126:127], v12 offset:57152
  v_mfma_f32_16x16x32_bf16 v[48:51], v[152:155], v[140:143], v[48:51]
  ds_read_b64_tr_b16 v[128:129], v209 offset:49152
  s_setprio 2
  v_mfma_f32_16x16x32_bf16 v[64:67], v[152:155], v[144:147], v[64:67]
  ds_read_b64_tr_b16 v[130:131], v216 offset:49152
  v_mfma_f32_16x16x32_bf16 v[68:71], v[156:159], v[144:147], v[68:71]
  ds_read_b128 v[104:107], v8 offset:53248
  s_add_u32 m0, s59, 0
  v_mfma_f32_16x16x32_bf16 v[76:79], v[164:167], v[144:147], v[76:79]
  buffer_load_dwordx4 v169, s[8:11], s52 offen lds
  ds_read_b128 v[108:111], v8 offset:55296
  v_mfma_f32_16x16x32_bf16 v[72:75], v[144:147], v[160:163], v[72:75]
  ds_read_b128 v[112:115], v8 offset:57344
  v_mfma_f32_16x16x32_bf16 v[88:91], v[148:151], v[160:163], v[88:91]
  v_mfma_f32_16x16x32_bf16 v[92:95], v[164:167], v[148:151], v[92:95]
  v_mfma_f32_16x16x32_bf16 v[84:87], v[156:159], v[148:151], v[84:87]
  v_mfma_f32_16x16x32_bf16 v[80:83], v[152:155], v[148:151], v[80:83]
  s_waitcnt lgkmcnt(0)
  s_setprio 1
  v_mfma_f32_16x16x32_bf16 v[32:35], v[116:119], v[100:103], v[32:35]
  ds_read_b128 v[136:139], v9 offset:51200
  s_add_u32 m0, s60, 0
  v_mfma_f32_16x16x32_bf16 v[36:39], v[120:123], v[100:103], v[36:39]
  buffer_load_dwordx4 v170, s[8:11], s52 offen lds
  ds_read_b64_tr_b16 v[152:153], v12 offset:64512
  v_mfma_f32_16x16x32_bf16 v[44:47], v[128:131], v[100:103], v[44:47]
  ds_read_b64_tr_b16 v[154:155], v13 offset:6656
  v_mfma_f32_16x16x32_bf16 v[40:43], v[100:103], v[124:127], v[40:43]
  ds_read_b64_tr_b16 v[156:157], v12 offset:64672
  s_add_u32 m0, s61, 0
  v_mfma_f32_16x16x32_bf16 v[56:59], v[104:107], v[124:127], v[56:59]
  buffer_load_dwordx4 v171, s[8:11], s52 offen lds
  s_add_u32 s52, s52, s55
  ds_read_b64_tr_b16 v[158:159], v13 offset:6816
  v_mfma_f32_16x16x32_bf16 v[60:63], v[128:131], v[104:107], v[60:63]
  ds_read_b64_tr_b16 v[160:161], v12 offset:64832
  v_mfma_f32_16x16x32_bf16 v[52:55], v[120:123], v[104:107], v[52:55]
  ds_read_b64_tr_b16 v[162:163], v13 offset:6976
  v_mfma_f32_16x16x32_bf16 v[48:51], v[116:119], v[104:107], v[48:51]
  ds_read_b64_tr_b16 v[164:165], v217 offset:49152
  s_add_u32 m0, s62, 0
  s_setprio 0
  v_mfma_f32_16x16x32_bf16 v[64:67], v[116:119], v[108:111], v[64:67]
  buffer_load_dwordx4 v172, s[12:15], s53 offen lds
  s_add_u32 s53, s53, s56
  ds_read_b64_tr_b16 v[166:167], v218 offset:49152
  v_mfma_f32_16x16x32_bf16 v[68:71], v[120:123], v[108:111], v[68:71]
  ds_read_b128 v[140:143], v9 offset:53248
  v_mfma_f32_16x16x32_bf16 v[76:79], v[128:131], v[108:111], v[76:79]
  ds_read_b128 v[144:147], v9 offset:55296
  v_mfma_f32_16x16x32_bf16 v[72:75], v[108:111], v[124:127], v[72:75]
  ds_read_b128 v[148:151], v9 offset:57344
  v_mfma_f32_16x16x32_bf16 v[88:91], v[112:115], v[124:127], v[88:91]
  v_mfma_f32_16x16x32_bf16 v[92:95], v[128:131], v[112:115], v[92:95]
  v_mfma_f32_16x16x32_bf16 v[84:87], v[120:123], v[112:115], v[84:87]
  v_mfma_f32_16x16x32_bf16 v[80:83], v[116:119], v[112:115], v[80:83]
  s_waitcnt vmcnt(6) lgkmcnt(0)
  s_barrier
  s_setprio 3
  v_mfma_f32_16x16x32_bf16 v[32:35], v[152:155], v[136:139], v[32:35]
  ds_read_b128 v[100:103], v10 offset:34816
  s_add_u32 m0, s57, 49152
  v_mfma_f32_16x16x32_bf16 v[36:39], v[156:159], v[136:139], v[36:39]
  buffer_load_dwordx4 v168, s[4:7], s50 offen lds
  s_add_u32 s50, s50, s54
  ds_read_b64_tr_b16 v[116:117], v13 offset:32768
  v_mfma_f32_16x16x32_bf16 v[44:47], v[164:167], v[136:139], v[44:47]
  ds_read_b64_tr_b16 v[118:119], v13 offset:40448
  v_mfma_f32_16x16x32_bf16 v[40:43], v[136:139], v[160:163], v[40:43]
  ds_read_b64_tr_b16 v[120:121], v13 offset:32928
  s_add_u32 m0, s58, 49152
  v_mfma_f32_16x16x32_bf16 v[56:59], v[140:143], v[160:163], v[56:59]
  buffer_load_dwordx4 v168, s[4:7], s51 offen lds
  s_add_u32 s51, s51, s54
  ds_read_b64_tr_b16 v[122:123], v13 offset:40608
  v_mfma_f32_16x16x32_bf16 v[60:63], v[164:167], v[140:143], v[60:63]
  ds_read_b64_tr_b16 v[124:125], v13 offset:33088
  v_mfma_f32_16x16x32_bf16 v[52:55], v[156:159], v[140:143], v[52:55]
  ds_read_b64_tr_b16 v[126:127], v13 offset:40768
  v_mfma_f32_16x16x32_bf16 v[48:51], v[152:155], v[140:143], v[48:51]
  ds_read_b64_tr_b16 v[128:129], v219 offset:32768
  s_add_u32 m0, s59, 49152
  s_setprio 2
  v_mfma_f32_16x16x32_bf16 v[64:67], v[152:155], v[144:147], v[64:67]
  buffer_load_dwordx4 v169, s[8:11], s52 offen lds
  ds_read_b64_tr_b16 v[130:131], v220 offset:32768
  v_mfma_f32_16x16x32_bf16 v[68:71], v[156:159], v[144:147], v[68:71]
  ds_read_b128 v[104:107], v10 offset:36864
  v_mfma_f32_16x16x32_bf16 v[76:79], v[164:167], v[144:147], v[76:79]
  ds_read_b128 v[108:111], v10 offset:38912
  s_add_u32 m0, s60, 49152
  v_mfma_f32_16x16x32_bf16 v[72:75], v[144:147], v[160:163], v[72:75]
  buffer_load_dwordx4 v170, s[8:11], s52 offen lds
  ds_read_b128 v[112:115], v10 offset:40960
  v_mfma_f32_16x16x32_bf16 v[88:91], v[148:151], v[160:163], v[88:91]
  v_mfma_f32_16x16x32_bf16 v[92:95], v[164:167], v[148:151], v[92:95]
  v_mfma_f32_16x16x32_bf16 v[84:87], v[156:159], v[148:151], v[84:87]
  v_mfma_f32_16x16x32_bf16 v[80:83], v[152:155], v[148:151], v[80:83]
  s_waitcnt lgkmcnt(0)
  s_setprio 1
  v_mfma_f32_16x16x32_bf16 v[32:35], v[116:119], v[100:103], v[32:35]
  ds_read_b128 v[136:139], v11 offset:34816
  s_add_u32 m0, s61, 49152
  v_mfma_f32_16x16x32_bf16 v[36:39], v[120:123], v[100:103], v[36:39]
  buffer_load_dwordx4 v171, s[8:11], s52 offen lds
  s_add_u32 s52, s52, s55
  ds_read_b64_tr_b16 v[152:153], v13 offset:48128
  v_mfma_f32_16x16x32_bf16 v[44:47], v[128:131], v[100:103], v[44:47]
  ds_read_b64_tr_b16 v[154:155], v13 offset:55808
  v_mfma_f32_16x16x32_bf16 v[40:43], v[100:103], v[124:127], v[40:43]
  ds_read_b64_tr_b16 v[156:157], v13 offset:48288
  s_add_u32 m0, s62, 49152
  v_mfma_f32_16x16x32_bf16 v[56:59], v[104:107], v[124:127], v[56:59]
  buffer_load_dwordx4 v172, s[12:15], s53 offen lds
  s_add_u32 s53, s53, s56
  ds_read_b64_tr_b16 v[158:159], v13 offset:55968
  v_mfma_f32_16x16x32_bf16 v[60:63], v[128:131], v[104:107], v[60:63]
  ds_read_b64_tr_b16 v[160:161], v13 offset:48448
  v_mfma_f32_16x16x32_bf16 v[52:55], v[120:123], v[104:107], v[52:55]
  ds_read_b64_tr_b16 v[162:163], v13 offset:56128
  v_mfma_f32_16x16x32_bf16 v[48:51], v[116:119], v[104:107], v[48:51]
  ds_read_b64_tr_b16 v[164:165], v230 offset:32768
  s_setprio 0
  v_mfma_f32_16x16x32_bf16 v[64:67], v[116:119], v[108:111], v[64:67]
  buffer_load_dword v235, v234, s[96:99], s3 offen
  ds_read_b64_tr_b16 v[166:167], v231 offset:32768
  v_mfma_f32_16x16x32_bf16 v[68:71], v[120:123], v[108:111], v[68:71]
  ds_read_b128 v[140:143], v11 offset:36864
  v_mfma_f32_16x16x32_bf16 v[76:79], v[128:131], v[108:111], v[76:79]
  ds_read_b128 v[144:147], v11 offset:38912
  v_mfma_f32_16x16x32_bf16 v[72:75], v[108:111], v[124:127], v[72:75]
  ds_read_b128 v[148:151], v11 offset:40960
  v_mfma_f32_16x16x32_bf16 v[88:91], v[112:115], v[124:127], v[88:91]
  v_mfma_f32_16x16x32_bf16 v[92:95], v[128:131], v[112:115], v[92:95]
  v_mfma_f32_16x16x32_bf16 v[84:87], v[120:123], v[112:115], v[84:87]
  v_mfma_f32_16x16x32_bf16 v[80:83], v[116:119], v[112:115], v[80:83]
  s_waitcnt vmcnt(7) lgkmcnt(0)
  s_barrier
  s_setprio 3
  v_mfma_f32_16x16x32_bf16 v[32:35], v[152:155], v[136:139], v[32:35]
  ds_read_b128 v[100:103], v8 offset:2048
  v_mfma_f32_16x16x32_bf16 v[36:39], v[156:159], v[136:139], v[36:39]
  buffer_load_dword v208, off, s[20:23], 0 sc1
  ds_read_b64_tr_b16 v[116:117], v12 offset:0
  v_mfma_f32_16x16x32_bf16 v[44:47], v[164:167], v[136:139], v[44:47]
  ds_read_b64_tr_b16 v[118:119], v12 offset:7680
  v_mfma_f32_16x16x32_bf16 v[40:43], v[136:139], v[160:163], v[40:43]
  ds_read_b64_tr_b16 v[120:121], v12 offset:160
  s_add_u32 m0, s57, 98304
  v_mfma_f32_16x16x32_bf16 v[56:59], v[140:143], v[160:163], v[56:59]
  buffer_load_dwordx4 v168, s[4:7], s50 offen lds
  s_add_u32 s50, s50, s54
  ds_read_b64_tr_b16 v[122:123], v12 offset:7840
  v_mfma_f32_16x16x32_bf16 v[60:63], v[164:167], v[140:143], v[60:63]
  ds_read_b64_tr_b16 v[124:125], v12 offset:320
  v_mfma_f32_16x16x32_bf16 v[52:55], v[156:159], v[140:143], v[52:55]
  ds_read_b64_tr_b16 v[126:127], v12 offset:8000
  v_mfma_f32_16x16x32_bf16 v[48:51], v[152:155], v[140:143], v[48:51]
  ds_read_b64_tr_b16 v[128:129], v209 offset:0
  s_add_u32 m0, s58, 98304
  s_setprio 2
  v_mfma_f32_16x16x32_bf16 v[64:67], v[152:155], v[144:147], v[64:67]
  buffer_load_dwordx4 v168, s[4:7], s51 offen lds
  s_add_u32 s51, s51, s54
  ds_read_b64_tr_b16 v[130:131], v216 offset:0
  v_mfma_f32_16x16x32_bf16 v[68:71], v[156:159], v[144:147], v[68:71]
  ds_read_b128 v[104:107], v8 offset:4096
  v_mfma_f32_16x16x32_bf16 v[76:79], v[164:167], v[144:147], v[76:79]
  ds_read_b128 v[108:111], v8 offset:6144
  s_add_u32 m0, s59, 98304
  v_mfma_f32_16x16x32_bf16 v[72:75], v[144:147], v[160:163], v[72:75]
  buffer_load_dwordx4 v169, s[8:11], s52 offen lds
  ds_read_b128 v[112:115], v8 offset:8192
  v_mfma_f32_16x16x32_bf16 v[88:91], v[148:151], v[160:163], v[88:91]
  v_mfma_f32_16x16x32_bf16 v[92:95], v[164:167], v[148:151], v[92:95]
  v_mfma_f32_16x16x32_bf16 v[84:87], v[156:159], v[148:151], v[84:87]
  v_mfma_f32_16x16x32_bf16 v[80:83], v[152:155], v[148:151], v[80:83]
  s_waitcnt lgkmcnt(0)
  s_setprio 1
  v_mfma_f32_16x16x32_bf16 v[32:35], v[116:119], v[100:103], v[32:35]
  ds_read_b128 v[136:139], v9 offset:2048
  s_add_u32 m0, s60, 98304
  v_mfma_f32_16x16x32_bf16 v[36:39], v[120:123], v[100:103], v[36:39]
  buffer_load_dwordx4 v170, s[8:11], s52 offen lds
  ds_read_b64_tr_b16 v[152:153], v12 offset:15360
  v_mfma_f32_16x16x32_bf16 v[44:47], v[128:131], v[100:103], v[44:47]
  ds_read_b64_tr_b16 v[154:155], v12 offset:23040
  v_mfma_f32_16x16x32_bf16 v[40:43], v[100:103], v[124:127], v[40:43]
  ds_read_b64_tr_b16 v[156:157], v12 offset:15520
  s_add_u32 m0, s61, 98304
  v_mfma_f32_16x16x32_bf16 v[56:59], v[104:107], v[124:127], v[56:59]
  buffer_load_dwordx4 v171, s[8:11], s52 offen lds
  s_add_u32 s52, s52, s55
  ds_read_b64_tr_b16 v[158:159], v12 offset:23200
  v_mfma_f32_16x16x32_bf16 v[60:63], v[128:131], v[104:107], v[60:63]
  ds_read_b64_tr_b16 v[160:161], v12 offset:15680
  v_mfma_f32_16x16x32_bf16 v[52:55], v[120:123], v[104:107], v[52:55]
  ds_read_b64_tr_b16 v[162:163], v12 offset:23360
  v_mfma_f32_16x16x32_bf16 v[48:51], v[116:119], v[104:107], v[48:51]
  ds_read_b64_tr_b16 v[164:165], v217 offset:0
  s_add_u32 m0, s62, 98304
  s_setprio 0
  v_mfma_f32_16x16x32_bf16 v[64:67], v[116:119], v[108:111], v[64:67]
  buffer_load_dwordx4 v172, s[12:15], s53 offen lds
  s_add_u32 s53, s53, s56
  ds_read_b64_tr_b16 v[166:167], v218 offset:0
  v_mfma_f32_16x16x32_bf16 v[68:71], v[120:123], v[108:111], v[68:71]
  ds_read_b128 v[140:143], v9 offset:4096
  v_mfma_f32_16x16x32_bf16 v[76:79], v[128:131], v[108:111], v[76:79]
  ds_read_b128 v[144:147], v9 offset:6144
  v_mfma_f32_16x16x32_bf16 v[72:75], v[108:111], v[124:127], v[72:75]
  ds_read_b128 v[148:151], v9 offset:8192
  v_mfma_f32_16x16x32_bf16 v[88:91], v[112:115], v[124:127], v[88:91]
  v_mfma_f32_16x16x32_bf16 v[92:95], v[128:131], v[112:115], v[92:95]
  v_mfma_f32_16x16x32_bf16 v[84:87], v[120:123], v[112:115], v[84:87]
  v_mfma_f32_16x16x32_bf16 v[80:83], v[116:119], v[112:115], v[80:83]
  s_waitcnt vmcnt(8) lgkmcnt(0)
  s_barrier
  s_setprio 3
  v_mfma_f32_16x16x32_bf16 v[32:35], v[152:155], v[136:139], v[32:35]
  ds_read_b128 v[100:103], v8 offset:51200
  s_add_u32 m0, s57, 0
  v_mfma_f32_16x16x32_bf16 v[36:39], v[156:159], v[136:139], v[36:39]
  buffer_load_dwordx4 v168, s[4:7], s50 offen lds
  s_add_u32 s50, s50, s54
  ds_read_b64_tr_b16 v[116:117], v12 offset:49152
  v_mfma_f32_16x16x32_bf16 v[44:47], v[164:167], v[136:139], v[44:47]
  ds_read_b64_tr_b16 v[118:119], v12 offset:56832
  v_mfma_f32_16x16x32_bf16 v[40:43], v[136:139], v[160:163], v[40:43]
  ds_read_b64_tr_b16 v[120:121], v12 offset:49312
  v_mfma_f32_16x16x32_bf16 v[56:59], v[140:143], v[160:163], v[56:59]
  ds_read_b64_tr_b16 v[122:123], v12 offset:56992
  s_add_u32 m0, s58, 0
  v_mfma_f32_16x16x32_bf16 v[60:63], v[164:167], v[140:143], v[60:63]
  buffer_load_dwordx4 v168, s[4:7], s51 offen lds
  s_add_u32 s51, s51, s54
  ds_read_b64_tr_b16 v[124:125], v12 offset:49472
  v_mfma_f32_16x16x32_bf16 v[52:55], v[156:159], v[140:143], v[52:55]
  ds_read_b64_tr_b16 v[126:127], v12 offset:57152
  v_mfma_f32_16x16x32_bf16 v[48:51], v[152:155], v[140:143], v[48:51]
  ds_read_b64_tr_b16 v[128:129], v209 offset:49152
  s_setprio 2
  v_mfma_f32_16x16x32_bf16 v[64:67], v[152:155], v[144:147], v[64:67]
  ds_read_b64_tr_b16 v[130:131], v216 offset:49152
  v_mfma_f32_16x16x32_bf16 v[68:71], v[156:159], v[144:147], v[68:71]
  ds_read_b128 v[104:107], v8 offset:53248
  s_add_u32 m0, s59, 0
  v_mfma_f32_16x16x32_bf16 v[76:79], v[164:167], v[144:147], v[76:79]
  buffer_load_dwordx4 v169, s[8:11], s52 offen lds
  ds_read_b128 v[108:111], v8 offset:55296
  v_mfma_f32_16x16x32_bf16 v[72:75], v[144:147], v[160:163], v[72:75]
  ds_read_b128 v[112:115], v8 offset:57344
  v_mfma_f32_16x16x32_bf16 v[88:91], v[148:151], v[160:163], v[88:91]
  v_mfma_f32_16x16x32_bf16 v[92:95], v[164:167], v[148:151], v[92:95]
  v_mfma_f32_16x16x32_bf16 v[84:87], v[156:159], v[148:151], v[84:87]
  v_mfma_f32_16x16x32_bf16 v[80:83], v[152:155], v[148:151], v[80:83]
  s_waitcnt lgkmcnt(0)
  s_setprio 1
  v_mfma_f32_16x16x32_bf16 v[32:35], v[116:119], v[100:103], v[32:35]
  ds_read_b128 v[136:139], v9 offset:51200
  s_add_u32 m0, s60, 0
  v_mfma_f32_16x16x32_bf16 v[36:39], v[120:123], v[100:103], v[36:39]
  buffer_load_dwordx4 v170, s[8:11], s52 offen lds
  ds_read_b64_tr_b16 v[152:153], v12 offset:64512
  v_mfma_f32_16x16x32_bf16 v[44:47], v[128:131], v[100:103], v[44:47]
  ds_read_b64_tr_b16 v[154:155], v13 offset:6656
  v_mfma_f32_16x16x32_bf16 v[40:43], v[100:103], v[124:127], v[40:43]
  ds_read_b64_tr_b16 v[156:157], v12 offset:64672
  s_add_u32 m0, s61, 0
  v_mfma_f32_16x16x32_bf16 v[56:59], v[104:107], v[124:127], v[56:59]
  buffer_load_dwordx4 v171, s[8:11], s52 offen lds
  s_add_u32 s52, s52, s55
  ds_read_b64_tr_b16 v[158:159], v13 offset:6816
  v_mfma_f32_16x16x32_bf16 v[60:63], v[128:131], v[104:107], v[60:63]
  ds_read_b64_tr_b16 v[160:161], v12 offset:64832
  v_mfma_f32_16x16x32_bf16 v[52:55], v[120:123], v[104:107], v[52:55]
  ds_read_b64_tr_b16 v[162:163], v13 offset:6976
  v_mfma_f32_16x16x32_bf16 v[48:51], v[116:119], v[104:107], v[48:51]
  ds_read_b64_tr_b16 v[164:165], v217 offset:49152
  s_add_u32 m0, s62, 0
  s_setprio 0
  v_mfma_f32_16x16x32_bf16 v[64:67], v[116:119], v[108:111], v[64:67]
  buffer_load_dwordx4 v172, s[12:15], s53 offen lds
  s_add_u32 s53, s53, s56
  ds_read_b64_tr_b16 v[166:167], v218 offset:49152
  v_mfma_f32_16x16x32_bf16 v[68:71], v[120:123], v[108:111], v[68:71]
  ds_read_b128 v[140:143], v9 offset:53248
  v_mfma_f32_16x16x32_bf16 v[76:79], v[128:131], v[108:111], v[76:79]
  ds_read_b128 v[144:147], v9 offset:55296
  v_mfma_f32_16x16x32_bf16 v[72:75], v[108:111], v[124:127], v[72:75]
  ds_read_b128 v[148:151], v9 offset:57344
  v_mfma_f32_16x16x32_bf16 v[88:91], v[112:115], v[124:127], v[88:91]
  v_mfma_f32_16x16x32_bf16 v[92:95], v[128:131], v[112:115], v[92:95]
  v_mfma_f32_16x16x32_bf16 v[84:87], v[120:123], v[112:115], v[84:87]
  v_mfma_f32_16x16x32_bf16 v[80:83], v[116:119], v[112:115], v[80:83]
  s_waitcnt vmcnt(6) lgkmcnt(0)
  s_barrier
  s_setprio 3
  v_mfma_f32_16x16x32_bf16 v[32:35], v[152:155], v[136:139], v[32:35]
  ds_read_b128 v[100:103], v10 offset:34816
  v_cmp_eq_u32 vcc, 0, v208
  s_cbranch_vccnz L_slow_12
L_back_13:
  v_readfirstlane_b32 s70, v208
  s_add_u32 m0, s57, 49152
  v_mfma_f32_16x16x32_bf16 v[36:39], v[156:159], v[136:139], v[36:39]
  buffer_load_dwordx4 v168, s[4:7], s50 offen lds
  s_add_u32 s50, s50, s54
  ds_read_b64_tr_b16 v[116:117], v13 offset:32768
  v_mfma_f32_16x16x32_bf16 v[44:47], v[164:167], v[136:139], v[44:47]
  ds_read_b64_tr_b16 v[118:119], v13 offset:40448
  v_mfma_f32_16x16x32_bf16 v[40:43], v[136:139], v[160:163], v[40:43]
  ds_read_b64_tr_b16 v[120:121], v13 offset:32928
  v_mfma_f32_16x16x32_bf16 v[56:59], v[140:143], v[160:163], v[56:59]
  ds_read_b64_tr_b16 v[122:123], v13 offset:40608
  s_add_u32 m0, s58, 49152
  v_mfma_f32_16x16x32_bf16 v[60:63], v[164:167], v[140:143], v[60:63]
  buffer_load_dwordx4 v168, s[4:7], s51 offen lds
  s_add_u32 s51, s51, s54
  ds_read_b64_tr_b16 v[124:125], v13 offset:33088
  v_mfma_f32_16x16x32_bf16 v[52:55], v[156:159], v[140:143], v[52:55]
  ds_read_b64_tr_b16 v[126:127], v13 offset:40768
  v_mfma_f32_16x16x32_bf16 v[48:51], v[152:155], v[140:143], v[48:51]
  ds_read_b64_tr_b16 v[128:129], v219 offset:32768
  s_setprio 2
  v_mfma_f32_16x16x32_bf16 v[64:67], v[152:155], v[144:147], v[64:67]
  ds_read_b64_tr_b16 v[130:131], v220 offset:32768
  v_mfma_f32_16x16x32_bf16 v[68:71], v[156:159], v[144:147], v[68:71]
  ds_read_b128 v[104:107], v10 offset:36864
  s_add_u32 m0, s59, 49152
  v_mfma_f32_16x16x32_bf16 v[76:79], v[164:167], v[144:147], v[76:79]
  buffer_load_dwordx4 v169, s[8:11], s52 offen lds
  ds_read_b128 v[108:111], v10 offset:38912
  v_mfma_f32_16x16x32_bf16 v[72:75], v[144:147], v[160:163], v[72:75]
  ds_read_b128 v[112:115], v10 offset:40960
  v_mfma_f32_16x16x32_bf16 v[88:91], v[148:151], v[160:163], v[88:91]
  v_mfma_f32_16x16x32_bf16 v[92:95], v[164:167], v[148:151], v[92:95]
  v_mfma_f32_16x16x32_bf16 v[84:87], v[156:159], v[148:151], v[84:87]
  v_mfma_f32_16x16x32_bf16 v[80:83], v[152:155], v[148:151], v[80:83]
  s_waitcnt lgkmcnt(0)
  s_setprio 1
  v_mfma_f32_16x16x32_bf16 v[32:35], v[116:119], v[100:103], v[32:35]
  ds_read_b128 v[136:139], v11 offset:34816
  s_add_u32 m0, s60, 49152
  v_mfma_f32_16x16x32_bf16 v[36:39], v[120:123], v[100:103], v[36:39]
  buffer_load_dwordx4 v170, s[8:11], s52 offen lds
  ds_read_b64_tr_b16 v[152:153], v13 offset:48128
  v_mfma_f32_16x16x32_bf16 v[44:47], v[128:131], v[100:103], v[44:47]
  ds_read_b64_tr_b16 v[154:155], v13 offset:55808
  v_mfma_f32_16x16x32_bf16 v[40:43], v[100:103], v[124:127], v[40:43]
  ds_read_b64_tr_b16 v[156:157], v13 offset:48288
  s_add_u32 m0, s61, 49152
  v_mfma_f32_16x16x32_bf16 v[56:59], v[104:107], v[124:127], v[56:59]
  buffer_load_dwordx4 v171, s[8:11], s52 offen lds
  s_add_u32 s52, s52, s55
  ds_read_b64_tr_b16 v[158:159], v13 offset:55968
  v_mfma_f32_16x16x32_bf16 v[60:63], v[128:131], v[104:107], v[60:63]
  ds_read_b64_tr_b16 v[160:161], v13 offset:48448
  v_mfma_f32_16x16x32_bf16 v[52:55], v[120:123], v[104:107], v[52:55]
  ds_read_b64_tr_b16 v[162:163], v13 offset:56128
  v_mfma_f32_16x16x32_bf16 v[48:51], v[116:119], v[104:107], v[48:51]
  ds_read_b64_tr_b16 v[164:165], v230 offset:32768
  s_add_u32 m0, s62, 49152
  s_setprio 0
  v_mfma_f32_16x16x32_bf16 v[64:67], v[116:119], v[108:111], v[64:67]
  buffer_load_dwordx4 v172, s[12:15], s53 offen lds
  s_add_u32 s53, s53, s56
  ds_read_b64_tr_b16 v[166:167], v231 offset:32768
  v_mfma_f32_16x16x32_bf16 v[68:71], v[120:123], v[108:111], v[68:71]
  ds_read_b128 v[140:143], v11 offset:36864
  v_mfma_f32_16x16x32_bf16 v[76:79], v[128:131], v[108:111], v[76:79]
  ds_read_b128 v[144:147], v11 offset:38912
  v_mfma_f32_16x16x32_bf16 v[72:75], v[108:111], v[124:127], v[72:75]
  ds_read_b128 v[148:151], v11 offset:40960
  v_mfma_f32_16x16x32_bf16 v[88:91], v[112:115], v[124:127], v[88:91]
  v_mfma_f32_16x16x32_bf16 v[92:95], v[128:131], v[112:115], v[92:95]
  v_mfma_f32_16x16x32_bf16 v[84:87], v[120:123], v[112:115], v[84:87]
  v_mfma_f32_16x16x32_bf16 v[80:83], v[116:119], v[112:115], v[80:83]
  s_waitcnt vmcnt(6) lgkmcnt(0)
  s_barrier
  s_setprio 3
  v_mfma_f32_16x16x32_bf16 v[32:35], v[152:155], v[136:139], v[32:35]
  ds_read_b128 v[100:103], v8 offset:2048
  v_mfma_f32_16x16x32_bf16 v[36:39], v[156:159], v[136:139], v[36:39]
  buffer_load_dwordx4 v[226:229], v222, s[16:19], 0 offen sc1
  ds_read_b64_tr_b16 v[116:117], v12 offset:0
  v_mfma_f32_16x16x32_bf16 v[44:47], v[164:167], v[136:139], v[44:47]
  ds_read_b64_tr_b16 v[118:119], v12 offset:7680
  v_mfma_f32_16x16x32_bf16 v[40:43], v[136:139], v[160:163], v[40:43]
  ds_read_b64_tr_b16 v[120:121], v12 offset:160
  s_add_u32 m0, s57, 98304
  v_mfma_f32_16x16x32_bf16 v[56:59], v[140:143], v[160:163], v[56:59]
  buffer_load_dwordx4 v168, s[4:7], s50 offen lds
  s_add_u32 s50, s50, s54
  ds_read_b64_tr_b16 v[122:123], v12 offset:7840
  v_mfma_f32_16x16x32_bf16 v[60:63], v[164:167], v[140:143], v[60:63]
  ds_read_b64_tr_b16 v[124:125], v12 offset:320
  v_mfma_f32_16x16x32_bf16 v[52:55], v[156:159], v[140:143], v[52:55]
  ds_read_b64_tr_b16 v[126:127], v12 offset:8000
  v_mfma_f32_16x16x32_bf16 v[48:51], v[152:155], v[140:143], v[48:51]
  ds_read_b64_tr_b16 v[128:129], v209 offset:0
  s_add_u32 m0, s58, 98304
  s_setprio 2
  v_mfma_f32_16x16x32_bf16 v[64:67], v[152:155], v[144:147], v[64:67]
  buffer_load_dwordx4 v168, s[4:7], s51 offen lds
  s_add_u32 s51, s51, s54
  ds_read_b64_tr_b16 v[130:131], v216 offset:0
  v_mfma_f32_16x16x32_bf16 v[68:71], v[156:159], v[144:147], v[68:71]
  ds_read_b128 v[104:107], v8 offset:4096
  v_mfma_f32_16x16x32_bf16 v[76:79], v[164:167], v[144:147], v[76:79]
  ds_read_b128 v[108:111], v8 offset:6144
  s_add_u32 m0, s59, 98304
  v_mfma_f32_16x16x32_bf16 v[72:75], v[144:147], v[160:163], v[72:75]
  buffer_load_dwordx4 v169, s[8:11], s52 offen lds
  ds_read_b128 v[112:115], v8 offset:8192
  v_mfma_f32_16x16x32_bf16 v[88:91], v[148:151], v[160:163], v[88:91]
  v_mfma_f32_16x16x32_bf16 v[92:95], v[164:167], v[148:151], v[92:95]
  v_mfma_f32_16x16x32_bf16 v[84:87], v[156:159], v[148:151], v[84:87]
  v_mfma_f32_16x16x32_bf16 v[80:83], v[152:155], v[148:151], v[80:83]
  s_waitcnt lgkmcnt(0)
  s_setprio 1
  v_mfma_f32_16x16x32_bf16 v[32:35], v[116:119], v[100:103], v[32:35]
  ds_read_b128 v[136:139], v9 offset:2048
  s_add_u32 m0, s60, 98304
  v_mfma_f32_16x16x32_bf16 v[36:39], v[120:123], v[100:103], v[36:39]
  buffer_load_dwordx4 v170, s[8:11], s52 offen lds
  ds_read_b64_tr_b16 v[152:153], v12 offset:15360
  v_mfma_f32_16x16x32_bf16 v[44:47], v[128:131], v[100:103], v[44:47]
  ds_read_b64_tr_b16 v[154:155], v12 offset:23040
  v_mfma_f32_16x16x32_bf16 v[40:43], v[100:103], v[124:127], v[40:43]
  ds_read_b64_tr_b16 v[156:157], v12 offset:15520
  s_add_u32 m0, s61, 98304
  v_mfma_f32_16x16x32_bf16 v[56:59], v[104:107], v[124:127], v[56:59]
  buffer_load_dwordx4 v171, s[8:11], s52 offen lds
  s_add_u32 s52, s52, s55
  ds_read_b64_tr_b16 v[158:159], v12 offset:23200
  v_mfma_f32_16x16x32_bf16 v[60:63], v[128:131], v[104:107], v[60:63]
  ds_read_b64_tr_b16 v[160:161], v12 offset:15680
  v_mfma_f32_16x16x32_bf16 v[52:55], v[120:123], v[104:107], v[52:55]
  ds_read_b64_tr_b16 v[162:163], v12 offset:23360
  v_mfma_f32_16x16x32_bf16 v[48:51], v[116:119], v[104:107], v[48:51]
  ds_read_b64_tr_b16 v[164:165], v217 offset:0
  s_add_u32 m0, s62, 98304
  s_setprio 0
  v_mfma_f32_16x16x32_bf16 v[64:67], v[116:119], v[108:111], v[64:67]
  buffer_load_dwordx4 v172, s[12:15], s53 offen lds
  s_add_u32 s53, s53, s56
  ds_read_b64_tr_b16 v[166:167], v218 offset:0
  v_mfma_f32_16x16x32_bf16 v[68:71], v[120:123], v[108:111], v[68:71]
  ds_read_b128 v[140:143], v9 offset:4096
  v_mfma_f32_16x16x32_bf16 v[76:79], v[128:131], v[108:111], v[76:79]
  ds_read_b128 v[144:147], v9 offset:6144
  v_mfma_f32_16x16x32_bf16 v[72:75], v[108:111], v[124:127], v[72:75]
  ds_read_b128 v[148:151], v9 offset:8192
  v_mfma_f32_16x16x32_bf16 v[88:91], v[112:115], v[124:127], v[88:91]
  v_mfma_f32_16x16x32_bf16 v[92:95], v[128:131], v[112:115], v[92:95]
  v_mfma_f32_16x16x32_bf16 v[84:87], v[120:123], v[112:115], v[84:87]
  v_mfma_f32_16x16x32_bf16 v[80:83], v[116:119], v[112:115], v[80:83]
  s_waitcnt vmcnt(7) lgkmcnt(0)
  s_barrier
  s_setprio 3
  v_mfma_f32_16x16x32_bf16 v[32:35], v[152:155], v[136:139], v[32:35]
  ds_read_b128 v[100:103], v8 offset:51200
  s_add_u32 m0, s57, 0
  v_mfma_f32_16x16x32_bf16 v[36:39], v[156:159], v[136:139], v[36:39]
  buffer_load_dwordx4 v168, s[4:7], s50 offen lds
  ds_read_b64_tr_b16 v[116:117], v12 offset:49152
  v_mfma_f32_16x16x32_bf16 v[44:47], v[164:167], v[136:139], v[44:47]
  ds_read_b64_tr_b16 v[118:119], v12 offset:56832
  v_mfma_f32_16x16x32_bf16 v[40:43], v[136:139], v[160:163], v[40:43]
  ds_read_b64_tr_b16 v[120:121], v12 offset:49312
  v_mfma_f32_16x16x32_bf16 v[56:59], v[140:143], v[160:163], v[56:59]
  ds_read_b64_tr_b16 v[122:123], v12 offset:56992
  s_add_u32 m0, s58, 0
  v_mfma_f32_16x16x32_bf16 v[60:63], v[164:167], v[140:143], v[60:63]
  buffer_load_dwordx4 v168, s[4:7], s51 offen lds
  ds_read_b64_tr_b16 v[124:125], v12 offset:49472
  v_mfma_f32_16x16x32_bf16 v[52:55], v[156:159], v[140:143], v[52:55]
  ds_read_b64_tr_b16 v[126:127], v12 offset:57152
  v_mfma_f32_16x16x32_bf16 v[48:51], v[152:155], v[140:143], v[48:51]
  ds_read_b64_tr_b16 v[128:129], v209 offset:49152
  s_setprio 2
  v_mfma_f32_16x16x32_bf16 v[64:67], v[152:155], v[144:147], v[64:67]
  ds_read_b64_tr_b16 v[130:131], v216 offset:49152
  v_mfma_f32_16x16x32_bf16 v[68:71], v[156:159], v[144:147], v[68:71]
  ds_read_b128 v[104:107], v8 offset:53248
  s_add_u32 m0, s59, 0
  v_mfma_f32_16x16x32_bf16 v[76:79], v[164:167], v[144:147], v[76:79]
  buffer_load_dwordx4 v169, s[8:11], s52 offen lds
  ds_read_b128 v[108:111], v8 offset:55296
  v_mfma_f32_16x16x32_bf16 v[72:75], v[144:147], v[160:163], v[72:75]
  ds_read_b128 v[112:115], v8 offset:57344
  v_mfma_f32_16x16x32_bf16 v[88:91], v[148:151], v[160:163], v[88:91]
  v_mfma_f32_16x16x32_bf16 v[92:95], v[164:167], v[148:151], v[92:95]
  v_mfma_f32_16x16x32_bf16 v[84:87], v[156:159], v[148:151], v[84:87]
  v_mfma_f32_16x16x32_bf16 v[80:83], v[152:155], v[148:151], v[80:83]
  s_waitcnt lgkmcnt(0)
  s_setprio 1
  v_mfma_f32_16x16x32_bf16 v[32:35], v[116:119], v[100:103], v[32:35]
  ds_read_b128 v[136:139], v9 offset:51200
  s_add_u32 m0, s60, 0
  v_mfma_f32_16x16x32_bf16 v[36:39], v[120:123], v[100:103], v[36:39]
  buffer_load_dwordx4 v170, s[8:11], s52 offen lds
  ds_read_b64_tr_b16 v[152:153], v12 offset:64512
  v_mfma_f32_16x16x32_bf16 v[44:47], v[128:131], v[100:103], v[44:47]
  ds_read_b64_tr_b16 v[154:155], v13 offset:6656
  v_mfma_f32_16x16x32_bf16 v[40:43], v[100:103], v[124:127], v[40:43]
  ds_read_b64_tr_b16 v[156:157], v12 offset:64672
  s_add_u32 m0, s61, 0
  v_mfma_f32_16x16x32_bf16 v[56:59], v[104:107], v[124:127], v[56:59]
  buffer_load_dwordx4 v171, s[8:11], s52 offen lds
  ds_read_b64_tr_b16 v[158:159], v13 offset:6816
  v_mfma_f32_16x16x32_bf16 v[60:63], v[128:131], v[104:107], v[60:63]
  ds_read_b64_tr_b16 v[160:161], v12 offset:64832
  v_mfma_f32_16x16x32_bf16 v[52:55], v[120:123], v[104:107], v[52:55]
  ds_read_b64_tr_b16 v[162:163], v13 offset:6976
  v_mfma_f32_16x16x32_bf16 v[48:51], v[116:119], v[104:107], v[48:51]
  ds_read_b64_tr_b16 v[164:165], v217 offset:49152
  s_add_u32 m0, s62, 0
  s_setprio 0
  v_mfma_f32_16x16x32_bf16 v[64:67], v[116:119], v[108:111], v[64:67]
  buffer_load_dwordx4 v172, s[12:15], s53 offen lds
  ds_read_b64_tr_b16 v[166:167], v218 offset:49152
  v_mfma_f32_16x16x32_bf16 v[68:71], v[120:123], v[108:111], v[68:71]
  ds_read_b128 v[140:143], v9 offset:53248
  v_mfma_f32_16x16x32_bf16 v[76:79], v[128:131], v[108:111], v[76:79]
  ds_read_b128 v[144:147], v9 offset:55296
  v_mfma_f32_16x16x32_bf16 v[72:75], v[108:111], v[124:127], v[72:75]
  ds_read_b128 v[148:151], v9 offset:57344
  v_mfma_f32_16x16x32_bf16 v[88:91], v[112:115], v[124:127], v[88:91]
  v_mfma_f32_16x16x32_bf16 v[92:95], v[128:131], v[112:115], v[92:95]
  v_mfma_f32_16x16x32_bf16 v[84:87], v[120:123], v[112:115], v[84:87]
  v_mfma_f32_16x16x32_bf16 v[80:83], v[116:119], v[112:115], v[80:83]
  s_waitcnt vmcnt(6) lgkmcnt(0)
  s_barrier
  s_setprio 3
  v_mfma_f32_16x16x32_bf16 v[32:35], v[152:155], v[136:139], v[32:35]
  ds_read_b128 v[100:103], v10 offset:34816
  s_waitcnt vmcnt(12)
  v_cmp_ne_u32 vcc, s70, v227
  v_cmp_ne_u32 s[88:89], s70, v229
  s_nop 1
  s_or_b64 vcc, vcc, s[88:89]
  s_cbranch_vccnz L_slow_15
L_back_16:
  s_add_u32 m0, s74, 49152
  s_add_u32 s86, s71, 40960
  v_mfma_f32_16x16x32_bf16 v[36:39], v[156:159], v[136:139], v[36:39]
  buffer_load_dwordx4 v3, s[40:43], s86 offen lds
  ds_read_b64_tr_b16 v[116:117], v13 offset:32768
  ds_write_b32 v224, v228
  v_fmac_f32 v226, v225, v228
  v_mfma_f32_16x16x32_bf16 v[44:47], v[164:167], v[136:139], v[44:47]
  ds_read_b64_tr_b16 v[118:119], v13 offset:40448
  ds_write_b32 v223, v226
  v_mfma_f32_16x16x32_bf16 v[40:43], v[136:139], v[160:163], v[40:43]
  ds_read_b64_tr_b16 v[120:121], v13 offset:32928
  v_mfma_f32_16x16x32_bf16 v[56:59], v[140:143], v[160:163], v[56:59]
  ds_read_b64_tr_b16 v[122:123], v13 offset:40608
  s_add_u32 m0, s74, 50176
  s_add_u32 s86, s71, 102400
  v_mfma_f32_16x16x32_bf16 v[60:63], v[164:167], v[140:143], v[60:63]
  buffer_load_dwordx4 v3, s[40:43], s86 offen lds
  ds_read_b64_tr_b16 v[124:125], v13 offset:33088
  v_mfma_f32_16x16x32_bf16 v[52:55], v[156:159], v[140:143], v[52:55]
  ds_read_b64_tr_b16 v[126:127], v13 offset:40768
  v_mfma_f32_16x16x32_bf16 v[48:51], v[152:155], v[140:143], v[48:51]
  ds_read_b64_tr_b16 v[128:129], v219 offset:32768
  s_setprio 2
  v_mfma_f32_16x16x32_bf16 v[64:67], v[152:155], v[144:147], v[64:67]
  ds_read_b64_tr_b16 v[130:131], v220 offset:32768
  v_mfma_f32_16x16x32_bf16 v[68:71], v[156:159], v[144:147], v[68:71]
  ds_read_b128 v[104:107], v10 offset:36864
  s_add_u32 m0, s74, 65536
  s_add_u32 s86, s71, 51200
  v_mfma_f32_16x16x32_bf16 v[76:79], v[164:167], v[144:147], v[76:79]
  buffer_load_dwordx4 v3, s[40:43], s86 offen lds
  ds_read_b128 v[108:111], v10 offset:38912
  v_mfma_f32_16x16x32_bf16 v[72:75], v[144:147], v[160:163], v[72:75]
  ds_read_b128 v[112:115], v10 offset:40960
  v_mfma_f32_16x16x32_bf16 v[88:91], v[148:151], v[160:163], v[88:91]
  v_mfma_f32_16x16x32_bf16 v[92:95], v[164:167], v[148:151], v[92:95]
  v_mfma_f32_16x16x32_bf16 v[84:87], v[156:159], v[148:151], v[84:87]
  v_mfma_f32_16x16x32_bf16 v[80:83], v[152:155], v[148:151], v[80:83]
  s_waitcnt lgkmcnt(0)
  s_setprio 1
  v_mfma_f32_16x16x32_bf16 v[32:35], v[116:119], v[100:103], v[32:35]
  ds_read_b128 v[136:139], v11 offset:34816
  s_add_u32 m0, s74, 66560
  s_add_u32 s86, s71, 112640
  v_mfma_f32_16x16x32_bf16 v[36:39], v[120:123], v[100:103], v[36:39]
  buffer_load_dwordx4 v3, s[40:43], s86 offen lds
  ds_read_b64_tr_b16 v[152:153], v13 offset:48128
  v_mfma_f32_16x16x32_bf16 v[44:47], v[128:131], v[100:103], v[44:47]
  ds_read_b64_tr_b16 v[154:155], v13 offset:55808
  v_mfma_f32_16x16x32_bf16 v[40:43], v[100:103], v[124:127], v[40:43]
  ds_read_b64_tr_b16 v[156:157], v13 offset:48288
  s_add_u32 m0, s74, 81920
  s_add_u32 s86, s71, 163840
  v_mfma_f32_16x16x32_bf16 v[56:59], v[104:107], v[124:127], v[56:59]
  buffer_load_dwordx4 v3, s[40:43], s86 offen lds
  ds_read_b64_tr_b16 v[158:159], v13 offset:55968
  v_mfma_f32_16x16x32_bf16 v[60:63], v[128:131], v[104:107], v[60:63]
  ds_read_b64_tr_b16 v[160:161], v13 offset:48448
  v_mfma_f32_16x16x32_bf16 v[52:55], v[120:123], v[104:107], v[52:55]
  ds_read_b64_tr_b16 v[162:163], v13 offset:56128
  v_mfma_f32_16x16x32_bf16 v[48:51], v[116:119], v[104:107], v[48:51]
  ds_read_b64_tr_b16 v[164:165], v230 offset:32768
  s_add_u32 m0, s74, 82944
  s_add_u32 s86, s71, 225280
  s_setprio 0
  v_mfma_f32_16x16x32_bf16 v[64:67], v[116:119], v[108:111], v[64:67]
  buffer_load_dwordx4 v3, s[40:43], s86 offen lds
  ds_read_b64_tr_b16 v[166:167], v231 offset:32768
  v_mfma_f32_16x16x32_bf16 v[68:71], v[120:123], v[108:111], v[68:71]
  ds_read_b128 v[140:143], v11 offset:36864
  v_mfma_f32_16x16x32_bf16 v[76:79], v[128:131], v[108:111], v[76:79]
  ds_read_b128 v[144:147], v11 offset:38912
  v_mfma_f32_16x16x32_bf16 v[72:75], v[108:111], v[124:127], v[72:75]
  ds_read_b128 v[148:151], v11 offset:40960
  v_mfma_f32_16x16x32_bf16 v[88:91], v[112:115], v[124:127], v[88:91]
  v_mfma_f32_16x16x32_bf16 v[92:95], v[128:131], v[112:115], v[92:95]
  v_mfma_f32_16x16x32_bf16 v[84:87], v[120:123], v[112:115], v[84:87]
  v_mfma_f32_16x16x32_bf16 v[80:83], v[116:119], v[112:115], v[80:83]
  s_waitcnt vmcnt(6) lgkmcnt(0)
  s_barrier
  s_setprio 3
  v_mfma_f32_16x16x32_bf16 v[32:35], v[152:155], v[136:139], v[32:35]
  ds_read_b128 v[100:103], v8 offset:2048
  s_add_u32 m0, s74, 98304
  s_add_u32 s86, s71, 174080
  v_mfma_f32_16x16x32_bf16 v[36:39], v[156:159], v[136:139], v[36:39]
  buffer_load_dwordx4 v3, s[40:43], s86 offen lds
  ds_read_b64_tr_b16 v[116:117], v12 offset:0
  v_mfma_f32_16x16x32_bf16 v[44:47], v[164:167], v[136:139], v[44:47]
  ds_read_b64_tr_b16 v[118:119], v12 offset:7680
  v_mfma_f32_16x16x32_bf16 v[40:43], v[136:139], v[160:163], v[40:43]
  ds_read_b64_tr_b16 v[120:121], v12 offset:160
  v_mfma_f32_16x16x32_bf16 v[56:59], v[140:143], v[160:163], v[56:59]
  ds_read_b64_tr_b16 v[122:123], v12 offset:7840
  s_add_u32 m0, s74, 99328
  s_add_u32 s86, s71, 235520
  v_mfma_f32_16x16x32_bf16 v[60:63], v[164:167], v[140:143], v[60:63]
  buffer_load_dwordx4 v3, s[40:43], s86 offen lds
  ds_read_b64_tr_b16 v[124:125], v12 offset:320
  v_mfma_f32_16x16x32_bf16 v[52:55], v[156:159], v[140:143], v[52:55]
  ds_read_b64_tr_b16 v[126:127], v12 offset:8000
  v_mfma_f32_16x16x32_bf16 v[48:51], v[152:155], v[140:143], v[48:51]
  ds_read_b64_tr_b16 v[128:129], v209 offset:0
  s_setprio 2
  v_mfma_f32_16x16x32_bf16 v[64:67], v[152:155], v[144:147], v[64:67]
  ds_read_b64_tr_b16 v[130:131], v216 offset:0
  v_mfma_f32_16x16x32_bf16 v[68:71], v[156:159], v[144:147], v[68:71]
  ds_read_b128 v[104:107], v8 offset:4096
  s_add_u32 m0, s74, 114688
  s_add_u32 s86, s71, 0
  v_mfma_f32_16x16x32_bf16 v[76:79], v[164:167], v[144:147], v[76:79]
  buffer_load_dwordx4 v3, s[40:43], s86 offen lds
  ds_read_b128 v[108:111], v8 offset:6144
  v_mfma_f32_16x16x32_bf16 v[72:75], v[144:147], v[160:163], v[72:75]
  ds_read_b128 v[112:115], v8 offset:8192
  v_mfma_f32_16x16x32_bf16 v[88:91], v[148:151], v[160:163], v[88:91]
  v_mfma_f32_16x16x32_bf16 v[92:95], v[164:167], v[148:151], v[92:95]
  v_mfma_f32_16x16x32_bf16 v[84:87], v[156:159], v[148:151], v[84:87]
  v_mfma_f32_16x16x32_bf16 v[80:83], v[152:155], v[148:151], v[80:83]
  s_waitcnt lgkmcnt(0)
  s_setprio 1
  v_mfma_f32_16x16x32_bf16 v[32:35], v[116:119], v[100:103], v[32:35]
  ds_read_b128 v[136:139], v9 offset:2048
  s_add_u32 m0, s74, 115712
  s_add_u32 s86, s71, 10240
  v_mfma_f32_16x16x32_bf16 v[36:39], v[120:123], v[100:103], v[36:39]
  buffer_load_dwordx4 v3, s[40:43], s86 offen lds
  ds_read_b64_tr_b16 v[152:153], v12 offset:15360
  v_mfma_f32_16x16x32_bf16 v[44:47], v[128:131], v[100:103], v[44:47]
  ds_read_b64_tr_b16 v[154:155], v12 offset:23040
  v_mfma_f32_16x16x32_bf16 v[40:43], v[100:103], v[124:127], v[40:43]
  ds_read_b64_tr_b16 v[156:157], v12 offset:15520
  s_add_u32 m0, s74, 131072
  s_add_u32 s86, s71, 20480
  v_mfma_f32_16x16x32_bf16 v[56:59], v[104:107], v[124:127], v[56:59]
  buffer_load_dwordx4 v3, s[40:43], s86 offen lds
  ds_read_b64_tr_b16 v[158:159], v12 offset:23200
  v_mfma_f32_16x16x32_bf16 v[60:63], v[128:131], v[104:107], v[60:63]
  ds_read_b64_tr_b16 v[160:161], v12 offset:15680
  v_mfma_f32_16x16x32_bf16 v[52:55], v[120:123], v[104:107], v[52:55]
  ds_read_b64_tr_b16 v[162:163], v12 offset:23360
  v_mfma_f32_16x16x32_bf16 v[48:51], v[116:119], v[104:107], v[48:51]
  ds_read_b64_tr_b16 v[164:165], v217 offset:0
  s_add_u32 m0, s74, 132096
  s_add_u32 s86, s71, 30720
  s_setprio 0
  v_mfma_f32_16x16x32_bf16 v[64:67], v[116:119], v[108:111], v[64:67]
  buffer_load_dwordx4 v3, s[40:43], s86 offen lds
  ds_read_b64_tr_b16 v[166:167], v218 offset:0
  v_mfma_f32_16x16x32_bf16 v[68:71], v[120:123], v[108:111], v[68:71]
  ds_read_b128 v[140:143], v9 offset:4096
  v_mfma_f32_16x16x32_bf16 v[76:79], v[128:131], v[108:111], v[76:79]
  ds_read_b128 v[144:147], v9 offset:6144
  v_mfma_f32_16x16x32_bf16 v[72:75], v[108:111], v[124:127], v[72:75]
  ds_read_b128 v[148:151], v9 offset:8192
  v_mfma_f32_16x16x32_bf16 v[88:91], v[112:115], v[124:127], v[88:91]
  v_mfma_f32_16x16x32_bf16 v[92:95], v[128:131], v[112:115], v[92:95]
  v_mfma_f32_16x16x32_bf16 v[84:87], v[120:123], v[112:115], v[84:87]
  v_mfma_f32_16x16x32_bf16 v[80:83], v[116:119], v[112:115], v[80:83]
  s_waitcnt lgkmcnt(0)
  s_barrier
  s_setprio 1
  v_mfma_f32_16x16x32_bf16 v[32:35], v[152:155], v[136:139], v[32:35]
  s_lshl_b32 s86, s67, 8
  s_add_u32 s86, s86, 148736
  v_lshl_add_u32 v14, v5, 4, s86
  v_lshl_add_u32 v15, v6, 2, s86
  s_add_u32 m0, s74, 0
  s_add_u32 s86, s71, 61440
  v_mfma_f32_16x16x32_bf16 v[36:39], v[156:159], v[136:139], v[36:39]
  buffer_load_dwordx4 v3, s[40:43], s86 offen lds
  ds_read_b128 v[106:109], v14
  ds_read_b128 v[110:113], v14 offset:64
  v_mfma_f32_16x16x32_bf16 v[44:47], v[164:167], v[136:139], v[44:47]
  ds_read_b128 v[114:117], v14 offset:192
  ds_read_b32 v118, v15 offset:128
  v_mfma_f32_16x16x32_bf16 v[40:43], v[136:139], v[160:163], v[40:43]
  s_lshl_b32 s86, s66, 8
  s_add_u32 s86, s86, 147456
  v_lshl_add_u32 v14, v6, 2, s86
  v_lshl_add_u32 v15, v5, 4, s86
  s_add_u32 m0, s74, 1024
  s_add_u32 s86, s71, 71680
  v_mfma_f32_16x16x32_bf16 v[56:59], v[140:143], v[160:163], v[56:59]
  buffer_load_dwordx4 v3, s[40:43], s86 offen lds
  ds_read2_b32 v[96:97], v14 offset0:0 offset1:160
  ds_read2_b32 v[98:99], v14 offset0:16 offset1:176
  v_mfma_f32_16x16x32_bf16 v[60:63], v[164:167], v[140:143], v[60:63]
  ds_read2_b32 v[100:101], v14 offset0:32 offset1:192
  ds_read2_b32 v[102:103], v14 offset0:48 offset1:208
  v_mfma_f32_16x16x32_bf16 v[52:55], v[156:159], v[140:143], v[52:55]
  ds_read2_b32 v[104:105], v14 offset0:64 offset1:224
  ds_read_b128 v[120:123], v15 offset:64
  v_mfma_f32_16x16x32_bf16 v[48:51], v[152:155], v[140:143], v[48:51]
  ds_read_b128 v[124:127], v15 offset:704
  s_add_u32 m0, s74, 16384
  s_add_u32 s86, s71, 81920
  s_setprio 0
  v_mfma_f32_16x16x32_bf16 v[64:67], v[152:155], v[144:147], v[64:67]
  buffer_load_dwordx4 v3, s[40:43], s86 offen lds
  v_mfma_f32_16x16x32_bf16 v[68:71], v[156:159], v[144:147], v[68:71]
  v_mfma_f32_16x16x32_bf16 v[76:79], v[164:167], v[144:147], v[76:79]
  s_add_u32 m0, s74, 17408
  s_add_u32 s86, s71, 92160
  v_mfma_f32_16x16x32_bf16 v[72:75], v[144:147], v[160:163], v[72:75]
  buffer_load_dwordx4 v3, s[40:43], s86 offen lds
  v_mfma_f32_16x16x32_bf16 v[88:91], v[148:151], v[160:163], v[88:91]
  v_mfma_f32_16x16x32_bf16 v[92:95], v[164:167], v[148:151], v[92:95]
  v_mfma_f32_16x16x32_bf16 v[84:87], v[156:159], v[148:151], v[84:87]
  v_mfma_f32_16x16x32_bf16 v[80:83], v[152:155], v[148:151], v[80:83]
  s_barrier
  s_mul_i32 s86, s67, 3072
  s_add_u32 s86, s86, 32768
  v_add_u32 v13, s86, v2
  ds_read_b128 v[20:23], v13 offset:0
  ds_read_b128 v[24:27], v13 offset:1024
  ds_read_b128 v[28:31], v13 offset:2048
L_aepi:
  s_mul_i32 s81, s63, 1360
  s_add_u32 s81, s81, 151808
  v_lshlrev_b32 v174, 6, v5
  v_lshl_add_u32 v174, v6, 3, v174
  v_add_u32 v175, 149760, v174
  v_add_u32 v174, s81, v174
  s_mov_b32 s88, 0xffff
  s_mov_b32 s89, 0xffff
  v_cndmask_b32 v174, v175, v174, s[88:89]
  v_lshl_add_u32 v175, v6, 3, s81
  s_add_u32 s81, s81, 256
  v_add_u32 v8, 49152, v7
  v_xor_b32 v9, 32, v8
  v_mov_b32 v255, s81
  s_mov_b32 s88, 0xffff0000
  v_xor_b32 v10, 64, v8
  v_xor_b32 v11, 0x60, v8
  s_mov_b32 s89, 0
  v_cndmask_b32 v175, v255, v175, s[88:89]
  s_setprio 3
  s_waitcnt vmcnt(14)
  ds_read_b64_tr_b16 v[176:177], v8 offset:0
  ds_read_b128 v[132:135], v15 offset:128
  ds_read_b128 v[136:139], v15 offset:768
  ds_read_b64_tr_b16 v[180:181], v9 offset:0
  s_waitcnt lgkmcnt(4)
  v_pk_fma_f32 v[44:45], v[98:99], v[114:115], v[44:45] op_sel:[0,0,0] op_sel_hi:[0,1,1]
  v_pk_fma_f32 v[46:47], v[98:99], v[116:117], v[46:47] op_sel:[0,0,0] op_sel_hi:[0,1,1]
  ds_read_b64_tr_b16 v[184:185], v10 offset:0
  v_pk_mul_f32 v[44:45], v[98:99], v[44:45] op_sel:[1,0] op_sel_hi:[1,1]
  v_pk_mul_f32 v[46:47], v[98:99], v[46:47] op_sel:[1,0] op_sel_hi:[1,1]
  ds_read_b64_tr_b16 v[188:189], v11 offset:0
  v_pk_fma_f32 v[36:37], v[98:99], v[110:111], v[36:37] op_sel:[0,0,0] op_sel_hi:[0,1,1]
  v_pk_fma_f32 v[38:39], v[98:99], v[112:113], v[38:39] op_sel:[0,0,0] op_sel_hi:[0,1,1]
  v_pk_mul_f32 v[36:37], v[98:99], v[36:37] op_sel:[1,0] op_sel_hi:[1,1]
  s_waitcnt vmcnt(12)
  ds_read_b64_tr_b16 v[178:179], v8 offset:16384
  v_pk_mul_f32 v[38:39], v[98:99], v[38:39] op_sel:[1,0] op_sel_hi:[1,1]
  v_pk_fma_f32 v[32:33], v[98:99], v[106:107], v[32:33] op_sel:[0,0,0] op_sel_hi:[0,1,1]
  ds_read_b64_tr_b16 v[182:183], v9 offset:16384
  v_pk_fma_f32 v[34:35], v[98:99], v[108:109], v[34:35] op_sel:[0,0,0] op_sel_hi:[0,1,1]
  v_pk_mul_f32 v[32:33], v[98:99], v[32:33] op_sel:[1,0] op_sel_hi:[1,1]
  v_pk_mul_f32 v[34:35], v[98:99], v[34:35] op_sel:[1,0] op_sel_hi:[1,1]
  ds_read_b64_tr_b16 v[186:187], v10 offset:16384
  v_cvt_pk_bf16_f32 v36, v36, v37
  v_cvt_pk_bf16_f32 v37, v38, v39
  v_cvt_pk_bf16_f32 v38, v44, v45
  ds_read_b64_tr_b16 v[190:191], v11 offset:16384
  v_cvt_pk_bf16_f32 v39, v46, v47
  ds_write_b64 v174, v[38:39] offset:272
  s_waitcnt vmcnt(10)
  ds_read_b64_tr_b16 v[192:193], v8 offset:32768
  v_cvt_pk_bf16_f32 v32, v32, v33
  v_cvt_pk_bf16_f32 v33, v34, v35
  ds_read_b64 v[34:35], v175 offset:272
  ds_read_b64_tr_b16 v[196:197], v9 offset:32768
  v_pk_fma_f32 v[40:41], v[120:121], v[118:119], v[40:41] op_sel:[0,0,0] op_sel_hi:[1,0,1]
  v_pk_fma_f32 v[42:43], v[122:123], v[118:119], v[42:43] op_sel:[0,0,0] op_sel_hi:[1,0,1]
  ds_read_b64_tr_b16 v[200:201], v10 offset:32768
  v_pk_mul_f32 v[40:41], v[124:125], v[40:41] op_sel:[0,0] op_sel_hi:[1,1]
  v_pk_mul_f32 v[42:43], v[126:127], v[42:43] op_sel:[0,0] op_sel_hi:[1,1]
  v_cvt_pk_bf16_f32 v166, v40, v41
  ds_read_b64_tr_b16 v[204:205], v11 offset:32768
  v_cvt_pk_bf16_f32 v167, v42, v43
  ds_read_b128 v[140:143], v15 offset:192
  s_waitcnt lgkmcnt(11)
  s_add_u32 m0, s74, 49152
  s_add_u32 s86, s71, 122880
  buffer_load_dwordx4 v3, s[40:43], s86 offen lds
  ds_read_b128 v[144:147], v15 offset:832
  s_waitcnt lgkmcnt(14)
  v_pk_fma_f32 v[60:61], v[100:101], v[114:115], v[60:61] op_sel:[0,0,0] op_sel_hi:[0,1,1]
  v_pk_fma_f32 v[62:63], v[100:101], v[116:117], v[62:63] op_sel:[0,0,0] op_sel_hi:[0,1,1]
  v_pk_mul_f32 v[60:61], v[100:101], v[60:61] op_sel:[1,0] op_sel_hi:[1,1]
  v_pk_mul_f32 v[62:63], v[100:101], v[62:63] op_sel:[1,0] op_sel_hi:[1,1]
  v_pk_fma_f32 v[52:53], v[100:101], v[110:111], v[52:53] op_sel:[0,0,0] op_sel_hi:[0,1,1]
  v_pk_fma_f32 v[54:55], v[100:101], v[112:113], v[54:55] op_sel:[0,0,0] op_sel_hi:[0,1,1]
  v_pk_mul_f32 v[52:53], v[100:101], v[52:53] op_sel:[1,0] op_sel_hi:[1,1]
  v_pk_mul_f32 v[54:55], v[100:101], v[54:55] op_sel:[1,0] op_sel_hi:[1,1]
  v_pk_fma_f32 v[48:49], v[100:101], v[106:107], v[48:49] op_sel:[0,0,0] op_sel_hi:[0,1,1]
  s_add_u32 m0, s74, 50176
  s_add_u32 s86, s71, 133120
  buffer_load_dwordx4 v3, s[40:43], s86 offen lds
  v_pk_fma_f32 v[50:51], v[100:101], v[108:109], v[50:51] op_sel:[0,0,0] op_sel_hi:[0,1,1]
  v_pk_mul_f32 v[48:49], v[100:101], v[48:49] op_sel:[1,0] op_sel_hi:[1,1]
  v_pk_mul_f32 v[50:51], v[100:101], v[50:51] op_sel:[1,0] op_sel_hi:[1,1]
  v_cvt_pk_bf16_f32 v52, v52, v53
  v_cvt_pk_bf16_f32 v53, v54, v55
  v_cvt_pk_bf16_f32 v54, v60, v61
  v_cvt_pk_bf16_f32 v55, v62, v63
  ds_write_b64 v174, v[54:55] offset:544
  v_cvt_pk_bf16_f32 v48, v48, v49
  v_cvt_pk_bf16_f32 v49, v50, v51
  s_waitcnt lgkmcnt(9)
  s_add_u32 m0, s74, 65536
  s_add_u32 s86, s71, 143360
  buffer_load_dwordx4 v3, s[40:43], s86 offen lds
  ds_read_b64 v[50:51], v175 offset:544
  v_pk_fma_f32 v[56:57], v[132:133], v[118:119], v[56:57] op_sel:[0,0,0] op_sel_hi:[1,0,1]
  v_pk_fma_f32 v[58:59], v[134:135], v[118:119], v[58:59] op_sel:[0,0,0] op_sel_hi:[1,0,1]
  v_pk_mul_f32 v[56:57], v[136:137], v[56:57] op_sel:[0,0] op_sel_hi:[1,1]
  v_pk_mul_f32 v[58:59], v[138:139], v[58:59] op_sel:[0,0] op_sel_hi:[1,1]
  v_cvt_pk_bf16_f32 v168, v56, v57
  v_cvt_pk_bf16_f32 v169, v58, v59
  s_waitcnt lgkmcnt(7)
  v_mfma_f32_16x16x32_bf16 v[40:43], v[36:39], v[32:35], v[240:243]
  ds_read_b128 v[148:151], v15 offset:256
  s_add_u32 m0, s74, 66560
  s_add_u32 s86, s71, 153600
  buffer_load_dwordx4 v3, s[40:43], s86 offen lds
  ds_read_b128 v[152:155], v15 offset:896
  s_waitcnt lgkmcnt(4)
  v_pk_fma_f32 v[76:77], v[102:103], v[114:115], v[76:77] op_sel:[0,0,0] op_sel_hi:[0,1,1]
  v_pk_fma_f32 v[78:79], v[102:103], v[116:117], v[78:79] op_sel:[0,0,0] op_sel_hi:[0,1,1]
  v_pk_mul_f32 v[76:77], v[102:103], v[76:77] op_sel:[1,0] op_sel_hi:[1,1]
  v_pk_mul_f32 v[78:79], v[102:103], v[78:79] op_sel:[1,0] op_sel_hi:[1,1]
  v_pk_fma_f32 v[68:69], v[102:103], v[110:111], v[68:69] op_sel:[0,0,0] op_sel_hi:[0,1,1]
  v_pk_fma_f32 v[70:71], v[102:103], v[112:113], v[70:71] op_sel:[0,0,0] op_sel_hi:[0,1,1]
  v_pk_mul_f32 v[68:69], v[102:103], v[68:69] op_sel:[1,0] op_sel_hi:[1,1]
  v_pk_mul_f32 v[70:71], v[102:103], v[70:71] op_sel:[1,0] op_sel_hi:[1,1]
  v_pk_fma_f32 v[64:65], v[102:103], v[106:107], v[64:65] op_sel:[0,0,0] op_sel_hi:[0,1,1]
  s_waitcnt lgkmcnt(6)
  s_add_u32 m0, s74, 81920
  s_add_u32 s86, s71, 184320
  buffer_load_dwordx4 v3, s[40:43], s86 offen lds
  v_pk_fma_f32 v[66:67], v[102:103], v[108:109], v[66:67] op_sel:[0,0,0] op_sel_hi:[0,1,1]
  v_pk_mul_f32 v[64:65], v[102:103], v[64:65] op_sel:[1,0] op_sel_hi:[1,1]
  v_pk_mul_f32 v[66:67], v[102:103], v[66:67] op_sel:[1,0] op_sel_hi:[1,1]
  v_cvt_pk_bf16_f32 v68, v68, v69
  v_cvt_pk_bf16_f32 v69, v70, v71
  v_cvt_pk_bf16_f32 v70, v76, v77
  v_cvt_pk_bf16_f32 v71, v78, v79
  ds_write_b64 v174, v[70:71] offset:816
  v_cvt_pk_bf16_f32 v64, v64, v65
  v_cvt_pk_bf16_f32 v65, v66, v67
  s_add_u32 m0, s74, 82944
  s_add_u32 s86, s71, 194560
  buffer_load_dwordx4 v3, s[40:43], s86 offen lds
  ds_read_b64 v[66:67], v175 offset:816
  v_pk_fma_f32 v[72:73], v[140:141], v[118:119], v[72:73] op_sel:[0,0,0] op_sel_hi:[1,0,1]
  v_pk_fma_f32 v[74:75], v[142:143], v[118:119], v[74:75] op_sel:[0,0,0] op_sel_hi:[1,0,1]
  v_pk_mul_f32 v[72:73], v[144:145], v[72:73] op_sel:[0,0] op_sel_hi:[1,1]
  v_pk_mul_f32 v[74:75], v[146:147], v[74:75] op_sel:[0,0] op_sel_hi:[1,1]
  v_cvt_pk_bf16_f32 v170, v72, v73
  v_cvt_pk_bf16_f32 v171, v74, v75
  s_waitcnt lgkmcnt(4)
  v_mfma_f32_16x16x32_bf16 v[56:59], v[52:55], v[48:51], v[240:243]
  v_mfma_f32_16x16x32_bf16 v[60:63], v[36:39], v[48:51], v[244:247]
  v_add_u32 v8, 98304, v7
  v_xor_b32 v9, 32, v8
  ds_read_b128 v[156:159], v15 offset:0
  ds_read_b128 v[160:163], v15 offset:640
  s_waitcnt lgkmcnt(4)
  v_xor_b32 v10, 64, v8
  v_xor_b32 v11, 0x60, v8
  v_pk_fma_f32 v[92:93], v[104:105], v[114:115], v[92:93] op_sel:[0,0,0] op_sel_hi:[0,1,1]
  v_pk_fma_f32 v[94:95], v[104:105], v[116:117], v[94:95] op_sel:[0,0,0] op_sel_hi:[0,1,1]
  s_waitcnt vmcnt(14)
  ds_read_b64_tr_b16 v[194:195], v8 offset:0
  v_pk_mul_f32 v[92:93], v[104:105], v[92:93] op_sel:[1,0] op_sel_hi:[1,1]
  v_pk_mul_f32 v[94:95], v[104:105], v[94:95] op_sel:[1,0] op_sel_hi:[1,1]
  v_pk_fma_f32 v[84:85], v[104:105], v[110:111], v[84:85] op_sel:[0,0,0] op_sel_hi:[0,1,1]
  ds_read_b64_tr_b16 v[198:199], v9 offset:0
  v_pk_fma_f32 v[86:87], v[104:105], v[112:113], v[86:87] op_sel:[0,0,0] op_sel_hi:[0,1,1]
  v_pk_mul_f32 v[84:85], v[104:105], v[84:85] op_sel:[1,0] op_sel_hi:[1,1]
  ds_read_b64_tr_b16 v[202:203], v10 offset:0
  v_pk_mul_f32 v[86:87], v[104:105], v[86:87] op_sel:[1,0] op_sel_hi:[1,1]
  v_pk_fma_f32 v[80:81], v[104:105], v[106:107], v[80:81] op_sel:[0,0,0] op_sel_hi:[0,1,1]
  v_pk_fma_f32 v[82:83], v[104:105], v[108:109], v[82:83] op_sel:[0,0,0] op_sel_hi:[0,1,1]
  ds_read_b64_tr_b16 v[206:207], v11 offset:0
  v_pk_mul_f32 v[80:81], v[104:105], v[80:81] op_sel:[1,0] op_sel_hi:[1,1]
  v_pk_mul_f32 v[82:83], v[104:105], v[82:83] op_sel:[1,0] op_sel_hi:[1,1]
  s_waitcnt vmcnt(12)
  ds_read_b64_tr_b16 v[208:209], v8 offset:16384
  v_cvt_pk_bf16_f32 v84, v84, v85
  v_cvt_pk_bf16_f32 v85, v86, v87
  v_cvt_pk_bf16_f32 v86, v92, v93
  ds_read_b64_tr_b16 v[212:213], v9 offset:16384
  v_cvt_pk_bf16_f32 v87, v94, v95
  ds_write_b64 v174, v[86:87] offset:1088
  v_cvt_pk_bf16_f32 v80, v80, v81
  ds_read_b64_tr_b16 v[216:217], v10 offset:16384
  v_cvt_pk_bf16_f32 v81, v82, v83
  ds_read_b64 v[82:83], v175 offset:1088
  ds_read_b64_tr_b16 v[220:221], v11 offset:16384
  v_pk_fma_f32 v[88:89], v[148:149], v[118:119], v[88:89] op_sel:[0,0,0] op_sel_hi:[1,0,1]
  v_pk_fma_f32 v[90:91], v[150:151], v[118:119], v[90:91] op_sel:[0,0,0] op_sel_hi:[1,0,1]
  v_pk_mul_f32 v[88:89], v[152:153], v[88:89] op_sel:[0,0] op_sel_hi:[1,1]
  s_waitcnt vmcnt(10)
  ds_read_b64_tr_b16 v[210:211], v8 offset:32768
  v_pk_mul_f32 v[90:91], v[154:155], v[90:91] op_sel:[0,0] op_sel_hi:[1,1]
  v_cvt_pk_bf16_f32 v172, v88, v89
  ds_read_b64_tr_b16 v[214:215], v9 offset:32768
  v_cvt_pk_bf16_f32 v173, v90, v91
  s_waitcnt lgkmcnt(14)
  v_mfma_f32_16x16x32_bf16 v[72:75], v[68:71], v[64:67], v[240:243]
  ds_read_b64_tr_b16 v[218:219], v10 offset:32768
  v_mfma_f32_16x16x32_bf16 v[76:79], v[52:55], v[64:67], v[244:247]
  s_waitcnt lgkmcnt(13)
  ds_read_b64_tr_b16 v[222:223], v11 offset:32768
  s_waitcnt lgkmcnt(14)
  v_pk_fma_f32 v[28:29], v[96:97], v[114:115], v[28:29] op_sel:[0,0,0] op_sel_hi:[0,1,1]
  v_pk_fma_f32 v[30:31], v[96:97], v[116:117], v[30:31] op_sel:[0,0,0] op_sel_hi:[0,1,1]
  s_waitcnt lgkmcnt(10)
  s_add_u32 m0, s74, 98304
  s_add_u32 s86, s71, 204800
  buffer_load_dwordx4 v3, s[40:43], s86 offen lds
  v_pk_mul_f32 v[28:29], v[96:97], v[28:29] op_sel:[1,0] op_sel_hi:[1,1]
  v_pk_mul_f32 v[30:31], v[96:97], v[30:31] op_sel:[1,0] op_sel_hi:[1,1]
  v_pk_fma_f32 v[20:21], v[96:97], v[110:111], v[20:21] op_sel:[0,0,0] op_sel_hi:[0,1,1]
  v_pk_fma_f32 v[22:23], v[96:97], v[112:113], v[22:23] op_sel:[0,0,0] op_sel_hi:[0,1,1]
  v_pk_mul_f32 v[20:21], v[96:97], v[20:21] op_sel:[1,0] op_sel_hi:[1,1]
  v_pk_mul_f32 v[22:23], v[96:97], v[22:23] op_sel:[1,0] op_sel_hi:[1,1]
  v_cvt_pk_bf16_f32 v20, v20, v21
  v_cvt_pk_bf16_f32 v21, v22, v23
  v_cvt_pk_bf16_f32 v22, v28, v29
  v_cvt_pk_bf16_f32 v23, v30, v31
  s_add_u32 m0, s74, 99328
  s_add_u32 s86, s71, 215040
  buffer_load_dwordx4 v3, s[40:43], s86 offen lds
  ds_write_b64 v174, v[22:23] offset:0
  v_pk_fma_f32 v[24:25], v[156:157], v[118:119], v[24:25] op_sel:[0,0,0] op_sel_hi:[1,0,1]
  v_pk_fma_f32 v[26:27], v[158:159], v[118:119], v[26:27] op_sel:[0,0,0] op_sel_hi:[1,0,1]
  v_pk_mul_f32 v[24:25], v[160:161], v[24:25] op_sel:[0,0] op_sel_hi:[1,1]
  v_pk_mul_f32 v[26:27], v[162:163], v[26:27] op_sel:[0,0] op_sel_hi:[1,1]
  v_cvt_pk_bf16_f32 v164, v24, v25
  v_cvt_pk_bf16_f32 v165, v26, v27
  s_waitcnt lgkmcnt(6)
  v_mfma_f32_16x16x32_bf16 v[88:91], v[84:87], v[80:83], v[240:243]
  v_mfma_f32_16x16x32_bf16 v[92:95], v[68:71], v[80:83], v[244:247]
  v_mfma_f32_16x16x32_bf16 v[44:47], v[20:23], v[32:35], v[248:251]
  s_setprio 2
  v_lshrrev_b32 v174, 2, v1
  v_lshlrev_b32 v174, 3, v174
  v_and_b32 v12, 1, v1
  v_mul_u32_u24 v12, 1, v12
  v_add_u32 v12, s75, v12
  v_and_b32 v12, 4, v12
  s_add_u32 s86, s69, s63
  v_lshl_add_u32 v12, v12, 1, s86
  v_lshlrev_b32 v12, 7, v12
  s_mov_b32 s87, 9437184
  buffer_load_dword v13, v12, s[16:19], s87 offen sc1
  v_add_u32 v174, s81, v174
  v_subrev_u32 v174, 0x80, v174
  s_mov_b32 s88, 0x11111111
  s_mov_b32 s89, 0x11111111
  v_cndmask_b32 v175, v255, v174, s[88:89]
  ds_read_b64_tr_b16 v[96:97], v175 offset:0
  ds_read_b64_tr_b16 v[98:99], v175 offset:272
  s_mov_b32 s88, 0x22222222
  s_mov_b32 s89, 0x22222222
  v_cndmask_b32 v175, v255, v174, s[88:89]
  v_add_u32 v8, 0, v7
  v_xor_b32 v9, 32, v8
  ds_read_b64_tr_b16 v[100:101], v175 offset:272
  ds_read_b64_tr_b16 v[102:103], v175 offset:544
  v_xor_b32 v10, 64, v8
  v_xor_b32 v11, 0x60, v8
  s_mov_b32 s88, 0x44444444
  s_mov_b32 s89, 0x44444444
  v_cndmask_b32 v175, v255, v174, s[88:89]
  s_waitcnt vmcnt(11)
  ds_read_b64_tr_b16 v[224:225], v8 offset:0
  ds_read_b64_tr_b16 v[104:105], v175 offset:544
  ds_read_b64_tr_b16 v[106:107], v175 offset:816
  ds_read_b64_tr_b16 v[228:229], v9 offset:0
  s_mov_b32 s88, 0x88888888
  s_mov_b32 s89, 0x88888888
  v_cndmask_b32 v175, v255, v174, s[88:89]
  ds_read_b64_tr_b16 v[232:233], v10 offset:0
  ds_read_b64_tr_b16 v[108:109], v175 offset:816
  ds_read_b64_tr_b16 v[110:111], v175 offset:1088
  ds_read_b64_tr_b16 v[236:237], v11 offset:0
  v_mov_b32 v152, 0x3f803f80
  v_mov_b32 v153, 0x3f803f80
  v_mov_b32 v154, 0x3f803f80
  s_waitcnt vmcnt(9)
  ds_read_b64_tr_b16 v[226:227], v8 offset:16384
  v_mov_b32 v155, 0x3f803f80
  v_max_f32 v56, v56, v60
  ds_read_b64_tr_b16 v[230:231], v9 offset:16384
  v_max_f32 v57, v57, v61
  v_max_f32 v58, v58, v62
  v_max_f32 v59, v59, v63
  ds_read_b64_tr_b16 v[234:235], v10 offset:16384
  v_max3_f32 v137, v56, v57, v58
  v_max_f32 v137, v137, v59
  ds_read_b64_tr_b16 v[238:239], v11 offset:16384
  v_max_f32 v72, v72, v76
  v_max_f32 v73, v73, v77
  v_max_f32 v74, v74, v78
  s_waitcnt lgkmcnt(14)
  s_add_u32 m0, s74, 114688
  s_add_u32 s86, s72, 0
  buffer_load_dwordx4 v3, s[36:39], s86 offen lds
  v_max_f32 v75, v75, v79
  v_max3_f32 v138, v72, v73, v74
  v_max_f32 v138, v138, v75
  v_max_f32 v88, v88, v92
  v_max_f32 v89, v89, v93
  v_max_f32 v90, v90, v94
  v_max_f32 v91, v91, v95
  v_max3_f32 v139, v88, v89, v90
  v_max_f32 v139, v139, v91
  v_max_f32 v40, v40, v44
  s_add_u32 m0, s74, 115712
  s_add_u32 s86, s72, 25600
  buffer_load_dwordx4 v3, s[36:39], s86 offen lds
  v_max_f32 v41, v41, v45
  v_max_f32 v42, v42, v46
  v_max_f32 v43, v43, v47
  v_max3_f32 v136, v40, v41, v42
  v_max_f32 v136, v136, v43
  v_permlane16_swap_b32 v138, v139
  s_nop 0
  v_permlane16_swap_b32 v136, v137
  v_and_b32 v174, 31, v1
  v_lshlrev_b32 v174, 4, v174
  v_max_f32 v138, v138, v139
  s_waitcnt lgkmcnt(14)
  s_add_u32 m0, s74, 131072
  s_add_u32 s86, s72, 10240
  buffer_load_dwordx4 v3, s[36:39], s86 offen lds
  v_lshrrev_b32 v175, 5, v1
  s_mov_b32 s81, 73728
  v_max_f32 v136, v136, v137
  v_mad_u32_u24 v174, v175, s81, v174
  v_lshlrev_b32 v175, 26, v175
  v_permlane32_swap_b32 v136, v138
  v_lshl_add_u32 v175, v6, 4, v175
  v_mad_u32_u24 v175, v5, s81, v175
  v_max_f32 v136, v136, v138
  s_lshl_b32 s81, s64, 1
  s_add_u32 m0, s74, 132096
  s_add_u32 s86, s72, 35840
  buffer_load_dwordx4 v3, s[36:39], s86 offen lds
  s_add_u32 s81, s81, s66
  v_mul_f32 v136, v136, v254
  s_lshl_b32 s81, s81, 5
  s_add_u32 s81, s81, s65
  v_mov_b32 v138, v136
  s_mul_i32 s81, s81, 9216
  s_lshl_b32 s82, s67, 9
  v_permlane32_swap_b32 v136, v138
  s_add_u32 s82, s82, s81
  s_add_u32 s82, s82, 6144
  v_mov_b32 v137, v136
  s_waitcnt lgkmcnt(4)
  s_add_u32 m0, s74, 0
  s_add_u32 s86, s72, 51200
  buffer_load_dwordx4 v3, s[36:39], s86 offen lds
  s_lshl_b32 s83, s67, 8
  s_add_u32 s83, s83, s81
  v_mov_b32 v139, v138
  s_add_u32 s83, s83, 8192
  v_permlane16_swap_b32 v136, v137
  v_permlane16_swap_b32 v138, v139
  s_waitcnt lgkmcnt(5)
  v_pk_fma_f32 v[40:41], v[40:41], v[254:255], v[136:137] op_sel:[0,0,0] op_sel_hi:[1,0,0] neg_lo:[0,0,1] neg_hi:[0,0,1]
  v_pk_fma_f32 v[42:43], v[42:43], v[254:255], v[136:137] op_sel:[0,0,0] op_sel_hi:[1,0,0] neg_lo:[0,0,1] neg_hi:[0,0,1]
  v_exp_f32 v40, v40
  s_add_u32 m0, s74, 1024
  s_add_u32 s86, s72, 76800
  buffer_load_dwordx4 v3, s[36:39], s86 offen lds
  v_exp_f32 v41, v41
  v_exp_f32 v42, v42
  v_exp_f32 v43, v43
  v_cvt_pk_bf16_f32 v44, v40, v41
  v_cvt_pk_bf16_f32 v45, v42, v43
  v_and_b32 v46, v44, v252
  v_and_b32 v47, v45, v253
  v_xor_b32 v44, v44, v46
  v_xor_b32 v45, v45, v47
  s_nop 1
  v_mfma_f32_16x16x32_bf16 v[36:39], v[152:155], v[44:47], 0
  s_waitcnt lgkmcnt(0)
  s_add_u32 m0, s74, 16384
  s_add_u32 s86, s72, 61440
  buffer_load_dwordx4 v3, s[36:39], s86 offen lds
  v_mfma_f32_16x16x32_bf16 v[32:35], v[164:167], v[44:47], 0
  v_mfma_f32_16x16x32_bf16 v[140:143], v[96:99], v[44:47], 0
  v_pk_fma_f32 v[56:57], v[56:57], v[254:255], v[136:137] op_sel:[0,0,1] op_sel_hi:[1,0,1] neg_lo:[0,0,1] neg_hi:[0,0,1]
  v_pk_fma_f32 v[58:59], v[58:59], v[254:255], v[136:137] op_sel:[0,0,1] op_sel_hi:[1,0,1] neg_lo:[0,0,1] neg_hi:[0,0,1]
  v_exp_f32 v56, v56
  v_exp_f32 v57, v57
  v_exp_f32 v58, v58
  v_exp_f32 v59, v59
  v_cvt_pk_bf16_f32 v60, v56, v57
  v_cvt_pk_bf16_f32 v61, v58, v59
  s_add_u32 m0, s74, 17408
  s_add_u32 s86, s72, 87040
  buffer_load_dwordx4 v3, s[36:39], s86 offen lds
  v_and_b32 v62, v60, v252
  v_and_b32 v63, v61, v253
  v_xor_b32 v60, v60, v62
  v_xor_b32 v61, v61, v63
  s_setprio 1
  v_rcp_f32 v144, v36
  v_mfma_f32_16x16x32_bf16 v[52:55], v[152:155], v[60:63], 0
  v_mfma_f32_16x16x32_bf16 v[48:51], v[166:169], v[60:63], 0
  v_mfma_f32_16x16x32_bf16 v[140:143], v[100:103], v[60:63], v[140:143]
  v_pk_fma_f32 v[72:73], v[72:73], v[254:255], v[138:139] op_sel:[0,0,0] op_sel_hi:[1,0,0] neg_lo:[0,0,1] neg_hi:[0,0,1]
  s_waitcnt vmcnt(8)
  v_cmp_ne_u32 vcc, s70, v13
  s_cbranch_vccnz L_slow_18
L_back_19:
  buffer_load_dwordx4 v[112:115], v2, s[16:19], s44 offen offset:0 sc1
  v_pk_fma_f32 v[74:75], v[74:75], v[254:255], v[138:139] op_sel:[0,0,0] op_sel_hi:[1,0,0] neg_lo:[0,0,1] neg_hi:[0,0,1]
  v_exp_f32 v72, v72
  v_exp_f32 v73, v73
  v_exp_f32 v74, v74
  v_exp_f32 v75, v75
  v_cvt_pk_bf16_f32 v76, v72, v73
  v_cvt_pk_bf16_f32 v77, v74, v75
  v_and_b32 v78, v76, v252
  v_and_b32 v79, v77, v253
  v_xor_b32 v76, v76, v78
  buffer_load_dwordx4 v[116:119], v2, s[16:19], s44 offen offset:1024 sc1
  v_xor_b32 v77, v77, v79
  v_rcp_f32 v145, v52
  s_nop 0
  v_mfma_f32_16x16x32_bf16 v[68:71], v[152:155], v[76:79], 0
  v_mfma_f32_16x16x32_bf16 v[64:67], v[168:171], v[76:79], 0
  v_mfma_f32_16x16x32_bf16 v[140:143], v[104:107], v[76:79], v[140:143]
  v_pk_fma_f32 v[88:89], v[88:89], v[254:255], v[138:139] op_sel:[0,0,1] op_sel_hi:[1,0,1] neg_lo:[0,0,1] neg_hi:[0,0,1]
  v_pk_fma_f32 v[90:91], v[90:91], v[254:255], v[138:139] op_sel:[0,0,1] op_sel_hi:[1,0,1] neg_lo:[0,0,1] neg_hi:[0,0,1]
  v_exp_f32 v88, v88
  v_exp_f32 v89, v89
  v_exp_f32 v90, v90
  buffer_load_dwordx4 v[120:123], v2, s[16:19], s44 offen offset:2048 sc1
  v_exp_f32 v91, v91
  v_cvt_pk_bf16_f32 v92, v88, v89
  v_cvt_pk_bf16_f32 v93, v90, v91
  v_and_b32 v94, v92, v252
  v_and_b32 v95, v93, v253
  v_xor_b32 v92, v92, v94
  v_xor_b32 v93, v93, v95
  v_rcp_f32 v146, v68
  s_nop 0
  v_mfma_f32_16x16x32_bf16 v[84:87], v[152:155], v[92:95], 0
  v_mfma_f32_16x16x32_bf16 v[80:83], v[170:173], v[92:95], 0
  v_mfma_f32_16x16x32_bf16 v[140:143], v[108:111], v[92:95], v[140:143]
  v_pk_mul_f32 v[32:33], v[32:33], v[144:145] op_sel:[0,0] op_sel_hi:[1,0]
  v_pk_mul_f32 v[34:35], v[34:35], v[144:145] op_sel:[0,0] op_sel_hi:[1,0]
  v_cvt_pk_bf16_f32 v16, v32, v33
  v_cvt_pk_bf16_f32 v17, v34, v35
  v_mov_b32_dpp v148, v144 quad_perm:[0,1,2,3] row_mask:0x1 bank_mask:0xf
  v_pk_mul_f32 v[48:49], v[144:145], v[48:49] op_sel:[1,0] op_sel_hi:[1,1]
  v_pk_mul_f32 v[50:51], v[144:145], v[50:51] op_sel:[1,0] op_sel_hi:[1,1]
  v_cvt_pk_bf16_f32 v18, v48, v49
  v_cvt_pk_bf16_f32 v19, v50, v51
  v_mov_b32_dpp v148, v145 quad_perm:[0,1,2,3] row_mask:0x2 bank_mask:0xf
  v_permlane32_swap_b32 v16, v18
  v_permlane32_swap_b32 v17, v19
  buffer_store_dwordx4 v[16:19], v174, s[16:19], s82 offen sc1
  s_add_u32 s82, s82, 147456
  v_pk_mul_f32 v[64:65], v[64:65], v[146:147] op_sel:[0,0] op_sel_hi:[1,0]
  v_pk_mul_f32 v[66:67], v[66:67], v[146:147] op_sel:[0,0] op_sel_hi:[1,0]
  v_cvt_pk_bf16_f32 v20, v64, v65
  v_cvt_pk_bf16_f32 v21, v66, v67
  v_mov_b32_dpp v148, v146 quad_perm:[0,1,2,3] row_mask:0x4 bank_mask:0xf
  v_rcp_f32 v147, v84
  s_nop 0
  v_pk_mul_f32 v[80:81], v[146:147], v[80:81] op_sel:[1,0] op_sel_hi:[1,1]
  v_pk_mul_f32 v[82:83], v[146:147], v[82:83] op_sel:[1,0] op_sel_hi:[1,1]
  v_cvt_pk_bf16_f32 v22, v80, v81
  v_cvt_pk_bf16_f32 v23, v82, v83
  v_mov_b32_dpp v148, v147 quad_perm:[0,1,2,3] row_mask:0x8 bank_mask:0xf
  v_permlane32_swap_b32 v20, v22
  v_permlane32_swap_b32 v21, v23
  buffer_store_dwordx4 v[20:23], v174, s[16:19], s82 offen sc1
  s_add_u32 s82, s82, 147456
  v_pk_mul_f32 v[140:141], v[140:141], v[148:149] op_sel:[0,0] op_sel_hi:[1,0]
  v_pk_mul_f32 v[142:143], v[142:143], v[148:149] op_sel:[0,0] op_sel_hi:[1,0]
  v_cvt_pk_bf16_f32 v24, v140, v141
  v_cvt_pk_bf16_f32 v25, v142, v143
  s_nop 0
  v_permlane32_swap_b32 v24, v26
  v_permlane32_swap_b32 v25, v27
  buffer_store_dwordx4 v[24:27], v175, s[16:19], s83 offen sc1
  s_setprio 0
  s_waitcnt lgkmcnt(14)
  s_setprio 3
  s_waitcnt vmcnt(5)
  v_mfma_f32_16x16x32_bf16 v[16:19], v[176:179], v[112:115], 0
  v_add_u32 v8, 49152, v7
  v_xor_b32 v9, 32, v8
  v_xor_b32 v10, 64, v8
  v_xor_b32 v11, 0x60, v8
  v_mfma_f32_16x16x32_bf16 v[20:23], v[180:183], v[112:115], 0
  s_waitcnt vmcnt(21)
  ds_read_b64_tr_b16 v[240:241], v8 offset:0
  ds_read_b64_tr_b16 v[244:245], v9 offset:0
  v_mfma_f32_16x16x32_bf16 v[24:27], v[184:187], v[112:115], 0
  ds_read_b64_tr_b16 v[248:249], v10 offset:0
  ds_read_b64_tr_b16 v[252:253], v11 offset:0
  v_mfma_f32_16x16x32_bf16 v[28:31], v[188:191], v[112:115], 0
  s_waitcnt vmcnt(19)
  ds_read_b64_tr_b16 v[242:243], v8 offset:16384
  ds_read_b64_tr_b16 v[246:247], v9 offset:16384
  buffer_load_dwordx4 v[112:115], v2, s[16:19], s44 offen offset:3072 sc1
  s_waitcnt lgkmcnt(14)
  s_waitcnt vmcnt(5)
  v_mfma_f32_16x16x32_bf16 v[16:19], v[192:195], v[116:119], v[16:19]
  ds_read_b64_tr_b16 v[250:251], v10 offset:16384
  ds_read_b64_tr_b16 v[254:255], v11 offset:16384
  v_mfma_f32_16x16x32_bf16 v[20:23], v[196:199], v[116:119], v[20:23]
  s_waitcnt vmcnt(18)
  ds_read_b64_tr_b16 v[160:161], v8 offset:32768
  ds_read_b64_tr_b16 v[164:165], v9 offset:32768
  v_mfma_f32_16x16x32_bf16 v[24:27], v[200:203], v[116:119], v[24:27]
  ds_read_b64_tr_b16 v[168:169], v10 offset:32768
  ds_read_b64_tr_b16 v[172:173], v11 offset:32768
  v_mfma_f32_16x16x32_bf16 v[28:31], v[204:207], v[116:119], v[28:31]
  s_waitcnt vmcnt(16)
  ds_read_b64_tr_b16 v[162:163], v8 offset:49152
  ds_read_b64_tr_b16 v[166:167], v9 offset:49152
  s_add_u32 s80, s44, 4096
  buffer_load_dwordx4 v[116:119], v2, s[16:19], s80 offen offset:0 sc1
  s_waitcnt lgkmcnt(14)
  s_waitcnt vmcnt(5)
  s_waitcnt vmcnt(2)
  s_setprio 3
  v_mov_b32 v108, 162828
  v_mov_b32 v109, 1
  s_mov_b64 exec, 1
  ds_add_rtn_u32 v109, v108, v109
  v_mov_b32 v108, s70
  s_add_u32 s86, s34, 49152
  s_waitcnt lgkmcnt(0)
  v_cmp_eq_u32 vcc, 7, v109
  s_cbranch_vccz L_nofl_21
  s_mov_b64 exec, 0xff
  buffer_store_dwordx4 v[108:111], v2, s[16:19], s86 offen sc1
L_nofl_21:
  s_mov_b64 exec, -1
  s_setprio 0
  v_mfma_f32_16x16x32_bf16 v[16:19], v[208:211], v[120:123], v[16:19]
  ds_read_b64_tr_b16 v[170:171], v10 offset:49152
  ds_read_b64_tr_b16 v[174:175], v11 offset:49152
  v_mfma_f32_16x16x32_bf16 v[20:23], v[212:215], v[120:123], v[20:23]
  s_waitcnt lgkmcnt(13)
  s_add_u32 m0, s74, 49152
  s_add_u32 s86, s72, 20480
  buffer_load_dwordx4 v4, s[36:39], s86 offen lds
  v_mfma_f32_16x16x32_bf16 v[24:27], v[216:219], v[120:123], v[24:27]
  s_bfe_u32 s81, s63, 0x10001
  v_xor_b32 v154, v6, v5
  v_xor_b32 v154, s81, v154
  v_mfma_f32_16x16x32_bf16 v[28:31], v[220:223], v[120:123], v[28:31]
  v_lshlrev_b32 v154, 3, v154
  v_lshl_add_u32 v154, v5, 7, v154
  buffer_load_dwordx4 v[120:123], v2, s[16:19], s80 offen offset:1024 sc1
  s_waitcnt lgkmcnt(14)
  s_setprio 2
  s_waitcnt vmcnt(3)
  v_mfma_f32_16x16x32_bf16 v[16:19], v[224:227], v[112:115], v[16:19]
  s_add_u32 s81, s74, 49152
  v_add_u32 v154, s81, v154
  s_lshl_b32 s81, s67, 2
  v_and_or_b32 v155, v5, 1, s81
  v_mfma_f32_16x16x32_bf16 v[20:23], v[228:231], v[112:115], v[20:23]
  v_xor_b32 v155, v155, v6
  v_lshlrev_b32 v155, 3, v155
  v_mfma_f32_16x16x32_bf16 v[24:27], v[232:235], v[112:115], v[24:27]
  v_lshl_add_u32 v155, v6, 7, v155
  v_lshlrev_b32 v157, 12, v5
  v_mfma_f32_16x16x32_bf16 v[28:31], v[236:239], v[112:115], v[28:31]
  s_lshl_b32 s81, s66, 14
  s_add_u32 s81, s81, 49152
  v_add3_u32 v155, v155, v157, s81
  s_lshl_b32 s81, s67, 2
  v_add_u32 v157, s81, v5
  buffer_load_dwordx4 v[112:115], v2, s[16:19], s45 offen offset:0 sc1
  s_waitcnt lgkmcnt(9)
  s_waitcnt vmcnt(3)
  v_mfma_f32_16x16x32_bf16 v[16:19], v[240:243], v[116:119], v[16:19]
  v_mul_u32_u24 v156, 2560, v157
  v_lshl_add_u32 v156, v6, 3, v156
  v_mfma_f32_16x16x32_bf16 v[20:23], v[244:247], v[116:119], v[20:23]
  s_add_u32 m0, s74, 50176
  s_add_u32 s86, s72, 71680
  buffer_load_dwordx4 v4, s[36:39], s86 offen lds
  v_mfma_f32_16x16x32_bf16 v[24:27], v[248:251], v[116:119], v[24:27]
  v_and_b32 v157, 1, v1
  v_mfma_f32_16x16x32_bf16 v[28:31], v[252:255], v[116:119], v[28:31]
  v_lshlrev_b32 v157, 4, v157
  v_mov_b32 v153, 0x3f80
  buffer_load_dwordx4 v[116:119], v2, s[16:19], s45 offen offset:1024 sc1
  s_waitcnt lgkmcnt(0)
  s_waitcnt vmcnt(3)
  v_mfma_f32_16x16x32_bf16 v[16:19], v[160:163], v[120:123], v[16:19]
  v_lshlrev_b32 v157, v157, v153
  v_mfma_f32_16x16x32_bf16 v[20:23], v[164:167], v[120:123], v[20:23]
  s_mov_b32 s88, 0x30003
  s_mov_b32 s89, 0x30003
  v_cndmask_b32 v136, 0, v157, s[88:89]
  v_cndmask_b32 v138, 0, v157, s[88:89]
  v_mfma_f32_16x16x32_bf16 v[24:27], v[168:171], v[120:123], v[24:27]
  s_mov_b32 s88, 0xc000c
  s_mov_b32 s89, 0xc000c
  v_cndmask_b32 v137, 0, v157, s[88:89]
  v_cndmask_b32 v139, 0, v157, s[88:89]
  v_mfma_f32_16x16x32_bf16 v[28:31], v[172:175], v[120:123], v[28:31]
  s_mov_b32 s88, 0x300030
  s_mov_b32 s89, 0x300030
  v_cndmask_b32 v140, 0, v157, s[88:89]
  v_cndmask_b32 v142, 0, v157, s[88:89]
  buffer_load_dwordx4 v[120:123], v2, s[16:19], s45 offen offset:2048 sc1
  s_setprio 1
  s_waitcnt vmcnt(3)
  v_mfma_f32_16x16x32_bf16 v[32:35], v[176:179], v[112:115], 0
  s_mov_b32 s88, 0xc000c0
  s_mov_b32 s89, 0xc000c0
  v_cndmask_b32 v141, 0, v157, s[88:89]
  v_cndmask_b32 v143, 0, v157, s[88:89]
  v_mfma_f32_16x16x32_bf16 v[36:39], v[180:183], v[112:115], 0
  s_mov_b32 s88, 0x3000300
  s_mov_b32 s89, 0x3000300
  v_cndmask_b32 v144, 0, v157, s[88:89]
  v_cndmask_b32 v146, 0, v157, s[88:89]
  v_mfma_f32_16x16x32_bf16 v[40:43], v[184:187], v[112:115], 0
  s_mov_b32 s88, 0xc000c00
  s_mov_b32 s89, 0xc000c00
  v_cndmask_b32 v145, 0, v157, s[88:89]
  v_cndmask_b32 v147, 0, v157, s[88:89]
  v_mfma_f32_16x16x32_bf16 v[44:47], v[188:191], v[112:115], 0
  s_mov_b32 s88, 0x30003000
  s_mov_b32 s89, 0x30003000
  v_cndmask_b32 v148, 0, v157, s[88:89]
  v_cndmask_b32 v150, 0, v157, s[88:89]
  buffer_load_dwordx4 v[112:115], v2, s[16:19], s45 offen offset:3072 sc1
  s_waitcnt vmcnt(2)
  v_mfma_f32_16x16x32_bf16 v[32:35], v[192:195], v[116:119], v[32:35]
  s_mov_b32 s88, 0xc000c000
  s_mov_b32 s89, 0xc000c000
  v_cndmask_b32 v149, 0, v157, s[88:89]
  v_cndmask_b32 v151, 0, v157, s[88:89]
  v_mfma_f32_16x16x32_bf16 v[36:39], v[196:199], v[116:119], v[36:39]
  buffer_load_dwordx2 v[152:153], v156, s[4:7], s28 offen
  v_mfma_f32_16x16x32_bf16 v[40:43], v[200:203], v[116:119], v[40:43]
  buffer_load_dwordx2 v[158:159], v156, s[4:7], s29 offen
  v_mfma_f32_16x16x32_bf16 v[44:47], v[204:207], v[116:119], v[44:47]
  s_mov_b32 s87, 9453568
  buffer_load_dword v13, v12, s[16:19], s87 offen sc1
  s_add_u32 s80, s45, 4096
  buffer_load_dwordx4 v[116:119], v2, s[16:19], s80 offen offset:0 sc1
  s_waitcnt vmcnt(5)
  v_mfma_f32_16x16x32_bf16 v[32:35], v[208:211], v[120:123], v[32:35]
  v_mfma_f32_16x16x32_bf16 v[36:39], v[212:215], v[120:123], v[36:39]
  v_mfma_f32_16x16x32_bf16 v[40:43], v[216:219], v[120:123], v[40:43]
  v_mfma_f32_16x16x32_bf16 v[44:47], v[220:223], v[120:123], v[44:47]
  buffer_load_dwordx4 v[120:123], v2, s[16:19], s80 offen offset:1024 sc1
  s_setprio 0
  s_waitcnt vmcnt(5)
  v_mfma_f32_16x16x32_bf16 v[32:35], v[224:227], v[112:115], v[32:35]
  v_mfma_f32_16x16x32_bf16 v[36:39], v[228:231], v[112:115], v[36:39]
  v_mfma_f32_16x16x32_bf16 v[40:43], v[232:235], v[112:115], v[40:43]
  v_mfma_f32_16x16x32_bf16 v[44:47], v[236:239], v[112:115], v[44:47]
  s_waitcnt vmcnt(2)
  v_cmp_ne_u32 vcc, s70, v13
  s_cbranch_vccnz L_slow_22
L_back_23:
  buffer_load_dwordx4 v[112:115], v2, s[16:19], s46 offen offset:0 sc1
  s_waitcnt vmcnt(2)
  v_mfma_f32_16x16x32_bf16 v[32:35], v[240:243], v[116:119], v[32:35]
  v_mfma_f32_16x16x32_bf16 v[36:39], v[244:247], v[116:119], v[36:39]
  v_mfma_f32_16x16x32_bf16 v[40:43], v[248:251], v[116:119], v[40:43]
  v_mfma_f32_16x16x32_bf16 v[44:47], v[252:255], v[116:119], v[44:47]
  buffer_load_dwordx4 v[116:119], v2, s[16:19], s46 offen offset:1024 sc1
  s_waitcnt vmcnt(2)
  v_mfma_f32_16x16x32_bf16 v[32:35], v[160:163], v[120:123], v[32:35]
  v_mfma_f32_16x16x32_bf16 v[36:39], v[164:167], v[120:123], v[36:39]
  v_mfma_f32_16x16x32_bf16 v[40:43], v[168:171], v[120:123], v[40:43]
  v_mfma_f32_16x16x32_bf16 v[44:47], v[172:175], v[120:123], v[44:47]
  buffer_load_dwordx4 v[120:123], v2, s[16:19], s46 offen offset:2048 sc1
  s_setprio 3
  s_waitcnt vmcnt(2)
  v_mfma_f32_16x16x32_bf16 v[48:51], v[176:179], v[112:115], 0
  v_mfma_f32_16x16x32_bf16 v[52:55], v[180:183], v[112:115], 0
  v_mfma_f32_16x16x32_bf16 v[56:59], v[184:187], v[112:115], 0
  v_mfma_f32_16x16x32_bf16 v[60:63], v[188:191], v[112:115], 0
  buffer_load_dwordx4 v[112:115], v2, s[16:19], s47 offen offset:0 sc1
  s_waitcnt vmcnt(2)
  v_mfma_f32_16x16x32_bf16 v[48:51], v[192:195], v[116:119], v[48:51]
  v_mfma_f32_16x16x32_bf16 v[52:55], v[196:199], v[116:119], v[52:55]
  v_mfma_f32_16x16x32_bf16 v[56:59], v[200:203], v[116:119], v[56:59]
  v_mfma_f32_16x16x32_bf16 v[60:63], v[204:207], v[116:119], v[60:63]
  buffer_load_dwordx4 v[116:119], v2, s[16:19], s47 offen offset:1024 sc1
  s_waitcnt vmcnt(2)
  v_mfma_f32_16x16x32_bf16 v[48:51], v[208:211], v[120:123], v[48:51]
  v_mfma_f32_16x16x32_bf16 v[52:55], v[212:215], v[120:123], v[52:55]
  v_mfma_f32_16x16x32_bf16 v[56:59], v[216:219], v[120:123], v[56:59]
  v_mfma_f32_16x16x32_bf16 v[60:63], v[220:223], v[120:123], v[60:63]
  buffer_load_dwordx4 v[120:123], v2, s[16:19], s47 offen offset:2048 sc1
  s_setprio 2
  s_waitcnt vmcnt(2)
  v_mfma_f32_16x16x32_bf16 v[64:67], v[176:179], v[112:115], 0
  v_add_u32 v8, 114688, v7
  v_xor_b32 v9, 32, v8
  v_mfma_f32_16x16x32_bf16 v[68:71], v[180:183], v[112:115], 0
  v_xor_b32 v10, 64, v8
  v_xor_b32 v11, 0x60, v8
  v_mfma_f32_16x16x32_bf16 v[72:75], v[184:187], v[112:115], 0
  v_mfma_f32_16x16x32_bf16 v[76:79], v[188:191], v[112:115], 0
  buffer_load_dwordx4 v[112:115], v2, s[16:19], s46 offen offset:3072 sc1
  s_waitcnt vmcnt(2)
  v_mfma_f32_16x16x32_bf16 v[64:67], v[192:195], v[116:119], v[64:67]
  s_waitcnt vmcnt(33)
  ds_read_b64_tr_b16 v[176:177], v8 offset:0
  v_mfma_f32_16x16x32_bf16 v[68:71], v[196:199], v[116:119], v[68:71]
  ds_read_b64_tr_b16 v[180:181], v9 offset:0
  v_mfma_f32_16x16x32_bf16 v[72:75], v[200:203], v[116:119], v[72:75]
  ds_read_b64_tr_b16 v[184:185], v10 offset:0
  v_mfma_f32_16x16x32_bf16 v[76:79], v[204:207], v[116:119], v[76:79]
  ds_read_b64_tr_b16 v[188:189], v11 offset:0
  s_add_u32 s80, s46, 4096
  buffer_load_dwordx4 v[116:119], v2, s[16:19], s80 offen offset:0 sc1
  s_waitcnt vmcnt(2)
  v_mfma_f32_16x16x32_bf16 v[64:67], v[208:211], v[120:123], v[64:67]
  s_waitcnt vmcnt(32)
  ds_read_b64_tr_b16 v[178:179], v8 offset:16384
  v_mfma_f32_16x16x32_bf16 v[68:71], v[212:215], v[120:123], v[68:71]
  ds_read_b64_tr_b16 v[182:183], v9 offset:16384
  v_mfma_f32_16x16x32_bf16 v[72:75], v[216:219], v[120:123], v[72:75]
  ds_read_b64_tr_b16 v[186:187], v10 offset:16384
  v_mfma_f32_16x16x32_bf16 v[76:79], v[220:223], v[120:123], v[76:79]
  ds_read_b64_tr_b16 v[190:191], v11 offset:16384
  buffer_load_dwordx4 v[120:123], v2, s[16:19], s80 offen offset:1024 sc1
  s_setprio 1
  s_waitcnt vmcnt(2)
  v_mfma_f32_16x16x32_bf16 v[48:51], v[224:227], v[112:115], v[48:51]
  v_add_u32 v8, 0, v7
  v_xor_b32 v9, 32, v8
  v_mfma_f32_16x16x32_bf16 v[52:55], v[228:231], v[112:115], v[52:55]
  v_xor_b32 v10, 64, v8
  v_xor_b32 v11, 0x60, v8
  v_mfma_f32_16x16x32_bf16 v[56:59], v[232:235], v[112:115], v[56:59]
  s_waitcnt vmcnt(31)
  ds_read_b64_tr_b16 v[192:193], v8 offset:0
  v_mfma_f32_16x16x32_bf16 v[60:63], v[236:239], v[112:115], v[60:63]
  ds_read_b64_tr_b16 v[196:197], v9 offset:0
  buffer_load_dwordx4 v[112:115], v2, s[16:19], s47 offen offset:3072 sc1
  s_waitcnt vmcnt(2)
  v_mfma_f32_16x16x32_bf16 v[48:51], v[240:243], v[116:119], v[48:51]
  ds_read_b64_tr_b16 v[200:201], v10 offset:0
  v_mfma_f32_16x16x32_bf16 v[52:55], v[244:247], v[116:119], v[52:55]
  ds_read_b64_tr_b16 v[204:205], v11 offset:0
  v_mfma_f32_16x16x32_bf16 v[56:59], v[248:251], v[116:119], v[56:59]
  s_waitcnt vmcnt(30)
  ds_read_b64_tr_b16 v[194:195], v8 offset:16384
  v_mfma_f32_16x16x32_bf16 v[60:63], v[252:255], v[116:119], v[60:63]
  ds_read_b64_tr_b16 v[198:199], v9 offset:16384
  s_mov_b32 s87, 9486336
  buffer_load_dword v13, v12, s[16:19], s87 offen sc1
  s_add_u32 s80, s47, 4096
  buffer_load_dwordx4 v[116:119], v2, s[16:19], s80 offen offset:0 sc1
  s_waitcnt vmcnt(3)
  v_mfma_f32_16x16x32_bf16 v[48:51], v[160:163], v[120:123], v[48:51]
  ds_read_b64_tr_b16 v[202:203], v10 offset:16384
  v_mfma_f32_16x16x32_bf16 v[52:55], v[164:167], v[120:123], v[52:55]
  ds_read_b64_tr_b16 v[206:207], v11 offset:16384
  v_mfma_f32_16x16x32_bf16 v[56:59], v[168:171], v[120:123], v[56:59]
  v_add_u32 v8, 49152, v7
  v_xor_b32 v9, 32, v8
  v_mfma_f32_16x16x32_bf16 v[60:63], v[172:175], v[120:123], v[60:63]
  v_xor_b32 v10, 64, v8
  v_xor_b32 v11, 0x60, v8
  buffer_load_dwordx4 v[120:123], v2, s[16:19], s80 offen offset:1024 sc1
  s_setprio 0
  s_waitcnt vmcnt(3)
  v_mfma_f32_16x16x32_bf16 v[64:67], v[224:227], v[112:115], v[64:67]
  s_waitcnt vmcnt(21)
  ds_read_b64_tr_b16 v[208:209], v8 offset:0
  v_mfma_f32_16x16x32_bf16 v[68:71], v[228:231], v[112:115], v[68:71]
  ds_read_b64_tr_b16 v[212:213], v9 offset:0
  v_mfma_f32_16x16x32_bf16 v[72:75], v[232:235], v[112:115], v[72:75]
  ds_read_b64_tr_b16 v[216:217], v10 offset:0
  v_mfma_f32_16x16x32_bf16 v[76:79], v[236:239], v[112:115], v[76:79]
  ds_read_b64_tr_b16 v[220:221], v11 offset:0
  s_waitcnt vmcnt(2)
  v_cmp_ne_u32 vcc, s70, v13
  s_cbranch_vccnz L_slow_25
L_back_26:
  s_add_u32 s80, s44, 4096
  buffer_load_dwordx4 v[112:115], v2, s[16:19], s80 offen offset:2048 sc1
  s_waitcnt vmcnt(2)
  v_mfma_f32_16x16x32_bf16 v[64:67], v[240:243], v[116:119], v[64:67]
  v_mfma_f32_16x16x32_bf16 v[68:71], v[244:247], v[116:119], v[68:71]
  v_mfma_f32_16x16x32_bf16 v[72:75], v[248:251], v[116:119], v[72:75]
  v_mfma_f32_16x16x32_bf16 v[76:79], v[252:255], v[116:119], v[76:79]
  buffer_load_dwordx4 v[116:119], v2, s[16:19], s80 offen offset:3072 sc1
  s_waitcnt vmcnt(2)
  v_mfma_f32_16x16x32_bf16 v[64:67], v[160:163], v[120:123], v[64:67]
  v_mfma_f32_16x16x32_bf16 v[68:71], v[164:167], v[120:123], v[68:71]
  v_mfma_f32_16x16x32_bf16 v[72:75], v[168:171], v[120:123], v[72:75]
  v_mfma_f32_16x16x32_bf16 v[76:79], v[172:175], v[120:123], v[76:79]
  s_add_u32 s80, s44, 8192
  buffer_load_dwordx4 v[120:123], v2, s[16:19], s80 offen offset:0 sc1
  s_waitcnt lgkmcnt(12)
  s_setprio 2
  s_waitcnt vmcnt(2)
  v_mfma_f32_16x16x32_bf16 v[16:19], v[176:179], v[112:115], v[16:19]
  v_xor_b32 v240, 32, v154
  v_xor_b32 v243, 8, v155
  v_mfma_f32_16x16x32_bf16 v[20:23], v[180:183], v[112:115], v[20:23]
  v_xor_b32 v241, 64, v154
  v_xor_b32 v244, 16, v155
  v_mfma_f32_16x16x32_bf16 v[24:27], v[184:187], v[112:115], v[24:27]
  v_xor_b32 v242, 96, v154
  v_xor_b32 v245, 24, v155
  v_mfma_f32_16x16x32_bf16 v[28:31], v[188:191], v[112:115], v[28:31]
  s_waitcnt vmcnt(20)
  v_lshlrev_b32 v224, 16, v152
  v_and_b32 v225, 0xffff0000, v152
  s_add_u32 s80, s45, 4096
  buffer_load_dwordx4 v[112:115], v2, s[16:19], s80 offen offset:2048 sc1
  s_waitcnt lgkmcnt(4)
  s_waitcnt vmcnt(2)
  v_mfma_f32_16x16x32_bf16 v[16:19], v[192:195], v[116:119], v[16:19]
  v_lshlrev_b32 v226, 16, v153
  v_and_b32 v227, 0xffff0000, v153
  v_mfma_f32_16x16x32_bf16 v[20:23], v[196:199], v[116:119], v[20:23]
  s_waitcnt vmcnt(20)
  v_lshlrev_b32 v228, 16, v158
  v_and_b32 v229, 0xffff0000, v158
  v_mfma_f32_16x16x32_bf16 v[24:27], v[200:203], v[116:119], v[24:27]
  v_lshlrev_b32 v230, 16, v159
  v_and_b32 v231, 0xffff0000, v159
  v_mfma_f32_16x16x32_bf16 v[28:31], v[204:207], v[116:119], v[28:31]
  buffer_load_dwordx4 v[116:119], v2, s[16:19], s80 offen offset:3072 sc1
  s_waitcnt lgkmcnt(0)
  s_waitcnt vmcnt(2)
  v_mfma_f32_16x16x16_bf16 v[16:19], v[208:209], v[120:121], v[16:19]
  v_mfma_f32_16x16x16_bf16 v[20:23], v[212:213], v[120:121], v[20:23]
  v_mfma_f32_16x16x16_bf16 v[24:27], v[216:217], v[120:121], v[24:27]
  v_mfma_f32_16x16x16_bf16 v[28:31], v[220:221], v[120:121], v[28:31]
  v_mfma_f32_16x16x16_bf16 v[48:51], v[208:209], v[122:123], v[48:51]
  v_mfma_f32_16x16x16_bf16 v[52:55], v[212:213], v[122:123], v[52:55]
  v_mfma_f32_16x16x16_bf16 v[56:59], v[216:217], v[122:123], v[56:59]
  v_mfma_f32_16x16x16_bf16 v[60:63], v[220:221], v[122:123], v[60:63]
  s_add_u32 s80, s45, 8192
  buffer_load_dwordx4 v[120:123], v2, s[16:19], s80 offen offset:0 sc1
  s_setprio 1
  s_waitcnt vmcnt(2)
  v_mfma_f32_16x16x32_bf16 v[32:35], v[176:179], v[112:115], v[32:35]
  v_mfma_f32_16x16x32_bf16 v[36:39], v[180:183], v[112:115], v[36:39]
  v_mfma_f32_16x16x32_bf16 v[40:43], v[184:187], v[112:115], v[40:43]
  v_cvt_pk_bf16_f32 v16, v16, v17
  v_cvt_pk_bf16_f32 v17, v18, v19
  ds_write_b64 v154, v[16:17] offset:0
  v_mfma_f32_16x16x32_bf16 v[44:47], v[188:191], v[112:115], v[44:47]
  v_cvt_pk_bf16_f32 v20, v20, v21
  v_cvt_pk_bf16_f32 v21, v22, v23
  ds_write_b64 v240, v[20:21] offset:512
  s_add_u32 s80, s46, 4096
  buffer_load_dwordx4 v[112:115], v2, s[16:19], s80 offen offset:2048 sc1
  s_waitcnt vmcnt(2)
  v_mfma_f32_16x16x32_bf16 v[32:35], v[192:195], v[116:119], v[32:35]
  v_cvt_pk_bf16_f32 v24, v24, v25
  v_cvt_pk_bf16_f32 v25, v26, v27
  ds_write_b64 v241, v[24:25] offset:1024
  v_mfma_f32_16x16x32_bf16 v[36:39], v[196:199], v[116:119], v[36:39]
  v_cvt_pk_bf16_f32 v28, v28, v29
  v_cvt_pk_bf16_f32 v29, v30, v31
  ds_write_b64 v242, v[28:29] offset:1536
  v_mfma_f32_16x16x32_bf16 v[40:43], v[200:203], v[116:119], v[40:43]
  v_mfma_f32_16x16x32_bf16 v[44:47], v[204:207], v[116:119], v[44:47]
  buffer_load_dwordx4 v[116:119], v2, s[16:19], s80 offen offset:3072 sc1
  s_waitcnt vmcnt(2)
  v_mfma_f32_16x16x16_bf16 v[32:35], v[208:209], v[120:121], v[32:35]
  v_mfma_f32_16x16x16_bf16 v[36:39], v[212:213], v[120:121], v[36:39]
  s_nop 0
  v_mfma_f32_16x16x16_bf16 v[40:43], v[216:217], v[120:121], v[40:43]
  v_mfma_f32_16x16x16_bf16 v[44:47], v[220:221], v[120:121], v[44:47]
  v_mfma_f32_16x16x16_bf16 v[64:67], v[208:209], v[122:123], v[64:67]
  v_mfma_f32_16x16x16_bf16 v[68:71], v[212:213], v[122:123], v[68:71]
  v_mfma_f32_16x16x16_bf16 v[72:75], v[216:217], v[122:123], v[72:75]
  v_mfma_f32_16x16x16_bf16 v[76:79], v[220:221], v[122:123], v[76:79]
  s_add_u32 s80, s47, 4096
  buffer_load_dwordx4 v[120:123], v2, s[16:19], s80 offen offset:2048 sc1
  s_setprio 0
  s_waitcnt vmcnt(2)
  v_mfma_f32_16x16x32_bf16 v[48:51], v[176:179], v[112:115], v[48:51]
  v_mfma_f32_16x16x32_bf16 v[52:55], v[180:183], v[112:115], v[52:55]
  v_mfma_f32_16x16x32_bf16 v[56:59], v[184:187], v[112:115], v[56:59]
  v_cvt_pk_bf16_f32 v32, v32, v33
  v_cvt_pk_bf16_f32 v33, v34, v35
  ds_write_b64 v154, v[32:33] offset:16384
  v_mfma_f32_16x16x32_bf16 v[60:63], v[188:191], v[112:115], v[60:63]
  v_cvt_pk_bf16_f32 v36, v36, v37
  v_cvt_pk_bf16_f32 v37, v38, v39
  ds_write_b64 v240, v[36:37] offset:16896
  buffer_load_dwordx4 v[112:115], v2, s[16:19], s80 offen offset:3072 sc1
  s_waitcnt vmcnt(2)
  v_mfma_f32_16x16x32_bf16 v[48:51], v[192:195], v[116:119], v[48:51]
  v_cvt_pk_bf16_f32 v40, v40, v41
  v_cvt_pk_bf16_f32 v41, v42, v43
  ds_write_b64 v241, v[40:41] offset:17408
  v_mfma_f32_16x16x32_bf16 v[52:55], v[196:199], v[116:119], v[52:55]
  v_cvt_pk_bf16_f32 v44, v44, v45
  v_cvt_pk_bf16_f32 v45, v46, v47
  ds_write_b64 v242, v[44:45] offset:17920
  v_mfma_f32_16x16x32_bf16 v[56:59], v[200:203], v[116:119], v[56:59]
  v_mfma_f32_16x16x32_bf16 v[60:63], v[204:207], v[116:119], v[60:63]
  s_waitcnt vmcnt(1)
  v_mfma_f32_16x16x32_bf16 v[64:67], v[176:179], v[120:123], v[64:67]
  v_mfma_f32_16x16x32_bf16 v[68:71], v[180:183], v[120:123], v[68:71]
  v_mfma_f32_16x16x32_bf16 v[72:75], v[184:187], v[120:123], v[72:75]
  v_cvt_pk_bf16_f32 v48, v48, v49
  v_cvt_pk_bf16_f32 v49, v50, v51
  ds_write_b64 v154, v[48:49] offset:32768
  v_mfma_f32_16x16x32_bf16 v[76:79], v[188:191], v[120:123], v[76:79]
  v_cvt_pk_bf16_f32 v52, v52, v53
  v_cvt_pk_bf16_f32 v53, v54, v55
  ds_write_b64 v240, v[52:53] offset:33280
  s_setprio 0
  s_waitcnt vmcnt(0)
  v_mfma_f32_16x16x32_bf16 v[64:67], v[192:195], v[112:115], v[64:67]
  v_cvt_pk_bf16_f32 v56, v56, v57
  v_cvt_pk_bf16_f32 v57, v58, v59
  ds_write_b64 v241, v[56:57] offset:33792
  v_mfma_f32_16x16x32_bf16 v[68:71], v[196:199], v[112:115], v[68:71]
  v_cvt_pk_bf16_f32 v60, v60, v61
  v_cvt_pk_bf16_f32 v61, v62, v63
  ds_write_b64 v242, v[60:61] offset:34304
  v_mfma_f32_16x16x32_bf16 v[72:75], v[200:203], v[112:115], v[72:75]
  v_mfma_f32_16x16x32_bf16 v[76:79], v[204:207], v[112:115], v[76:79]
  v_cvt_pk_bf16_f32 v64, v64, v65
  v_cvt_pk_bf16_f32 v65, v66, v67
  ds_write_b64 v154, v[64:65] offset:49152
  v_cvt_pk_bf16_f32 v68, v68, v69
  v_cvt_pk_bf16_f32 v69, v70, v71
  ds_write_b64 v240, v[68:69] offset:49664
  s_nop 0
  v_cvt_pk_bf16_f32 v72, v72, v73
  v_cvt_pk_bf16_f32 v73, v74, v75
  ds_write_b64 v241, v[72:73] offset:50176
  v_cvt_pk_bf16_f32 v76, v76, v77
  v_cvt_pk_bf16_f32 v77, v78, v79
  ds_write_b64 v242, v[76:77] offset:50688
  s_waitcnt lgkmcnt(0)
  s_barrier
  ds_read_b64 v[16:17], v155 offset:0
  ds_read_b64 v[18:19], v155 offset:2048
  ds_read_b64 v[20:21], v243 offset:0
  ds_read_b64 v[22:23], v243 offset:2048
  ds_read_b64 v[24:25], v244 offset:0
  ds_read_b64 v[26:27], v244 offset:2048
  ds_read_b64 v[28:29], v245 offset:0
  ds_read_b64 v[30:31], v245 offset:2048
  s_waitcnt lgkmcnt(6)
  v_mfma_f32_16x16x32_bf16 v[224:227], v[136:139], v[16:19], v[224:227]
  ds_read_b64 v[48:49], v155 offset:32768
  ds_read_b64 v[50:51], v155 offset:34816
  s_waitcnt lgkmcnt(6)
  v_mfma_f32_16x16x32_bf16 v[224:227], v[140:143], v[20:23], v[224:227]
  ds_read_b64 v[52:53], v243 offset:32768
  ds_read_b64 v[54:55], v243 offset:34816
  s_waitcnt lgkmcnt(6)
  v_mfma_f32_16x16x32_bf16 v[224:227], v[144:147], v[24:27], v[224:227]
  ds_read_b64 v[56:57], v244 offset:32768
  ds_read_b64 v[58:59], v244 offset:34816
  s_waitcnt lgkmcnt(6)
  v_mfma_f32_16x16x32_bf16 v[224:227], v[148:151], v[28:31], v[224:227]
  ds_read_b64 v[60:61], v245 offset:32768
  ds_read_b64 v[62:63], v245 offset:34816
  s_waitcnt lgkmcnt(6)
  v_mfma_f32_16x16x32_bf16 v[228:231], v[136:139], v[48:51], v[228:231]
  s_waitcnt lgkmcnt(4)
  v_mfma_f32_16x16x32_bf16 v[228:231], v[140:143], v[52:55], v[228:231]
  s_waitcnt lgkmcnt(2)
  v_mfma_f32_16x16x32_bf16 v[228:231], v[144:147], v[56:59], v[228:231]
  v_cvt_pk_bf16_f32 v224, v224, v225
  v_cvt_pk_bf16_f32 v225, v226, v227
  buffer_store_dwordx2 v[224:225], v156, s[24:27], s28 offen sc1
  s_waitcnt lgkmcnt(0)
  v_mfma_f32_16x16x32_bf16 v[228:231], v[148:151], v[60:63], v[228:231]
  s_nop 7
  v_cvt_pk_bf16_f32 v228, v228, v229
  v_cvt_pk_bf16_f32 v229, v230, v231
  buffer_store_dwordx2 v[228:229], v156, s[24:27], s29 offen sc1
  s_endpgm
L_slow_6:
  s_mov_b32 s86, 0
L_lp_8:
  s_add_u32 s86, s86, 1
  s_cmp_gt_u32 s86, 262144
  s_cbranch_scc1 L_back_7
  s_sleep 1
  buffer_load_dword v208, off, s[20:23], 0 sc1
  s_waitcnt vmcnt(0)
  v_cmp_eq_u32 vcc, 0, v208
  s_cbranch_vccnz L_lp_8
  s_branch L_back_7
L_slow_9:
  s_mov_b32 s86, 0
L_lp_11:
  s_add_u32 s86, s86, 1
  s_cmp_gt_u32 s86, 262144
  s_cbranch_scc1 L_back_10
  s_sleep 1
  buffer_load_dwordx4 v[226:229], v222, s[16:19], 0 offen sc1
  s_waitcnt vmcnt(0)
  v_cmp_ne_u32 vcc, s70, v227
  v_cmp_ne_u32 s[88:89], s70, v229
  s_nop 1
  s_or_b64 vcc, vcc, s[88:89]
  s_cbranch_vccnz L_lp_11
  s_branch L_back_10
L_slow_12:
  s_mov_b32 s86, 0
L_lp_14:
  s_add_u32 s86, s86, 1
  s_cmp_gt_u32 s86, 262144
  s_cbranch_scc1 L_back_13
  s_sleep 1
  buffer_load_dword v208, off, s[20:23], 0 sc1
  s_waitcnt vmcnt(0)
  v_cmp_eq_u32 vcc, 0, v208
  s_cbranch_vccnz L_lp_14
  s_branch L_back_13
L_slow_15:
  s_mov_b32 s86, 0
L_lp_17:
  s_add_u32 s86, s86, 1
  s_cmp_gt_u32 s86, 262144
  s_cbranch_scc1 L_back_16
  s_sleep 1
  buffer_load_dwordx4 v[226:229], v222, s[16:19], 0 offen sc1
  s_waitcnt vmcnt(0)
  v_cmp_ne_u32 vcc, s70, v227
  v_cmp_ne_u32 s[88:89], s70, v229
  s_nop 1
  s_or_b64 vcc, vcc, s[88:89]
  s_cbranch_vccnz L_lp_17
  s_branch L_back_16
L_slow_18:
  s_mov_b32 s86, 0
L_lp_20:
  s_add_u32 s86, s86, 1
  s_cmp_gt_u32 s86, 262144
  s_cbranch_scc1 L_back_19
  s_sleep 1
  buffer_load_dword v13, v12, s[16:19], s87 offen sc1
  s_waitcnt vmcnt(0)
  v_cmp_ne_u32 vcc, s70, v13
  s_cbranch_vccnz L_lp_20
  s_branch L_back_19
L_slow_22:
  s_mov_b32 s86, 0
L_lp_24:
  s_add_u32 s86, s86, 1
  s_cmp_gt_u32 s86, 262144
  s_cbranch_scc1 L_back_23
  s_sleep 1
  buffer_load_dword v13, v12, s[16:19], s87 offen sc1
  s_waitcnt vmcnt(0)
  v_cmp_ne_u32 vcc, s70, v13
  s_cbranch_vccnz L_lp_24
  s_branch L_back_23
L_slow_25:
  s_mov_b32 s86, 0
L_lp_27:
  s_add_u32 s86, s86, 1
  s_cmp_gt_u32 s86, 262144
  s_cbranch_scc1 L_back_26
  s_sleep 1
  buffer_load_dword v13, v12, s[16:19], s87 offen sc1
  s_waitcnt vmcnt(0)
  v_cmp_ne_u32 vcc, s70, v13
  s_cbranch_vccnz L_lp_27
  s_branch L_back_26
L_mlp:
  s_and_b32 s73, s2, 7
  s_lshr_b32 s81, s2, 3
  s_and_b32 s64, s81, 7
  s_and_b32 s82, s2, 4
  s_lshl_b32 s82, s82, 1
  s_or_b32 s64, s64, s82
  s_and_b32 s65, s2, 3
  s_lshl_b32 s65, s65, 1
  s_bfe_u32 s82, s2, 0x10006
  s_or_b32 s65, s65, s82
  s_lshr_b32 s66, s63, 2
  s_and_b32 s67, s63, 3
  v_lshrrev_b32 v236, 3, v1
  s_and_b32 s82, s63, 1
  s_lshl_b32 s82, s82, 2
  v_lshrrev_b32 v237, 4, v1
  v_or_b32 v237, s82, v237
  v_and_b32 v238, 7, v1
  v_xor_b32 v237, v237, v238
  s_lshl_b32 s82, s63, 3
  v_add_u32 v236, s82, v236
  v_mul_u32_u24 v236, 2560, v236
  v_lshl_add_u32 v168, v237, 4, v236
  s_and_b32 s82, s64, 7
  s_mul_i32 s50, s82, 327680
  s_lshr_b32 s83, s64, 3
  s_mul_i32 s83, s83, 1280
  s_add_u32 s50, s50, s83
  s_add_u32 s51, s50, 163840
  s_mov_b32 s54, 128
  s_lshl_b32 s83, s63, 10
  s_add_u32 s57, s83, 2048
  s_add_u32 s58, s83, 10240
  s_add_u32 s59, s83, 18432
  s_add_u32 s60, s83, 26624
  s_add_u32 s61, s83, 34816
  s_add_u32 s62, s83, 43008
  s_lshl_b32 s84, s63, 6
  v_lshrrev_b32 v236, 5, v1
  v_bfe_u32 v237, v1, 3, 2
  v_lshl_add_u32 v236, v236, 3, v237
  v_mul_u32_u24 v236, 3072, v236
  v_lshrrev_b32 v237, 3, v1
  v_and_b32 v237, 6, v237
  v_and_b32 v238, 7, v1
  v_xor_b32 v237, v237, v238
  v_lshl_add_u32 v169, v237, 4, v236
  s_lshl_b32 s81, s66, 5
  s_and_b32 s82, s63, 1
  s_lshl_b32 s82, s82, 4
  s_add_u32 s81, s81, s82
  s_and_b32 s82, s63, 2
  s_lshl_b32 s82, s82, 1
  s_add_u32 s81, s81, s82
  s_mul_i32 s81, s81, 3072
  s_mul_i32 s52, s65, 384
  s_add_u32 s52, s52, s81
  s_mov_b32 s55, 196608
  s_mov_b32 s8, s40
  s_mov_b32 s9, s41
  s_mov_b32 s10, 1966080
  s_mov_b32 s11, 0x20000
  s_mov_b32 s20, s46
  s_mov_b32 s21, s47
  s_mov_b32 s22, 256
  s_mov_b32 s23, 0x20000
  v_lshrrev_b32 v5, 4, v1
  v_and_b32 v6, 15, v1
  v_lshlrev_b32 v2, 4, v1
  v_lshrrev_b32 v236, 1, v6
  v_xor_b32 v236, v236, v5
  v_lshlrev_b32 v236, 4, v236
  v_lshl_add_u32 v236, v6, 7, v236
  s_lshl_b32 s81, s66, 13
  v_add_u32 v8, s81, v236
  v_xor_b32 v9, 64, v8
  v_lshrrev_b32 v236, 2, v1
  v_and_b32 v237, 3, v1
  v_bfe_u32 v238, v1, 3, 2
  v_lshlrev_b32 v7, 7, v236
  v_lshl_add_u32 v7, v238, 5, v7
  v_lshl_add_u32 v7, v237, 3, v7
  s_mul_i32 s81, s67, 3
  s_add_u32 s82, s81, 0
  s_lshr_b32 s83, s82, 2
  s_lshl_b32 s83, s83, 13
  s_add_u32 s83, s83, 18432
  s_and_b32 s82, s82, 3
  s_lshl_b32 s82, s82, 5
  v_xor_b32 v237, s82, v7
  v_add_u32 v12, s83, v237
  s_add_u32 s82, s81, 1
  s_lshr_b32 s83, s82, 2
  s_lshl_b32 s83, s83, 13
  s_add_u32 s83, s83, 18432
  s_and_b32 s82, s82, 3
  s_lshl_b32 s82, s82, 5
  v_xor_b32 v237, s82, v7
  v_add_u32 v14, s83, v237
  s_add_u32 s82, s81, 2
  s_lshr_b32 s83, s82, 2
  s_lshl_b32 s83, s83, 13
  s_add_u32 s83, s83, 18432
  s_and_b32 s82, s82, 3
  s_lshl_b32 s82, s82, 5
  v_xor_b32 v237, s82, v7
  v_add_u32 v173, s83, v237
  s_lshl_b32 s74, s63, 11
  v_add_u32 v7, s74, v7
  s_bfe_u32 s68, s2, 0x30003
  s_bfe_u32 s75, s2, 0x10006
  s_mul_i32 s75, s75, 3
  s_lshl_b32 s69, s73, 4
  s_mov_b32 s16, s48
  s_mov_b32 s17, s49
  s_mov_b32 s18, 10223616
  s_mov_b32 s19, 0x20000
  s_mov_b32 s24, s44
  s_mov_b32 s25, s45
  s_mov_b32 s26, 2621440
  s_mov_b32 s27, 0x20000
  s_mov_b32 s38, 819200
  s_mov_b32 s39, 0x20000
  s_mov_b32 s40, s42
  s_mov_b32 s41, s43
  s_mov_b32 s42, 1966080
  s_mov_b32 s43, 0x20000
  s_lshl_b32 s81, s65, 2
  s_add_u32 s81, s81, s67
  s_mul_i32 s81, s81, 48
  s_add_u32 s81, s81, 1920
  v_min_u32 v239, 47, v1
  v_add_u32 v239, s81, v239
  v_add_u32 v10, 0x10000, v8
  v_add_u32 v11, 0x10000, v9
  v_add_u32 v13, 0x10000, v12
  v_add_u32 v15, 0x10000, v14
  v_add_u32 v174, 0x10000, v173
  v_lshlrev_b32 v238, 2, v1
  v_add_u32 v224, 149760, v238
  s_lshl_b32 s81, s67, 8
  s_cmp_eq_u32 s66, 0
  s_cbranch_scc1 L_crow_29
  v_lshlrev_b32 v222, 4, v239
  v_add_u32 v222, 9568256, v222
  s_add_u32 s81, s81, 148736
  v_add_u32 v223, s81, v238
  v_mov_b32 v225, 1.0
  s_branch L_cend_30
L_crow_29:
  s_lshl_b32 s82, s67, 6
  v_add_u32 v236, s82, v1
  v_cmp_gt_u32 vcc, 0x90, v236
  v_min_u32 v236, 0x8f, v236
  s_add_u32 s81, s81, 147456
  v_add_u32 v237, s81, v238
  v_cndmask_b32 v223, v224, v237, vcc
  v_add_u32 v224, 640, v223
  s_and_b32 s81, s64, 7
  s_lshl_b32 s81, s81, 7
  s_sub_u32 s81, s81, 16
  v_add_u32 v236, s81, v236
  v_max_i32 v236, 0, v236
  s_lshr_b32 s81, s64, 3
  s_lshl_b32 s81, s81, 14
  s_add_u32 s81, s81, 9502720
  v_lshl_add_u32 v222, v236, 4, s81
  v_mov_b32 v225, 0
L_cend_30:
  v_and_b32 v236, 7, v1
  v_and_b32 v237, 1, v5
  v_lshlrev_b32 v237, 4, v237
  v_lshl_add_u32 v237, v236, 5, v237
  s_lshl_b32 s81, s63, 8
  s_add_u32 s81, s81, 149760
  v_add_u32 v218, s81, v237
  v_lshrrev_b32 v237, 3, v1
  v_lshlrev_b32 v238, 8, v237
  v_lshl_add_u32 v238, v236, 2, v238
  s_lshl_b32 s81, s63, 5
  s_add_u32 s81, s81, 149760
  v_add_u32 v219, s81, v238
  v_lshl_add_u32 v220, v237, 27, v2
  v_and_b32 v237, 1, v1
  v_lshlrev_b32 v237, 4, v237
  v_mov_b32 v238, 0x3f80
  v_lshlrev_b32 v238, v237, v238
  v_lshrrev_b32 v236, 1, v236
  v_cmp_eq_u32 s[88:89], 0, v236
  s_nop 1
  v_cndmask_b32 v60, 0, v238, s[88:89]
  v_cmp_eq_u32 s[88:89], 1, v236
  s_nop 1
  v_cndmask_b32 v61, 0, v238, s[88:89]
  v_cmp_eq_u32 s[88:89], 2, v236
  s_nop 1
  v_cndmask_b32 v62, 0, v238, s[88:89]
  v_cmp_eq_u32 s[88:89], 3, v236
  s_nop 1
  v_cndmask_b32 v63, 0, v238, s[88:89]
  v_lshrrev_b32 v236, 3, v1
  v_lshlrev_b32 v237, 1, v5
  v_and_b32 v238, 7, v1
  v_xor_b32 v237, v237, v238
  v_lshlrev_b32 v237, 4, v237
  v_mul_u32_u24 v3, 1280, v236
  v_add_u32 v3, v3, v237
  v_lshrrev_b32 v238, 5, v1
  v_mul_u32_u24 v238, 20480, v238
  v_add_u32 v4, v3, v238
  s_lshl_b32 s81, s68, 7
  s_mul_i32 s71, s63, 245760
  s_add_u32 s71, s71, s81
  s_mul_i32 s72, s63, 102400
  s_add_u32 s72, s72, s81
  s_lshl_b32 s81, s64, 3
  s_add_u32 s81, s81, s65
  s_lshl_b32 s81, s81, 7
  s_add_u32 s34, s81, 9437184
  v_and_b32 v236, 3, v1
  v_lshlrev_b32 v236, 2, v236
  v_add_u32 v236, 162816, v236
  v_mov_b32 v237, 0
  ds_write_b32 v236, v237
  s_lshl_b32 s35, s69, 3
  s_add_u32 s35, s35, s63
  s_mul_i32 s35, s35, 9216
  s_mov_b32 s81, s68
  s_cmp_ge_u32 s81, 3
  s_cselect_b32 s82, 3, 0
  s_sub_u32 s81, s81, s82
  s_cmp_ge_u32 s81, 3
  s_cselect_b32 s82, 3, 0
  s_sub_u32 s81, s81, s82
  s_add_u32 s82, s81, s75
  s_and_b32 s83, s82, 6
  s_add_u32 s96, s82, s83
  s_mul_i32 s44, s96, 73728
  s_add_u32 s44, s44, s35
  s_add_u32 s47, s44, 147456
  s_add_u32 s81, s81, 1
  s_cmp_eq_u32 s81, 3
  s_cselect_b32 s81, 0, s81
  s_add_u32 s82, s81, s75
  s_and_b32 s83, s82, 6
  s_add_u32 s97, s82, s83
  s_mul_i32 s45, s97, 73728
  s_add_u32 s45, s45, s35
  s_add_u32 s48, s45, 147456
  s_add_u32 s81, s81, 1
  s_cmp_eq_u32 s81, 3
  s_cselect_b32 s81, 0, s81
  s_add_u32 s82, s81, s75
  s_and_b32 s83, s82, 6
  s_add_u32 s98, s82, s83
  s_mul_i32 s46, s98, 73728
  s_add_u32 s46, s46, s35
  s_add_u32 s49, s46, 147456
  s_and_b32 s84, s69, 63
  s_mul_i32 s84, s84, 40960
  s_lshr_b32 s81, s69, 6
  s_mul_i32 s81, s81, 1280
  s_add_u32 s84, s84, s81
  s_lshl_b32 s81, s68, 7
  s_add_u32 s84, s84, s81
  s_cmp_eq_u32 s66, 1
  s_cselect_b32 s81, s97, s96
  s_cselect_b32 s82, 0, 0
  s_add_u32 s81, s81, s82
  s_mul_i32 s81, s81, 40960
  s_add_u32 s28, s81, s84
  s_cmp_eq_u32 s66, 1
  s_cselect_b32 s81, s96, s98
  s_cselect_b32 s82, 2, 0
  s_add_u32 s81, s81, s82
  s_mul_i32 s81, s81, 40960
  s_add_u32 s29, s81, s84
  s_cmp_eq_u32 s66, 1
  s_cselect_b32 s81, s98, s97
  s_cselect_b32 s82, 2, 2
  s_add_u32 s81, s81, s82
  s_mul_i32 s81, s81, 40960
  s_add_u32 s30, s81, s84
  s_waitcnt vmcnt(5)
  v_lshlrev_b32 v186, 16, v176
  v_and_b32 v187, 0xffff0000, v176
  v_lshlrev_b32 v188, 16, v177
  v_and_b32 v189, 0xffff0000, v177
  v_lshlrev_b32 v190, 16, v178
  v_and_b32 v191, 0xffff0000, v178
  v_lshlrev_b32 v192, 16, v179
  v_and_b32 v193, 0xffff0000, v179
  v_mov_b32_dpp v212, v186 row_newbcast:0 row_mask:0xf bank_mask:0xf
  v_mov_b32 v213, v212
  s_nop 1
  v_permlane16_swap_b32 v212, v213
  v_pk_add_f32 v[186:187], v[186:187], v[212:213] op_sel:[0,0] op_sel_hi:[1,0] neg_lo:[0,1] neg_hi:[0,1]
  v_pk_add_f32 v[188:189], v[188:189], v[212:213] op_sel:[0,0] op_sel_hi:[1,0] neg_lo:[0,1] neg_hi:[0,1]
  v_pk_add_f32 v[190:191], v[190:191], v[212:213] op_sel:[0,0] op_sel_hi:[1,0] neg_lo:[0,1] neg_hi:[0,1]
  v_pk_add_f32 v[192:193], v[192:193], v[212:213] op_sel:[0,0] op_sel_hi:[1,0] neg_lo:[0,1] neg_hi:[0,1]
  v_pk_mul_f32 v[94:95], v[186:187], v[186:187] op_sel:[0,0] op_sel_hi:[1,1]
  v_pk_add_f32 v[92:93], v[188:189], v[186:187] op_sel:[0,0] op_sel_hi:[1,1]
  v_pk_fma_f32 v[94:95], v[188:189], v[188:189], v[94:95] op_sel:[0,0,0] op_sel_hi:[1,1,1]
  v_pk_add_f32 v[92:93], v[190:191], v[92:93] op_sel:[0,0] op_sel_hi:[1,1]
  v_pk_fma_f32 v[94:95], v[190:191], v[190:191], v[94:95] op_sel:[0,0,0] op_sel_hi:[1,1,1]
  v_pk_add_f32 v[92:93], v[192:193], v[92:93] op_sel:[0,0] op_sel_hi:[1,1]
  v_pk_fma_f32 v[94:95], v[192:193], v[192:193], v[94:95] op_sel:[0,0,0] op_sel_hi:[1,1,1]
  v_mfma_f32_16x16x32_bf16 v[76:79], v[60:63], v[16:19], 0
  v_mfma_f32_16x16x32_bf16 v[76:79], v[60:63], v[20:23], v[76:79]
  s_waitcnt vmcnt(0)
  v_mfma_f32_16x16x32_bf16 v[76:79], v[60:63], v[24:27], v[76:79]
  v_mfma_f32_16x16x32_bf16 v[76:79], v[60:63], v[28:31], v[76:79]
  v_mfma_f32_16x16x32_bf16 v[76:79], v[60:63], v[44:47], v[76:79]
  v_lshlrev_b32 v194, 16, v180
  v_and_b32 v195, 0xffff0000, v180
  v_lshlrev_b32 v196, 16, v181
  v_and_b32 v197, 0xffff0000, v181
  v_lshlrev_b32 v198, 16, v182
  v_and_b32 v199, 0xffff0000, v182
  v_lshlrev_b32 v200, 16, v183
  v_and_b32 v201, 0xffff0000, v183
  v_lshlrev_b32 v202, 16, v184
  v_and_b32 v203, 0xffff0000, v184
  v_lshlrev_b32 v204, 16, v185
  v_and_b32 v205, 0xffff0000, v185
  v_pk_add_f32 v[194:195], v[194:195], v[212:213] op_sel:[0,0] op_sel_hi:[1,0] neg_lo:[0,1] neg_hi:[0,1]
  v_pk_add_f32 v[196:197], v[196:197], v[212:213] op_sel:[0,0] op_sel_hi:[1,0] neg_lo:[0,1] neg_hi:[0,1]
  v_pk_add_f32 v[198:199], v[198:199], v[212:213] op_sel:[0,0] op_sel_hi:[1,0] neg_lo:[0,1] neg_hi:[0,1]
  v_pk_add_f32 v[200:201], v[200:201], v[212:213] op_sel:[0,0] op_sel_hi:[1,0] neg_lo:[0,1] neg_hi:[0,1]
  v_pk_add_f32 v[202:203], v[202:203], v[212:213] op_sel:[0,0] op_sel_hi:[1,0] neg_lo:[0,1] neg_hi:[0,1]
  v_pk_add_f32 v[204:205], v[204:205], v[212:213] op_sel:[0,0] op_sel_hi:[1,0] neg_lo:[0,1] neg_hi:[0,1]
  v_pk_add_f32 v[92:93], v[194:195], v[92:93] op_sel:[0,0] op_sel_hi:[1,1]
  v_pk_fma_f32 v[94:95], v[194:195], v[194:195], v[94:95] op_sel:[0,0,0] op_sel_hi:[1,1,1]
  v_pk_add_f32 v[92:93], v[196:197], v[92:93] op_sel:[0,0] op_sel_hi:[1,1]
  v_pk_fma_f32 v[94:95], v[196:197], v[196:197], v[94:95] op_sel:[0,0,0] op_sel_hi:[1,1,1]
  v_pk_add_f32 v[92:93], v[198:199], v[92:93] op_sel:[0,0] op_sel_hi:[1,1]
  v_pk_fma_f32 v[94:95], v[198:199], v[198:199], v[94:95] op_sel:[0,0,0] op_sel_hi:[1,1,1]
  v_pk_add_f32 v[92:93], v[200:201], v[92:93] op_sel:[0,0] op_sel_hi:[1,1]
  v_pk_fma_f32 v[94:95], v[200:201], v[200:201], v[94:95] op_sel:[0,0,0] op_sel_hi:[1,1,1]
  v_pk_add_f32 v[92:93], v[202:203], v[92:93] op_sel:[0,0] op_sel_hi:[1,1]
  v_pk_fma_f32 v[94:95], v[202:203], v[202:203], v[94:95] op_sel:[0,0,0] op_sel_hi:[1,1,1]
  v_pk_add_f32 v[92:93], v[204:205], v[92:93] op_sel:[0,0] op_sel_hi:[1,1]
  v_pk_fma_f32 v[94:95], v[204:205], v[204:205], v[94:95] op_sel:[0,0,0] op_sel_hi:[1,1,1]
  v_add_f32 v92, v92, v93
  v_add_f32 v94, v94, v95
  v_add_f32_dpp v76, v76, v76 row_ror:8 row_mask:0xf bank_mask:0xf
  v_add_f32_dpp v92, v92, v92 quad_perm:[1,0,3,2] row_mask:0xf bank_mask:0xf
  v_add_f32_dpp v94, v94, v94 quad_perm:[1,0,3,2] row_mask:0xf bank_mask:0xf
  v_add_f32_dpp v77, v77, v77 row_ror:8 row_mask:0xf bank_mask:0xf
  v_add_f32_dpp v92, v92, v92 quad_perm:[2,3,0,1] row_mask:0xf bank_mask:0xf
  v_add_f32_dpp v94, v94, v94 quad_perm:[2,3,0,1] row_mask:0xf bank_mask:0xf
  v_add_f32_dpp v78, v78, v78 row_ror:8 row_mask:0xf bank_mask:0xf
  v_add_f32_dpp v92, v92, v92 row_half_mirror row_mask:0xf bank_mask:0xf
  v_add_f32_dpp v94, v94, v94 row_half_mirror row_mask:0xf bank_mask:0xf
  v_add_f32_dpp v79, v79, v79 row_ror:8 row_mask:0xf bank_mask:0xf
  v_add_f32_dpp v92, v92, v92 row_mirror row_mask:0xf bank_mask:0xf
  v_add_f32_dpp v94, v94, v94 row_mirror row_mask:0xf bank_mask:0xf
  ds_write_b128 v218, v[76:79]
  v_mov_b32 v206, v92
  v_mov_b32 v207, v94
  s_nop 0
  v_permlane16_swap_b32 v92, v206
  v_permlane16_swap_b32 v94, v207
  v_add_f32 v92, v92, v206
  v_add_f32 v94, v94, v207
  v_mul_f32 v92, 0x3acccccd, v92
  v_mul_f32 v94, 0x3acccccd, v94
  v_fma_f32 v94, -v92, v92, v94
  v_add_f32 v92, v92, v212
  v_max_f32 v94, 0, v94
  v_cvt_pk_bf16_f32 v206, v92, v94
  v_and_b32 v94, 0xffff0000, v206
  v_lshlrev_b32 v92, 16, v206
  v_add_f32 v94, 0x3727c5ac, v94
  v_xor_b32 v92, 0x80000000, v92
  v_cvt_pk_bf16_f32 v206, v94, v94
  v_and_b32 v94, 0xffff0000, v206
  v_sqrt_f32 v94, v94
  s_nop 0
  v_cvt_pk_bf16_f32 v206, v94, v94
  v_and_b32 v94, 0xffff0000, v206
  v_rcp_f32 v94, v94
  s_add_u32 m0, s57, 0
  s_nop 0
  buffer_load_dwordx4 v168, s[4:7], s50 offen lds
  s_add_u32 s50, s50, s54
  s_add_u32 m0, s58, 0
  s_nop 0
  buffer_load_dwordx4 v168, s[4:7], s51 offen lds
  s_add_u32 s51, s51, s54
  s_add_u32 m0, s59, 0
  s_nop 0
  buffer_load_dwordx4 v169, s[8:11], s52 offen offset:0 lds
  s_add_u32 m0, s59, 8064
  s_nop 0
  buffer_load_dwordx4 v169, s[8:11], s52 offen offset:128 lds
  s_add_u32 m0, s59, 16128
  s_nop 0
  buffer_load_dwordx4 v169, s[8:11], s52 offen offset:256 lds
  s_add_u32 s52, s52, s55
  buffer_load_dword v208, off, s[20:23], 0 sc1
  s_add_u32 m0, s57, 49152
  s_nop 0
  buffer_load_dwordx4 v168, s[4:7], s50 offen lds
  s_add_u32 s50, s50, s54
  s_add_u32 m0, s58, 49152
  s_nop 0
  buffer_load_dwordx4 v168, s[4:7], s51 offen lds
  s_add_u32 s51, s51, s54
  s_add_u32 m0, s59, 49152
  s_nop 0
  buffer_load_dwordx4 v169, s[8:11], s52 offen offset:0 lds
  s_add_u32 m0, s59, 57216
  s_nop 0
  buffer_load_dwordx4 v169, s[8:11], s52 offen offset:128 lds
  s_add_u32 m0, s59, 65280
  s_nop 0
  buffer_load_dwordx4 v169, s[8:11], s52 offen offset:256 lds
  s_add_u32 s52, s52, s55
  s_waitcnt vmcnt(6) lgkmcnt(0)
  s_barrier
  ds_read_b128 v[100:103], v8 offset:2048
  ds_read_b64_tr_b16 v[116:117], v12 offset:0
  ds_read_b64_tr_b16 v[118:119], v12 offset:2048
  ds_read_b64_tr_b16 v[120:121], v14 offset:0
  ds_read_b64_tr_b16 v[122:123], v14 offset:2048
  ds_read_b64_tr_b16 v[124:125], v173 offset:0
  ds_read_b64_tr_b16 v[126:127], v173 offset:2048
  ds_read_b128 v[104:107], v8 offset:4096
  ds_read_b128 v[108:111], v8 offset:6144
  ds_read_b128 v[112:115], v8 offset:8192
  s_waitcnt vmcnt(5)
  ds_read_b32 v76, v219
  v_cmp_eq_u32 vcc, 0, v208
  s_cbranch_vccnz L_slow_31
L_back_32:
  v_readfirstlane_b32 s70, v208
  v_mov_b32 v93, v208
  v_mov_b32 v95, v208
  buffer_store_dwordx4 v[92:95], v221, s[16:19], s77 offen sc1
  s_waitcnt lgkmcnt(0)
  v_mfma_f32_16x16x32_bf16 v[32:35], v[116:119], v[100:103], 0
  ds_read_b128 v[136:139], v9 offset:2048
  v_add_f32_dpp v76, v76, v76 row_ror:8 row_mask:0xf bank_mask:0xf
  v_mov_b32 v77, v208
  s_add_u32 m0, s57, 98304
  v_mfma_f32_16x16x32_bf16 v[36:39], v[120:123], v[100:103], 0
  buffer_load_dwordx4 v168, s[4:7], s50 offen lds
  s_add_u32 s50, s50, s54
  ds_read_b64_tr_b16 v[152:153], v12 offset:4096
  v_mov_b32 v78, v76
  s_nop 1
  v_permlane16_swap_b32 v76, v78
  v_mfma_f32_16x16x32_bf16 v[40:43], v[124:127], v[100:103], 0
  ds_read_b64_tr_b16 v[154:155], v12 offset:6144
  v_add_f32 v76, v76, v78
  v_mov_b32 v78, v76
  s_add_u32 m0, s58, 98304
  v_mfma_f32_16x16x32_bf16 v[56:59], v[124:127], v[104:107], 0
  buffer_load_dwordx4 v168, s[4:7], s51 offen lds
  s_add_u32 s51, s51, s54
  ds_read_b64_tr_b16 v[156:157], v14 offset:4096
  v_permlane32_swap_b32 v76, v78
  v_add_f32 v76, v76, v78
  v_mfma_f32_16x16x32_bf16 v[52:55], v[120:123], v[104:107], 0
  ds_read_b64_tr_b16 v[158:159], v14 offset:6144
  buffer_store_dwordx2 v[76:77], v220, s[16:19], s78 offen sc1
  s_add_u32 m0, s59, 98304
  v_mfma_f32_16x16x32_bf16 v[48:51], v[116:119], v[104:107], 0
  buffer_load_dwordx4 v169, s[8:11], s52 offen offset:0 lds
  ds_read_b64_tr_b16 v[160:161], v173 offset:4096
  v_mfma_f32_16x16x32_bf16 v[64:67], v[116:119], v[108:111], 0
  ds_read_b64_tr_b16 v[162:163], v173 offset:6144
  s_add_u32 m0, s59, 106368
  v_mfma_f32_16x16x32_bf16 v[68:71], v[120:123], v[108:111], 0
  buffer_load_dwordx4 v169, s[8:11], s52 offen offset:128 lds
  ds_read_b128 v[140:143], v9 offset:4096
  v_mfma_f32_16x16x32_bf16 v[72:75], v[124:127], v[108:111], 0
  ds_read_b128 v[144:147], v9 offset:6144
  s_add_u32 m0, s59, 114432
  v_mfma_f32_16x16x32_bf16 v[88:91], v[124:127], v[112:115], 0
  buffer_load_dwordx4 v169, s[8:11], s52 offen offset:256 lds
  s_add_u32 s52, s52, s55
  ds_read_b128 v[148:151], v9 offset:8192
  v_mfma_f32_16x16x32_bf16 v[84:87], v[120:123], v[112:115], 0
  v_mfma_f32_16x16x32_bf16 v[80:83], v[116:119], v[112:115], 0
  s_waitcnt vmcnt(7) lgkmcnt(0)
  s_barrier
  s_setprio 3
  v_mfma_f32_16x16x32_bf16 v[32:35], v[152:155], v[136:139], v[32:35]
  ds_read_b128 v[100:103], v8 offset:51200
  s_add_u32 m0, s57, 0
  v_mfma_f32_16x16x32_bf16 v[36:39], v[156:159], v[136:139], v[36:39]
  buffer_load_dwordx4 v168, s[4:7], s50 offen lds
  s_add_u32 s50, s50, s54
  ds_read_b64_tr_b16 v[116:117], v12 offset:49152
  v_mfma_f32_16x16x32_bf16 v[40:43], v[160:163], v[136:139], v[40:43]
  ds_read_b64_tr_b16 v[118:119], v12 offset:51200
  v_mfma_f32_16x16x32_bf16 v[56:59], v[160:163], v[140:143], v[56:59]
  ds_read_b64_tr_b16 v[120:121], v14 offset:49152
  s_add_u32 m0, s58, 0
  v_mfma_f32_16x16x32_bf16 v[52:55], v[156:159], v[140:143], v[52:55]
  buffer_load_dwordx4 v168, s[4:7], s51 offen lds
  s_add_u32 s51, s51, s54
  ds_read_b64_tr_b16 v[122:123], v14 offset:51200
  v_mfma_f32_16x16x32_bf16 v[48:51], v[152:155], v[140:143], v[48:51]
  ds_read_b64_tr_b16 v[124:125], v173 offset:49152
  s_setprio 2
  v_mfma_f32_16x16x32_bf16 v[64:67], v[152:155], v[144:147], v[64:67]
  ds_read_b64_tr_b16 v[126:127], v173 offset:51200
  s_add_u32 m0, s59, 0
  v_mfma_f32_16x16x32_bf16 v[68:71], v[156:159], v[144:147], v[68:71]
  buffer_load_dwordx4 v169, s[8:11], s52 offen offset:0 lds
  ds_read_b128 v[104:107], v8 offset:53248
  v_mfma_f32_16x16x32_bf16 v[72:75], v[160:163], v[144:147], v[72:75]
  ds_read_b128 v[108:111], v8 offset:55296
  v_mfma_f32_16x16x32_bf16 v[88:91], v[160:163], v[148:151], v[88:91]
  ds_read_b128 v[112:115], v8 offset:57344
  v_mfma_f32_16x16x32_bf16 v[84:87], v[156:159], v[148:151], v[84:87]
  v_mfma_f32_16x16x32_bf16 v[80:83], v[152:155], v[148:151], v[80:83]
  s_waitcnt lgkmcnt(0)
  s_setprio 1
  v_mfma_f32_16x16x32_bf16 v[32:35], v[116:119], v[100:103], v[32:35]
  ds_read_b128 v[136:139], v9 offset:51200
  s_add_u32 m0, s59, 8064
  v_mfma_f32_16x16x32_bf16 v[36:39], v[120:123], v[100:103], v[36:39]
  buffer_load_dwordx4 v169, s[8:11], s52 offen offset:128 lds
  ds_read_b64_tr_b16 v[152:153], v12 offset:53248
  v_mfma_f32_16x16x32_bf16 v[40:43], v[124:127], v[100:103], v[40:43]
  ds_read_b64_tr_b16 v[154:155], v12 offset:55296
  v_mfma_f32_16x16x32_bf16 v[56:59], v[124:127], v[104:107], v[56:59]
  ds_read_b64_tr_b16 v[156:157], v14 offset:53248
  v_mfma_f32_16x16x32_bf16 v[52:55], v[120:123], v[104:107], v[52:55]
  ds_read_b64_tr_b16 v[158:159], v14 offset:55296
  s_add_u32 m0, s59, 16128
  v_mfma_f32_16x16x32_bf16 v[48:51], v[116:119], v[104:107], v[48:51]
  buffer_load_dwordx4 v169, s[8:11], s52 offen offset:256 lds
  s_add_u32 s52, s52, s55
  ds_read_b64_tr_b16 v[160:161], v173 offset:53248
  s_setprio 0
  v_mfma_f32_16x16x32_bf16 v[64:67], v[116:119], v[108:111], v[64:67]
  ds_read_b64_tr_b16 v[162:163], v173 offset:55296
  v_mfma_f32_16x16x32_bf16 v[68:71], v[120:123], v[108:111], v[68:71]
  ds_read_b128 v[140:143], v9 offset:53248
  v_mfma_f32_16x16x32_bf16 v[72:75], v[124:127], v[108:111], v[72:75]
  ds_read_b128 v[144:147], v9 offset:55296
  v_mfma_f32_16x16x32_bf16 v[88:91], v[124:127], v[112:115], v[88:91]
  ds_read_b128 v[148:151], v9 offset:57344
  v_mfma_f32_16x16x32_bf16 v[84:87], v[120:123], v[112:115], v[84:87]
  v_mfma_f32_16x16x32_bf16 v[80:83], v[116:119], v[112:115], v[80:83]
  s_waitcnt vmcnt(5) lgkmcnt(0)
  s_barrier
  s_setprio 3
  v_mfma_f32_16x16x32_bf16 v[32:35], v[152:155], v[136:139], v[32:35]
  ds_read_b128 v[100:103], v10 offset:34816
  s_add_u32 m0, s57, 49152
  v_mfma_f32_16x16x32_bf16 v[36:39], v[156:159], v[136:139], v[36:39]
  buffer_load_dwordx4 v168, s[4:7], s50 offen lds
  s_add_u32 s50, s50, s54
  ds_read_b64_tr_b16 v[116:117], v13 offset:32768
  v_mfma_f32_16x16x32_bf16 v[40:43], v[160:163], v[136:139], v[40:43]
  ds_read_b64_tr_b16 v[118:119], v13 offset:34816
  v_mfma_f32_16x16x32_bf16 v[56:59], v[160:163], v[140:143], v[56:59]
  ds_read_b64_tr_b16 v[120:121], v15 offset:32768
  s_add_u32 m0, s58, 49152
  v_mfma_f32_16x16x32_bf16 v[52:55], v[156:159], v[140:143], v[52:55]
  buffer_load_dwordx4 v168, s[4:7], s51 offen lds
  s_add_u32 s51, s51, s54
  ds_read_b64_tr_b16 v[122:123], v15 offset:34816
  v_mfma_f32_16x16x32_bf16 v[48:51], v[152:155], v[140:143], v[48:51]
  ds_read_b64_tr_b16 v[124:125], v174 offset:32768
  s_setprio 2
  v_mfma_f32_16x16x32_bf16 v[64:67], v[152:155], v[144:147], v[64:67]
  ds_read_b64_tr_b16 v[126:127], v174 offset:34816
  s_add_u32 m0, s59, 49152
  v_mfma_f32_16x16x32_bf16 v[68:71], v[156:159], v[144:147], v[68:71]
  buffer_load_dwordx4 v169, s[8:11], s52 offen offset:0 lds
  ds_read_b128 v[104:107], v10 offset:36864
  v_mfma_f32_16x16x32_bf16 v[72:75], v[160:163], v[144:147], v[72:75]
  ds_read_b128 v[108:111], v10 offset:38912
  v_mfma_f32_16x16x32_bf16 v[88:91], v[160:163], v[148:151], v[88:91]
  ds_read_b128 v[112:115], v10 offset:40960
  v_mfma_f32_16x16x32_bf16 v[84:87], v[156:159], v[148:151], v[84:87]
  v_mfma_f32_16x16x32_bf16 v[80:83], v[152:155], v[148:151], v[80:83]
  s_waitcnt lgkmcnt(0)
  s_setprio 1
  v_mfma_f32_16x16x32_bf16 v[32:35], v[116:119], v[100:103], v[32:35]
  ds_read_b128 v[136:139], v11 offset:34816
  s_add_u32 m0, s59, 57216
  v_mfma_f32_16x16x32_bf16 v[36:39], v[120:123], v[100:103], v[36:39]
  buffer_load_dwordx4 v169, s[8:11], s52 offen offset:128 lds
  ds_read_b64_tr_b16 v[152:153], v13 offset:36864
  v_mfma_f32_16x16x32_bf16 v[40:43], v[124:127], v[100:103], v[40:43]
  ds_read_b64_tr_b16 v[154:155], v13 offset:38912
  v_mfma_f32_16x16x32_bf16 v[56:59], v[124:127], v[104:107], v[56:59]
  ds_read_b64_tr_b16 v[156:157], v15 offset:36864
  v_mfma_f32_16x16x32_bf16 v[52:55], v[120:123], v[104:107], v[52:55]
  ds_read_b64_tr_b16 v[158:159], v15 offset:38912
  s_add_u32 m0, s59, 65280
  v_mfma_f32_16x16x32_bf16 v[48:51], v[116:119], v[104:107], v[48:51]
  buffer_load_dwordx4 v169, s[8:11], s52 offen offset:256 lds
  s_add_u32 s52, s52, s55
  ds_read_b64_tr_b16 v[160:161], v174 offset:36864
  s_setprio 0
  v_mfma_f32_16x16x32_bf16 v[64:67], v[116:119], v[108:111], v[64:67]
  ds_read_b64_tr_b16 v[162:163], v174 offset:38912
  v_mfma_f32_16x16x32_bf16 v[68:71], v[120:123], v[108:111], v[68:71]
  ds_read_b128 v[140:143], v11 offset:36864
  v_mfma_f32_16x16x32_bf16 v[72:75], v[124:127], v[108:111], v[72:75]
  ds_read_b128 v[144:147], v11 offset:38912
  v_mfma_f32_16x16x32_bf16 v[88:91], v[124:127], v[112:115], v[88:91]
  ds_read_b128 v[148:151], v11 offset:40960
  v_mfma_f32_16x16x32_bf16 v[84:87], v[120:123], v[112:115], v[84:87]
  v_mfma_f32_16x16x32_bf16 v[80:83], v[116:119], v[112:115], v[80:83]
  s_waitcnt vmcnt(5) lgkmcnt(0)
  s_barrier
  s_setprio 3
  v_mfma_f32_16x16x32_bf16 v[32:35], v[152:155], v[136:139], v[32:35]
  ds_read_b128 v[100:103], v8 offset:2048
  s_add_u32 m0, s57, 98304
  v_mfma_f32_16x16x32_bf16 v[36:39], v[156:159], v[136:139], v[36:39]
  buffer_load_dwordx4 v168, s[4:7], s50 offen lds
  s_add_u32 s50, s50, s54
  ds_read_b64_tr_b16 v[116:117], v12 offset:0
  v_mfma_f32_16x16x32_bf16 v[40:43], v[160:163], v[136:139], v[40:43]
  ds_read_b64_tr_b16 v[118:119], v12 offset:2048
  v_mfma_f32_16x16x32_bf16 v[56:59], v[160:163], v[140:143], v[56:59]
  ds_read_b64_tr_b16 v[120:121], v14 offset:0
  s_add_u32 m0, s58, 98304
  v_mfma_f32_16x16x32_bf16 v[52:55], v[156:159], v[140:143], v[52:55]
  buffer_load_dwordx4 v168, s[4:7], s51 offen lds
  s_add_u32 s51, s51, s54
  ds_read_b64_tr_b16 v[122:123], v14 offset:2048
  v_mfma_f32_16x16x32_bf16 v[48:51], v[152:155], v[140:143], v[48:51]
  ds_read_b64_tr_b16 v[124:125], v173 offset:0
  s_setprio 2
  v_mfma_f32_16x16x32_bf16 v[64:67], v[152:155], v[144:147], v[64:67]
  ds_read_b64_tr_b16 v[126:127], v173 offset:2048
  s_add_u32 m0, s59, 98304
  v_mfma_f32_16x16x32_bf16 v[68:71], v[156:159], v[144:147], v[68:71]
  buffer_load_dwordx4 v169, s[8:11], s52 offen offset:0 lds
  ds_read_b128 v[104:107], v8 offset:4096
  v_mfma_f32_16x16x32_bf16 v[72:75], v[160:163], v[144:147], v[72:75]
  ds_read_b128 v[108:111], v8 offset:6144
  v_mfma_f32_16x16x32_bf16 v[88:91], v[160:163], v[148:151], v[88:91]
  ds_read_b128 v[112:115], v8 offset:8192
  v_mfma_f32_16x16x32_bf16 v[84:87], v[156:159], v[148:151], v[84:87]
  v_mfma_f32_16x16x32_bf16 v[80:83], v[152:155], v[148:151], v[80:83]
  s_waitcnt lgkmcnt(0)
  s_setprio 1
  v_mfma_f32_16x16x32_bf16 v[32:35], v[116:119], v[100:103], v[32:35]
  ds_read_b128 v[136:139], v9 offset:2048
  s_add_u32 m0, s59, 106368
  v_mfma_f32_16x16x32_bf16 v[36:39], v[120:123], v[100:103], v[36:39]
  buffer_load_dwordx4 v169, s[8:11], s52 offen offset:128 lds
  ds_read_b64_tr_b16 v[152:153], v12 offset:4096
  v_mfma_f32_16x16x32_bf16 v[40:43], v[124:127], v[100:103], v[40:43]
  ds_read_b64_tr_b16 v[154:155], v12 offset:6144
  v_mfma_f32_16x16x32_bf16 v[56:59], v[124:127], v[104:107], v[56:59]
  ds_read_b64_tr_b16 v[156:157], v14 offset:4096
  v_mfma_f32_16x16x32_bf16 v[52:55], v[120:123], v[104:107], v[52:55]
  ds_read_b64_tr_b16 v[158:159], v14 offset:6144
  s_add_u32 m0, s59, 114432
  v_mfma_f32_16x16x32_bf16 v[48:51], v[116:119], v[104:107], v[48:51]
  buffer_load_dwordx4 v169, s[8:11], s52 offen offset:256 lds
  s_add_u32 s52, s52, s55
  ds_read_b64_tr_b16 v[160:161], v173 offset:4096
  s_setprio 0
  v_mfma_f32_16x16x32_bf16 v[64:67], v[116:119], v[108:111], v[64:67]
  ds_read_b64_tr_b16 v[162:163], v173 offset:6144
  v_mfma_f32_16x16x32_bf16 v[68:71], v[120:123], v[108:111], v[68:71]
  ds_read_b128 v[140:143], v9 offset:4096
  v_mfma_f32_16x16x32_bf16 v[72:75], v[124:127], v[108:111], v[72:75]
  ds_read_b128 v[144:147], v9 offset:6144
  v_mfma_f32_16x16x32_bf16 v[88:91], v[124:127], v[112:115], v[88:91]
  ds_read_b128 v[148:151], v9 offset:8192
  v_mfma_f32_16x16x32_bf16 v[84:87], v[120:123], v[112:115], v[84:87]
  v_mfma_f32_16x16x32_bf16 v[80:83], v[116:119], v[112:115], v[80:83]
  s_waitcnt vmcnt(5) lgkmcnt(0)
  s_barrier
  s_setprio 3
  v_mfma_f32_16x16x32_bf16 v[32:35], v[152:155], v[136:139], v[32:35]
  ds_read_b128 v[100:103], v8 offset:51200
  s_add_u32 m0, s57, 0
  v_mfma_f32_16x16x32_bf16 v[36:39], v[156:159], v[136:139], v[36:39]
  buffer_load_dwordx4 v168, s[4:7], s50 offen lds
  s_add_u32 s50, s50, s54
  ds_read_b64_tr_b16 v[116:117], v12 offset:49152
  v_mfma_f32_16x16x32_bf16 v[40:43], v[160:163], v[136:139], v[40:43]
  ds_read_b64_tr_b16 v[118:119], v12 offset:51200
  v_mfma_f32_16x16x32_bf16 v[56:59], v[160:163], v[140:143], v[56:59]
  ds_read_b64_tr_b16 v[120:121], v14 offset:49152
  s_add_u32 m0, s58, 0
  v_mfma_f32_16x16x32_bf16 v[52:55], v[156:159], v[140:143], v[52:55]
  buffer_load_dwordx4 v168, s[4:7], s51 offen lds
  s_add_u32 s51, s51, s54
  ds_read_b64_tr_b16 v[122:123], v14 offset:51200
  v_mfma_f32_16x16x32_bf16 v[48:51], v[152:155], v[140:143], v[48:51]
  ds_read_b64_tr_b16 v[124:125], v173 offset:49152
  s_setprio 2
  v_mfma_f32_16x16x32_bf16 v[64:67], v[152:155], v[144:147], v[64:67]
  ds_read_b64_tr_b16 v[126:127], v173 offset:51200
  s_add_u32 m0, s59, 0
  v_mfma_f32_16x16x32_bf16 v[68:71], v[156:159], v[144:147], v[68:71]
  buffer_load_dwordx4 v169, s[8:11], s52 offen offset:0 lds
  ds_read_b128 v[104:107], v8 offset:53248
  v_mfma_f32_16x16x32_bf16 v[72:75], v[160:163], v[144:147], v[72:75]
  ds_read_b128 v[108:111], v8 offset:55296
  v_mfma_f32_16x16x32_bf16 v[88:91], v[160:163], v[148:151], v[88:91]
  ds_read_b128 v[112:115], v8 offset:57344
  v_mfma_f32_16x16x32_bf16 v[84:87], v[156:159], v[148:151], v[84:87]
  v_mfma_f32_16x16x32_bf16 v[80:83], v[152:155], v[148:151], v[80:83]
  s_waitcnt lgkmcnt(0)
  s_setprio 1
  v_mfma_f32_16x16x32_bf16 v[32:35], v[116:119], v[100:103], v[32:35]
  ds_read_b128 v[136:139], v9 offset:51200
  s_add_u32 m0, s59, 8064
  v_mfma_f32_16x16x32_bf16 v[36:39], v[120:123], v[100:103], v[36:39]
  buffer_load_dwordx4 v169, s[8:11], s52 offen offset:128 lds
  ds_read_b64_tr_b16 v[152:153], v12 offset:53248
  v_mfma_f32_16x16x32_bf16 v[40:43], v[124:127], v[100:103], v[40:43]
  ds_read_b64_tr_b16 v[154:155], v12 offset:55296
  v_mfma_f32_16x16x32_bf16 v[56:59], v[124:127], v[104:107], v[56:59]
  ds_read_b64_tr_b16 v[156:157], v14 offset:53248
  v_mfma_f32_16x16x32_bf16 v[52:55], v[120:123], v[104:107], v[52:55]
  ds_read_b64_tr_b16 v[158:159], v14 offset:55296
  s_add_u32 m0, s59, 16128
  v_mfma_f32_16x16x32_bf16 v[48:51], v[116:119], v[104:107], v[48:51]
  buffer_load_dwordx4 v169, s[8:11], s52 offen offset:256 lds
  s_add_u32 s52, s52, s55
  ds_read_b64_tr_b16 v[160:161], v173 offset:53248
  s_setprio 0
  v_mfma_f32_16x16x32_bf16 v[64:67], v[116:119], v[108:111], v[64:67]
  ds_read_b64_tr_b16 v[162:163], v173 offset:55296
  v_mfma_f32_16x16x32_bf16 v[68:71], v[120:123], v[108:111], v[68:71]
  ds_read_b128 v[140:143], v9 offset:53248
  v_mfma_f32_16x16x32_bf16 v[72:75], v[124:127], v[108:111], v[72:75]
  ds_read_b128 v[144:147], v9 offset:55296
  v_mfma_f32_16x16x32_bf16 v[88:91], v[124:127], v[112:115], v[88:91]
  ds_read_b128 v[148:151], v9 offset:57344
  v_mfma_f32_16x16x32_bf16 v[84:87], v[120:123], v[112:115], v[84:87]
  v_mfma_f32_16x16x32_bf16 v[80:83], v[116:119], v[112:115], v[80:83]
  s_waitcnt vmcnt(5) lgkmcnt(0)
  s_barrier
  s_setprio 3
  v_mfma_f32_16x16x32_bf16 v[32:35], v[152:155], v[136:139], v[32:35]
  ds_read_b128 v[100:103], v10 offset:34816
  s_add_u32 m0, s57, 49152
  v_mfma_f32_16x16x32_bf16 v[36:39], v[156:159], v[136:139], v[36:39]
  buffer_load_dwordx4 v168, s[4:7], s50 offen lds
  s_add_u32 s50, s50, s54
  ds_read_b64_tr_b16 v[116:117], v13 offset:32768
  v_mfma_f32_16x16x32_bf16 v[40:43], v[160:163], v[136:139], v[40:43]
  ds_read_b64_tr_b16 v[118:119], v13 offset:34816
  v_mfma_f32_16x16x32_bf16 v[56:59], v[160:163], v[140:143], v[56:59]
  ds_read_b64_tr_b16 v[120:121], v15 offset:32768
  s_add_u32 m0, s58, 49152
  v_mfma_f32_16x16x32_bf16 v[52:55], v[156:159], v[140:143], v[52:55]
  buffer_load_dwordx4 v168, s[4:7], s51 offen lds
  s_add_u32 s51, s51, s54
  ds_read_b64_tr_b16 v[122:123], v15 offset:34816
  v_mfma_f32_16x16x32_bf16 v[48:51], v[152:155], v[140:143], v[48:51]
  ds_read_b64_tr_b16 v[124:125], v174 offset:32768
  s_setprio 2
  v_mfma_f32_16x16x32_bf16 v[64:67], v[152:155], v[144:147], v[64:67]
  ds_read_b64_tr_b16 v[126:127], v174 offset:34816
  s_add_u32 m0, s59, 49152
  v_mfma_f32_16x16x32_bf16 v[68:71], v[156:159], v[144:147], v[68:71]
  buffer_load_dwordx4 v169, s[8:11], s52 offen offset:0 lds
  ds_read_b128 v[104:107], v10 offset:36864
  v_mfma_f32_16x16x32_bf16 v[72:75], v[160:163], v[144:147], v[72:75]
  ds_read_b128 v[108:111], v10 offset:38912
  v_mfma_f32_16x16x32_bf16 v[88:91], v[160:163], v[148:151], v[88:91]
  ds_read_b128 v[112:115], v10 offset:40960
  v_mfma_f32_16x16x32_bf16 v[84:87], v[156:159], v[148:151], v[84:87]
  v_mfma_f32_16x16x32_bf16 v[80:83], v[152:155], v[148:151], v[80:83]
  s_waitcnt lgkmcnt(0)
  s_setprio 1
  v_mfma_f32_16x16x32_bf16 v[32:35], v[116:119], v[100:103], v[32:35]
  ds_read_b128 v[136:139], v11 offset:34816
  s_add_u32 m0, s59, 57216
  v_mfma_f32_16x16x32_bf16 v[36:39], v[120:123], v[100:103], v[36:39]
  buffer_load_dwordx4 v169, s[8:11], s52 offen offset:128 lds
  ds_read_b64_tr_b16 v[152:153], v13 offset:36864
  v_mfma_f32_16x16x32_bf16 v[40:43], v[124:127], v[100:103], v[40:43]
  ds_read_b64_tr_b16 v[154:155], v13 offset:38912
  v_mfma_f32_16x16x32_bf16 v[56:59], v[124:127], v[104:107], v[56:59]
  ds_read_b64_tr_b16 v[156:157], v15 offset:36864
  v_mfma_f32_16x16x32_bf16 v[52:55], v[120:123], v[104:107], v[52:55]
  ds_read_b64_tr_b16 v[158:159], v15 offset:38912
  s_add_u32 m0, s59, 65280
  v_mfma_f32_16x16x32_bf16 v[48:51], v[116:119], v[104:107], v[48:51]
  buffer_load_dwordx4 v169, s[8:11], s52 offen offset:256 lds
  s_add_u32 s52, s52, s55
  ds_read_b64_tr_b16 v[160:161], v174 offset:36864
  s_setprio 0
  v_mfma_f32_16x16x32_bf16 v[64:67], v[116:119], v[108:111], v[64:67]
  ds_read_b64_tr_b16 v[162:163], v174 offset:38912
  v_mfma_f32_16x16x32_bf16 v[68:71], v[120:123], v[108:111], v[68:71]
  ds_read_b128 v[140:143], v11 offset:36864
  v_mfma_f32_16x16x32_bf16 v[72:75], v[124:127], v[108:111], v[72:75]
  ds_read_b128 v[144:147], v11 offset:38912
  v_mfma_f32_16x16x32_bf16 v[88:91], v[124:127], v[112:115], v[88:91]
  ds_read_b128 v[148:151], v11 offset:40960
  v_mfma_f32_16x16x32_bf16 v[84:87], v[120:123], v[112:115], v[84:87]
  v_mfma_f32_16x16x32_bf16 v[80:83], v[116:119], v[112:115], v[80:83]
  s_waitcnt vmcnt(5) lgkmcnt(0)
  s_barrier
  s_setprio 3
  v_mfma_f32_16x16x32_bf16 v[32:35], v[152:155], v[136:139], v[32:35]
  ds_read_b128 v[100:103], v8 offset:2048
  s_add_u32 m0, s57, 98304
  v_mfma_f32_16x16x32_bf16 v[36:39], v[156:159], v[136:139], v[36:39]
  buffer_load_dwordx4 v168, s[4:7], s50 offen lds
  s_add_u32 s50, s50, s54
  ds_read_b64_tr_b16 v[116:117], v12 offset:0
  v_mfma_f32_16x16x32_bf16 v[40:43], v[160:163], v[136:139], v[40:43]
  ds_read_b64_tr_b16 v[118:119], v12 offset:2048
  v_mfma_f32_16x16x32_bf16 v[56:59], v[160:163], v[140:143], v[56:59]
  ds_read_b64_tr_b16 v[120:121], v14 offset:0
  s_add_u32 m0, s58, 98304
  v_mfma_f32_16x16x32_bf16 v[52:55], v[156:159], v[140:143], v[52:55]
  buffer_load_dwordx4 v168, s[4:7], s51 offen lds
  s_add_u32 s51, s51, s54
  ds_read_b64_tr_b16 v[122:123], v14 offset:2048
  v_mfma_f32_16x16x32_bf16 v[48:51], v[152:155], v[140:143], v[48:51]
  ds_read_b64_tr_b16 v[124:125], v173 offset:0
  s_setprio 2
  v_mfma_f32_16x16x32_bf16 v[64:67], v[152:155], v[144:147], v[64:67]
  ds_read_b64_tr_b16 v[126:127], v173 offset:2048
  s_add_u32 m0, s59, 98304
  v_mfma_f32_16x16x32_bf16 v[68:71], v[156:159], v[144:147], v[68:71]
  buffer_load_dwordx4 v169, s[8:11], s52 offen offset:0 lds
  ds_read_b128 v[104:107], v8 offset:4096
  v_mfma_f32_16x16x32_bf16 v[72:75], v[160:163], v[144:147], v[72:75]
  ds_read_b128 v[108:111], v8 offset:6144
  v_mfma_f32_16x16x32_bf16 v[88:91], v[160:163], v[148:151], v[88:91]
  ds_read_b128 v[112:115], v8 offset:8192
  v_mfma_f32_16x16x32_bf16 v[84:87], v[156:159], v[148:151], v[84:87]
  v_mfma_f32_16x16x32_bf16 v[80:83], v[152:155], v[148:151], v[80:83]
  s_waitcnt lgkmcnt(0)
  s_setprio 1
  v_mfma_f32_16x16x32_bf16 v[32:35], v[116:119], v[100:103], v[32:35]
  ds_read_b128 v[136:139], v9 offset:2048
  s_add_u32 m0, s59, 106368
  v_mfma_f32_16x16x32_bf16 v[36:39], v[120:123], v[100:103], v[36:39]
  buffer_load_dwordx4 v169, s[8:11], s52 offen offset:128 lds
  ds_read_b64_tr_b16 v[152:153], v12 offset:4096
  v_mfma_f32_16x16x32_bf16 v[40:43], v[124:127], v[100:103], v[40:43]
  ds_read_b64_tr_b16 v[154:155], v12 offset:6144
  v_mfma_f32_16x16x32_bf16 v[56:59], v[124:127], v[104:107], v[56:59]
  ds_read_b64_tr_b16 v[156:157], v14 offset:4096
  v_mfma_f32_16x16x32_bf16 v[52:55], v[120:123], v[104:107], v[52:55]
  ds_read_b64_tr_b16 v[158:159], v14 offset:6144
  s_add_u32 m0, s59, 114432
  v_mfma_f32_16x16x32_bf16 v[48:51], v[116:119], v[104:107], v[48:51]
  buffer_load_dwordx4 v169, s[8:11], s52 offen offset:256 lds
  s_add_u32 s52, s52, s55
  ds_read_b64_tr_b16 v[160:161], v173 offset:4096
  s_setprio 0
  v_mfma_f32_16x16x32_bf16 v[64:67], v[116:119], v[108:111], v[64:67]
  ds_read_b64_tr_b16 v[162:163], v173 offset:6144
  v_mfma_f32_16x16x32_bf16 v[68:71], v[120:123], v[108:111], v[68:71]
  ds_read_b128 v[140:143], v9 offset:4096
  v_mfma_f32_16x16x32_bf16 v[72:75], v[124:127], v[108:111], v[72:75]
  ds_read_b128 v[144:147], v9 offset:6144
  v_mfma_f32_16x16x32_bf16 v[88:91], v[124:127], v[112:115], v[88:91]
  ds_read_b128 v[148:151], v9 offset:8192
  v_mfma_f32_16x16x32_bf16 v[84:87], v[120:123], v[112:115], v[84:87]
  v_mfma_f32_16x16x32_bf16 v[80:83], v[116:119], v[112:115], v[80:83]
  s_waitcnt vmcnt(5) lgkmcnt(0)
  s_barrier
  s_setprio 3
  v_mfma_f32_16x16x32_bf16 v[32:35], v[152:155], v[136:139], v[32:35]
  ds_read_b128 v[100:103], v8 offset:51200
  v_mfma_f32_16x16x32_bf16 v[36:39], v[156:159], v[136:139], v[36:39]
  buffer_load_dwordx4 v[226:229], v222, s[16:19], 0 offen sc1
  ds_read_b64_tr_b16 v[116:117], v12 offset:49152
  v_mfma_f32_16x16x32_bf16 v[40:43], v[160:163], v[136:139], v[40:43]
  ds_read_b64_tr_b16 v[118:119], v12 offset:51200
  v_mfma_f32_16x16x32_bf16 v[56:59], v[160:163], v[140:143], v[56:59]
  ds_read_b64_tr_b16 v[120:121], v14 offset:49152
  s_add_u32 m0, s57, 0
  v_mfma_f32_16x16x32_bf16 v[52:55], v[156:159], v[140:143], v[52:55]
  buffer_load_dwordx4 v168, s[4:7], s50 offen lds
  ds_read_b64_tr_b16 v[122:123], v14 offset:51200
  v_mfma_f32_16x16x32_bf16 v[48:51], v[152:155], v[140:143], v[48:51]
  ds_read_b64_tr_b16 v[124:125], v173 offset:49152
  s_setprio 2
  v_mfma_f32_16x16x32_bf16 v[64:67], v[152:155], v[144:147], v[64:67]
  ds_read_b64_tr_b16 v[126:127], v173 offset:51200
  s_add_u32 m0, s58, 0
  v_mfma_f32_16x16x32_bf16 v[68:71], v[156:159], v[144:147], v[68:71]
  buffer_load_dwordx4 v168, s[4:7], s51 offen lds
  ds_read_b128 v[104:107], v8 offset:53248
  v_mfma_f32_16x16x32_bf16 v[72:75], v[160:163], v[144:147], v[72:75]
  ds_read_b128 v[108:111], v8 offset:55296
  v_mfma_f32_16x16x32_bf16 v[88:91], v[160:163], v[148:151], v[88:91]
  ds_read_b128 v[112:115], v8 offset:57344
  v_mfma_f32_16x16x32_bf16 v[84:87], v[156:159], v[148:151], v[84:87]
  v_mfma_f32_16x16x32_bf16 v[80:83], v[152:155], v[148:151], v[80:83]
  s_waitcnt lgkmcnt(0)
  s_setprio 1
  v_mfma_f32_16x16x32_bf16 v[32:35], v[116:119], v[100:103], v[32:35]
  ds_read_b128 v[136:139], v9 offset:51200
  s_add_u32 m0, s59, 0
  v_mfma_f32_16x16x32_bf16 v[36:39], v[120:123], v[100:103], v[36:39]
  buffer_load_dwordx4 v169, s[8:11], s52 offen offset:0 lds
  ds_read_b64_tr_b16 v[152:153], v12 offset:53248
  v_mfma_f32_16x16x32_bf16 v[40:43], v[124:127], v[100:103], v[40:43]
  ds_read_b64_tr_b16 v[154:155], v12 offset:55296
  s_add_u32 m0, s59, 8064
  v_mfma_f32_16x16x32_bf16 v[56:59], v[124:127], v[104:107], v[56:59]
  buffer_load_dwordx4 v169, s[8:11], s52 offen offset:128 lds
  ds_read_b64_tr_b16 v[156:157], v14 offset:53248
  v_mfma_f32_16x16x32_bf16 v[52:55], v[120:123], v[104:107], v[52:55]
  ds_read_b64_tr_b16 v[158:159], v14 offset:55296
  v_mfma_f32_16x16x32_bf16 v[48:51], v[116:119], v[104:107], v[48:51]
  ds_read_b64_tr_b16 v[160:161], v173 offset:53248
  s_add_u32 m0, s59, 16128
  s_setprio 0
  v_mfma_f32_16x16x32_bf16 v[64:67], v[116:119], v[108:111], v[64:67]
  buffer_load_dwordx4 v169, s[8:11], s52 offen offset:256 lds
  ds_read_b64_tr_b16 v[162:163], v173 offset:55296
  v_mfma_f32_16x16x32_bf16 v[68:71], v[120:123], v[108:111], v[68:71]
  ds_read_b128 v[140:143], v9 offset:53248
  v_mfma_f32_16x16x32_bf16 v[72:75], v[124:127], v[108:111], v[72:75]
  ds_read_b128 v[144:147], v9 offset:55296
  v_mfma_f32_16x16x32_bf16 v[88:91], v[124:127], v[112:115], v[88:91]
  ds_read_b128 v[148:151], v9 offset:57344
  v_mfma_f32_16x16x32_bf16 v[84:87], v[120:123], v[112:115], v[84:87]
  v_mfma_f32_16x16x32_bf16 v[80:83], v[116:119], v[112:115], v[80:83]
  s_waitcnt vmcnt(6) lgkmcnt(0)
  s_barrier
  s_setprio 3
  v_mfma_f32_16x16x32_bf16 v[32:35], v[152:155], v[136:139], v[32:35]
  ds_read_b128 v[100:103], v10 offset:34816
  s_add_u32 m0, s74, 49152
  s_add_u32 s86, s71, 40960
  v_mfma_f32_16x16x32_bf16 v[36:39], v[156:159], v[136:139], v[36:39]
  buffer_load_dwordx4 v3, s[40:43], s86 offen lds
  ds_read_b64_tr_b16 v[116:117], v13 offset:32768
  v_mfma_f32_16x16x32_bf16 v[40:43], v[160:163], v[136:139], v[40:43]
  ds_read_b64_tr_b16 v[118:119], v13 offset:34816
  v_mfma_f32_16x16x32_bf16 v[56:59], v[160:163], v[140:143], v[56:59]
  ds_read_b64_tr_b16 v[120:121], v15 offset:32768
  s_add_u32 m0, s74, 50176
  s_add_u32 s86, s71, 102400
  v_mfma_f32_16x16x32_bf16 v[52:55], v[156:159], v[140:143], v[52:55]
  buffer_load_dwordx4 v3, s[40:43], s86 offen lds
  ds_read_b64_tr_b16 v[122:123], v15 offset:34816
  v_mfma_f32_16x16x32_bf16 v[48:51], v[152:155], v[140:143], v[48:51]
  ds_read_b64_tr_b16 v[124:125], v174 offset:32768
  s_setprio 2
  v_mfma_f32_16x16x32_bf16 v[64:67], v[152:155], v[144:147], v[64:67]
  ds_read_b64_tr_b16 v[126:127], v174 offset:34816
  s_add_u32 m0, s74, 65536
  s_add_u32 s86, s71, 51200
  v_mfma_f32_16x16x32_bf16 v[68:71], v[156:159], v[144:147], v[68:71]
  buffer_load_dwordx4 v3, s[40:43], s86 offen lds
  ds_read_b128 v[104:107], v10 offset:36864
  v_mfma_f32_16x16x32_bf16 v[72:75], v[160:163], v[144:147], v[72:75]
  ds_read_b128 v[108:111], v10 offset:38912
  v_mfma_f32_16x16x32_bf16 v[88:91], v[160:163], v[148:151], v[88:91]
  ds_read_b128 v[112:115], v10 offset:40960
  v_mfma_f32_16x16x32_bf16 v[84:87], v[156:159], v[148:151], v[84:87]
  v_mfma_f32_16x16x32_bf16 v[80:83], v[152:155], v[148:151], v[80:83]
  s_waitcnt lgkmcnt(0)
  s_setprio 1
  v_mfma_f32_16x16x32_bf16 v[32:35], v[116:119], v[100:103], v[32:35]
  ds_read_b128 v[136:139], v11 offset:34816
  s_add_u32 m0, s74, 66560
  s_add_u32 s86, s71, 112640
  v_mfma_f32_16x16x32_bf16 v[36:39], v[120:123], v[100:103], v[36:39]
  buffer_load_dwordx4 v3, s[40:43], s86 offen lds
  ds_read_b64_tr_b16 v[152:153], v13 offset:36864
  v_mfma_f32_16x16x32_bf16 v[40:43], v[124:127], v[100:103], v[40:43]
  ds_read_b64_tr_b16 v[154:155], v13 offset:38912
  s_add_u32 m0, s74, 81920
  s_add_u32 s86, s71, 163840
  v_mfma_f32_16x16x32_bf16 v[56:59], v[124:127], v[104:107], v[56:59]
  buffer_load_dwordx4 v3, s[40:43], s86 offen lds
  ds_read_b64_tr_b16 v[156:157], v15 offset:36864
  v_mfma_f32_16x16x32_bf16 v[52:55], v[120:123], v[104:107], v[52:55]
  ds_read_b64_tr_b16 v[158:159], v15 offset:38912
  v_mfma_f32_16x16x32_bf16 v[48:51], v[116:119], v[104:107], v[48:51]
  ds_read_b64_tr_b16 v[160:161], v174 offset:36864
  s_add_u32 m0, s74, 82944
  s_add_u32 s86, s71, 225280
  s_setprio 0
  v_mfma_f32_16x16x32_bf16 v[64:67], v[116:119], v[108:111], v[64:67]
  buffer_load_dwordx4 v3, s[40:43], s86 offen lds
  ds_read_b64_tr_b16 v[162:163], v174 offset:38912
  v_mfma_f32_16x16x32_bf16 v[68:71], v[120:123], v[108:111], v[68:71]
  ds_read_b128 v[140:143], v11 offset:36864
  v_mfma_f32_16x16x32_bf16 v[72:75], v[124:127], v[108:111], v[72:75]
  ds_read_b128 v[144:147], v11 offset:38912
  v_mfma_f32_16x16x32_bf16 v[88:91], v[124:127], v[112:115], v[88:91]
  ds_read_b128 v[148:151], v11 offset:40960
  v_mfma_f32_16x16x32_bf16 v[84:87], v[120:123], v[112:115], v[84:87]
  v_mfma_f32_16x16x32_bf16 v[80:83], v[116:119], v[112:115], v[80:83]
  s_waitcnt vmcnt(6) lgkmcnt(0)
  s_barrier
  s_setprio 3
  v_mfma_f32_16x16x32_bf16 v[32:35], v[152:155], v[136:139], v[32:35]
  ds_read_b128 v[100:103], v8 offset:2048
  s_waitcnt vmcnt(11)
  v_cmp_ne_u32 vcc, s70, v227
  v_cmp_ne_u32 s[88:89], s70, v229
  s_nop 1
  s_or_b64 vcc, vcc, s[88:89]
  s_cbranch_vccnz L_slow_34
L_back_35:
  s_add_u32 m0, s74, 98304
  s_add_u32 s86, s71, 174080
  v_mfma_f32_16x16x32_bf16 v[36:39], v[156:159], v[136:139], v[36:39]
  buffer_load_dwordx4 v3, s[40:43], s86 offen lds
  ds_read_b64_tr_b16 v[116:117], v12 offset:0
  ds_write_b32 v224, v228
  v_fmac_f32 v226, v225, v228
  v_mfma_f32_16x16x32_bf16 v[40:43], v[160:163], v[136:139], v[40:43]
  ds_read_b64_tr_b16 v[118:119], v12 offset:2048
  ds_write_b32 v223, v226
  v_mfma_f32_16x16x32_bf16 v[56:59], v[160:163], v[140:143], v[56:59]
  ds_read_b64_tr_b16 v[120:121], v14 offset:0
  s_add_u32 m0, s74, 99328
  s_add_u32 s86, s71, 235520
  v_mfma_f32_16x16x32_bf16 v[52:55], v[156:159], v[140:143], v[52:55]
  buffer_load_dwordx4 v3, s[40:43], s86 offen lds
  ds_read_b64_tr_b16 v[122:123], v14 offset:2048
  v_mfma_f32_16x16x32_bf16 v[48:51], v[152:155], v[140:143], v[48:51]
  ds_read_b64_tr_b16 v[124:125], v173 offset:0
  s_setprio 2
  v_mfma_f32_16x16x32_bf16 v[64:67], v[152:155], v[144:147], v[64:67]
  ds_read_b64_tr_b16 v[126:127], v173 offset:2048
  s_add_u32 m0, s74, 114688
  s_add_u32 s86, s71, 0
  v_mfma_f32_16x16x32_bf16 v[68:71], v[156:159], v[144:147], v[68:71]
  buffer_load_dwordx4 v3, s[40:43], s86 offen lds
  ds_read_b128 v[104:107], v8 offset:4096
  v_mfma_f32_16x16x32_bf16 v[72:75], v[160:163], v[144:147], v[72:75]
  ds_read_b128 v[108:111], v8 offset:6144
  v_mfma_f32_16x16x32_bf16 v[88:91], v[160:163], v[148:151], v[88:91]
  ds_read_b128 v[112:115], v8 offset:8192
  v_mfma_f32_16x16x32_bf16 v[84:87], v[156:159], v[148:151], v[84:87]
  v_mfma_f32_16x16x32_bf16 v[80:83], v[152:155], v[148:151], v[80:83]
  s_waitcnt lgkmcnt(0)
  s_setprio 1
  v_mfma_f32_16x16x32_bf16 v[32:35], v[116:119], v[100:103], v[32:35]
  ds_read_b128 v[136:139], v9 offset:2048
  s_add_u32 m0, s74, 115712
  s_add_u32 s86, s71, 10240
  v_mfma_f32_16x16x32_bf16 v[36:39], v[120:123], v[100:103], v[36:39]
  buffer_load_dwordx4 v3, s[40:43], s86 offen lds
  ds_read_b64_tr_b16 v[152:153], v12 offset:4096
  v_mfma_f32_16x16x32_bf16 v[40:43], v[124:127], v[100:103], v[40:43]
  ds_read_b64_tr_b16 v[154:155], v12 offset:6144
  s_add_u32 m0, s74, 131072
  s_add_u32 s86, s71, 20480
  v_mfma_f32_16x16x32_bf16 v[56:59], v[124:127], v[104:107], v[56:59]
  buffer_load_dwordx4 v3, s[40:43], s86 offen lds
  ds_read_b64_tr_b16 v[156:157], v14 offset:4096
  v_mfma_f32_16x16x32_bf16 v[52:55], v[120:123], v[104:107], v[52:55]
  ds_read_b64_tr_b16 v[158:159], v14 offset:6144
  v_mfma_f32_16x16x32_bf16 v[48:51], v[116:119], v[104:107], v[48:51]
  ds_read_b64_tr_b16 v[160:161], v173 offset:4096
  s_add_u32 m0, s74, 132096
  s_add_u32 s86, s71, 30720
  s_setprio 0
  v_mfma_f32_16x16x32_bf16 v[64:67], v[116:119], v[108:111], v[64:67]
  buffer_load_dwordx4 v3, s[40:43], s86 offen lds
  ds_read_b64_tr_b16 v[162:163], v173 offset:6144
  v_mfma_f32_16x16x32_bf16 v[68:71], v[120:123], v[108:111], v[68:71]
  ds_read_b128 v[140:143], v9 offset:4096
  v_mfma_f32_16x16x32_bf16 v[72:75], v[124:127], v[108:111], v[72:75]
  ds_read_b128 v[144:147], v9 offset:6144
  v_mfma_f32_16x16x32_bf16 v[88:91], v[124:127], v[112:115], v[88:91]
  ds_read_b128 v[148:151], v9 offset:8192
  v_mfma_f32_16x16x32_bf16 v[84:87], v[120:123], v[112:115], v[84:87]
  v_mfma_f32_16x16x32_bf16 v[80:83], v[116:119], v[112:115], v[80:83]
  s_waitcnt lgkmcnt(0)
  s_barrier
  s_setprio 1
  v_mfma_f32_16x16x32_bf16 v[32:35], v[152:155], v[136:139], v[32:35]
  s_lshl_b32 s86, s66, 8
  s_add_u32 s86, s86, 147520
  v_lshl_add_u32 v14, v6, 2, s86
  s_lshl_b32 s86, s67, 8
  s_add_u32 s86, s86, 148736
  v_lshl_add_u32 v15, v5, 4, s86
  s_add_u32 m0, s74, 0
  s_add_u32 s86, s71, 61440
  v_mfma_f32_16x16x32_bf16 v[36:39], v[156:159], v[136:139], v[36:39]
  buffer_load_dwordx4 v3, s[40:43], s86 offen lds
  ds_read2_b32 v[96:97], v14 offset0:0 offset1:160
  ds_read2_b32 v[98:99], v14 offset0:16 offset1:176
  v_mfma_f32_16x16x32_bf16 v[40:43], v[160:163], v[136:139], v[40:43]
  ds_read2_b32 v[100:101], v14 offset0:32 offset1:192
  ds_read2_b32 v[102:103], v14 offset0:48 offset1:208
  s_add_u32 m0, s74, 1024
  s_add_u32 s86, s71, 71680
  v_mfma_f32_16x16x32_bf16 v[56:59], v[160:163], v[140:143], v[56:59]
  buffer_load_dwordx4 v3, s[40:43], s86 offen lds
  ds_read_b128 v[104:107], v15 offset:0
  ds_read_b128 v[108:111], v15 offset:64
  v_mfma_f32_16x16x32_bf16 v[52:55], v[156:159], v[140:143], v[52:55]
  ds_read_b128 v[112:115], v15 offset:128
  v_add_u32 v8, 49152, v7
  v_xor_b32 v9, 32, v8
  v_mfma_f32_16x16x32_bf16 v[48:51], v[152:155], v[140:143], v[48:51]
  v_xor_b32 v10, 64, v8
  v_xor_b32 v11, 0x60, v8
  s_add_u32 m0, s74, 16384
  s_add_u32 s86, s71, 81920
  s_setprio 0
  v_mfma_f32_16x16x32_bf16 v[64:67], v[152:155], v[144:147], v[64:67]
  buffer_load_dwordx4 v3, s[40:43], s86 offen lds
  s_waitcnt vmcnt(13)
  ds_read_b64_tr_b16 v[176:177], v8 offset:0
  ds_read_b64_tr_b16 v[180:181], v9 offset:0
  v_mfma_f32_16x16x32_bf16 v[68:71], v[156:159], v[144:147], v[68:71]
  ds_read_b64_tr_b16 v[184:185], v10 offset:0
  ds_read_b64_tr_b16 v[188:189], v11 offset:0
  s_add_u32 m0, s74, 17408
  s_add_u32 s86, s71, 92160
  v_mfma_f32_16x16x32_bf16 v[72:75], v[160:163], v[144:147], v[72:75]
  buffer_load_dwordx4 v3, s[40:43], s86 offen lds
  s_waitcnt vmcnt(12)
  ds_read_b64_tr_b16 v[178:179], v8 offset:16384
  ds_read_b64_tr_b16 v[182:183], v9 offset:16384
  v_mfma_f32_16x16x32_bf16 v[88:91], v[160:163], v[148:151], v[88:91]
  ds_read_b64_tr_b16 v[186:187], v10 offset:16384
  ds_read_b64_tr_b16 v[190:191], v11 offset:16384
  v_mfma_f32_16x16x32_bf16 v[84:87], v[156:159], v[148:151], v[84:87]
  s_waitcnt vmcnt(10)
  ds_read_b64_tr_b16 v[192:193], v8 offset:32768
  ds_read_b64_tr_b16 v[196:197], v9 offset:32768
  v_mfma_f32_16x16x32_bf16 v[80:83], v[152:155], v[148:151], v[80:83]
  ds_read_b64_tr_b16 v[200:201], v10 offset:32768
  ds_read_b64_tr_b16 v[204:205], v11 offset:32768
  v_and_b32 v174, 31, v1
  v_lshlrev_b32 v174, 4, v174
  v_lshrrev_b32 v175, 5, v1
  s_mov_b32 s81, 73728
  v_mad_u32_u24 v174, v175, s81, v174
  s_lshl_b32 s81, s64, 1
  s_add_u32 s81, s81, s66
  s_lshl_b32 s81, s81, 5
  s_add_u32 s81, s81, s65
  s_mul_i32 s81, s81, 9216
  s_lshl_b32 s82, s67, 10
  s_waitcnt lgkmcnt(8)
  s_add_u32 m0, s74, 49152
  s_add_u32 s86, s71, 122880
  buffer_load_dwordx4 v3, s[40:43], s86 offen lds
  s_add_u32 s82, s82, s81
  s_add_u32 s82, s82, 2048
  s_lshl_b32 s83, s67, 9
  s_add_u32 s83, s83, s81
  s_waitcnt lgkmcnt(12)
  v_rcp_f32 v116, v97
  v_rcp_f32 v117, v99
  v_rcp_f32 v118, v101
  v_rcp_f32 v119, v103
  v_mul_f32 v97, 0xbfb8aa3b, v97
  v_mul_f32 v99, 0xbfb8aa3b, v99
  v_mul_f32 v101, 0xbfb8aa3b, v101
  v_mul_f32 v103, 0xbfb8aa3b, v103
  v_and_b32 v12, 1, v1
  v_mul_u32_u24 v12, 2, v12
  v_add_u32 v12, s75, v12
  v_and_b32 v12, 4, v12
  s_add_u32 s86, s69, s63
  v_lshl_add_u32 v12, v12, 1, s86
  v_lshlrev_b32 v12, 7, v12
  s_setprio 3
  v_pk_fma_f32 v[32:33], v[96:97], v[104:105], v[32:33] op_sel:[0,0,0] op_sel_hi:[0,1,1]
  v_pk_fma_f32 v[34:35], v[96:97], v[106:107], v[34:35] op_sel:[0,0,0] op_sel_hi:[0,1,1]
  v_pk_fma_f32 v[36:37], v[96:97], v[108:109], v[36:37] op_sel:[0,0,0] op_sel_hi:[0,1,1]
  v_pk_fma_f32 v[38:39], v[96:97], v[110:111], v[38:39] op_sel:[0,0,0] op_sel_hi:[0,1,1]
  v_pk_fma_f32 v[40:41], v[96:97], v[112:113], v[40:41] op_sel:[0,0,0] op_sel_hi:[0,1,1]
  v_pk_fma_f32 v[42:43], v[96:97], v[114:115], v[42:43] op_sel:[0,0,0] op_sel_hi:[0,1,1]
  v_pk_mul_f32 v[136:137], v[96:97], v[32:33] op_sel:[1,0] op_sel_hi:[1,1]
  v_pk_mul_f32 v[138:139], v[96:97], v[34:35] op_sel:[1,0] op_sel_hi:[1,1]
  v_pk_mul_f32 v[140:141], v[96:97], v[36:37] op_sel:[1,0] op_sel_hi:[1,1]
  v_pk_mul_f32 v[142:143], v[96:97], v[38:39] op_sel:[1,0] op_sel_hi:[1,1]
  v_pk_mul_f32 v[144:145], v[96:97], v[40:41] op_sel:[1,0] op_sel_hi:[1,1]
  v_pk_mul_f32 v[146:147], v[96:97], v[42:43] op_sel:[1,0] op_sel_hi:[1,1]
  v_exp_f32 v136, v136
  v_exp_f32 v137, v137
  v_exp_f32 v138, v138
  v_exp_f32 v139, v139
  s_add_u32 m0, s74, 50176
  s_add_u32 s86, s71, 133120
  buffer_load_dwordx4 v3, s[40:43], s86 offen lds
  v_exp_f32 v140, v140
  v_exp_f32 v141, v141
  v_exp_f32 v142, v142
  v_exp_f32 v143, v143
  v_exp_f32 v144, v144
  v_exp_f32 v145, v145
  v_exp_f32 v146, v146
  v_exp_f32 v147, v147
  v_pk_fma_f32 v[136:137], v[136:137], v[116:117], v[116:117] op_sel:[0,0,0] op_sel_hi:[1,0,0]
  v_pk_fma_f32 v[138:139], v[138:139], v[116:117], v[116:117] op_sel:[0,0,0] op_sel_hi:[1,0,0]
  v_pk_fma_f32 v[140:141], v[140:141], v[116:117], v[116:117] op_sel:[0,0,0] op_sel_hi:[1,0,0]
  v_pk_fma_f32 v[142:143], v[142:143], v[116:117], v[116:117] op_sel:[0,0,0] op_sel_hi:[1,0,0]
  v_pk_fma_f32 v[144:145], v[144:145], v[116:117], v[116:117] op_sel:[0,0,0] op_sel_hi:[1,0,0]
  v_pk_fma_f32 v[146:147], v[146:147], v[116:117], v[116:117] op_sel:[0,0,0] op_sel_hi:[1,0,0]
  v_rcp_f32 v136, v136
  v_rcp_f32 v137, v137
  v_rcp_f32 v138, v138
  v_rcp_f32 v139, v139
  v_rcp_f32 v140, v140
  v_rcp_f32 v141, v141
  v_rcp_f32 v142, v142
  v_rcp_f32 v143, v143
  v_rcp_f32 v144, v144
  v_rcp_f32 v145, v145
  v_rcp_f32 v146, v146
  v_rcp_f32 v147, v147
  v_pk_mul_f32 v[32:33], v[32:33], v[136:137] op_sel:[0,0] op_sel_hi:[1,1]
  v_pk_mul_f32 v[34:35], v[34:35], v[138:139] op_sel:[0,0] op_sel_hi:[1,1]
  v_pk_mul_f32 v[36:37], v[36:37], v[140:141] op_sel:[0,0] op_sel_hi:[1,1]
  v_pk_mul_f32 v[38:39], v[38:39], v[142:143] op_sel:[0,0] op_sel_hi:[1,1]
  v_pk_mul_f32 v[40:41], v[40:41], v[144:145] op_sel:[0,0] op_sel_hi:[1,1]
  v_pk_mul_f32 v[42:43], v[42:43], v[146:147] op_sel:[0,0] op_sel_hi:[1,1]
  v_cvt_pk_bf16_f32 v32, v32, v33
  v_cvt_pk_bf16_f32 v33, v34, v35
  v_cvt_pk_bf16_f32 v34, v36, v37
  v_cvt_pk_bf16_f32 v35, v38, v39
  buffer_store_dwordx4 v[32:35], v2, s[16:19], s82 offen sc1
  s_waitcnt lgkmcnt(4)
  s_add_u32 m0, s74, 65536
  s_add_u32 s86, s71, 143360
  buffer_load_dwordx4 v3, s[40:43], s86 offen lds
  s_add_u32 s82, s82, 73728
  v_cvt_pk_bf16_f32 v16, v40, v41
  v_cvt_pk_bf16_f32 v17, v42, v43
  s_setprio 3
  v_pk_fma_f32 v[48:49], v[98:99], v[104:105], v[48:49] op_sel:[0,0,0] op_sel_hi:[0,1,1]
  v_pk_fma_f32 v[50:51], v[98:99], v[106:107], v[50:51] op_sel:[0,0,0] op_sel_hi:[0,1,1]
  v_pk_fma_f32 v[52:53], v[98:99], v[108:109], v[52:53] op_sel:[0,0,0] op_sel_hi:[0,1,1]
  v_pk_fma_f32 v[54:55], v[98:99], v[110:111], v[54:55] op_sel:[0,0,0] op_sel_hi:[0,1,1]
  v_pk_fma_f32 v[56:57], v[98:99], v[112:113], v[56:57] op_sel:[0,0,0] op_sel_hi:[0,1,1]
  v_pk_fma_f32 v[58:59], v[98:99], v[114:115], v[58:59] op_sel:[0,0,0] op_sel_hi:[0,1,1]
  v_pk_mul_f32 v[136:137], v[98:99], v[48:49] op_sel:[1,0] op_sel_hi:[1,1]
  v_pk_mul_f32 v[138:139], v[98:99], v[50:51] op_sel:[1,0] op_sel_hi:[1,1]
  v_pk_mul_f32 v[140:141], v[98:99], v[52:53] op_sel:[1,0] op_sel_hi:[1,1]
  v_pk_mul_f32 v[142:143], v[98:99], v[54:55] op_sel:[1,0] op_sel_hi:[1,1]
  v_pk_mul_f32 v[144:145], v[98:99], v[56:57] op_sel:[1,0] op_sel_hi:[1,1]
  v_pk_mul_f32 v[146:147], v[98:99], v[58:59] op_sel:[1,0] op_sel_hi:[1,1]
  v_exp_f32 v136, v136
  v_exp_f32 v137, v137
  v_exp_f32 v138, v138
  v_exp_f32 v139, v139
  v_exp_f32 v140, v140
  v_exp_f32 v141, v141
  v_exp_f32 v142, v142
  v_exp_f32 v143, v143
  v_exp_f32 v144, v144
  v_exp_f32 v145, v145
  v_exp_f32 v146, v146
  v_exp_f32 v147, v147
  v_pk_fma_f32 v[136:137], v[116:117], v[136:137], v[116:117] op_sel:[1,0,1] op_sel_hi:[1,1,1]
  v_pk_fma_f32 v[138:139], v[116:117], v[138:139], v[116:117] op_sel:[1,0,1] op_sel_hi:[1,1,1]
  v_pk_fma_f32 v[140:141], v[116:117], v[140:141], v[116:117] op_sel:[1,0,1] op_sel_hi:[1,1,1]
  v_pk_fma_f32 v[142:143], v[116:117], v[142:143], v[116:117] op_sel:[1,0,1] op_sel_hi:[1,1,1]
  v_pk_fma_f32 v[144:145], v[116:117], v[144:145], v[116:117] op_sel:[1,0,1] op_sel_hi:[1,1,1]
  v_pk_fma_f32 v[146:147], v[116:117], v[146:147], v[116:117] op_sel:[1,0,1] op_sel_hi:[1,1,1]
  v_rcp_f32 v136, v136
  v_rcp_f32 v137, v137
  v_rcp_f32 v138, v138
  v_rcp_f32 v139, v139
  s_add_u32 m0, s74, 66560
  s_add_u32 s86, s71, 153600
  buffer_load_dwordx4 v3, s[40:43], s86 offen lds
  v_rcp_f32 v140, v140
  v_rcp_f32 v141, v141
  v_rcp_f32 v142, v142
  v_rcp_f32 v143, v143
  v_rcp_f32 v144, v144
  v_rcp_f32 v145, v145
  v_rcp_f32 v146, v146
  v_rcp_f32 v147, v147
  v_pk_mul_f32 v[48:49], v[48:49], v[136:137] op_sel:[0,0] op_sel_hi:[1,1]
  v_pk_mul_f32 v[50:51], v[50:51], v[138:139] op_sel:[0,0] op_sel_hi:[1,1]
  v_pk_mul_f32 v[52:53], v[52:53], v[140:141] op_sel:[0,0] op_sel_hi:[1,1]
  v_pk_mul_f32 v[54:55], v[54:55], v[142:143] op_sel:[0,0] op_sel_hi:[1,1]
  v_pk_mul_f32 v[56:57], v[56:57], v[144:145] op_sel:[0,0] op_sel_hi:[1,1]
  v_pk_mul_f32 v[58:59], v[58:59], v[146:147] op_sel:[0,0] op_sel_hi:[1,1]
  v_cvt_pk_bf16_f32 v48, v48, v49
  v_cvt_pk_bf16_f32 v49, v50, v51
  v_cvt_pk_bf16_f32 v50, v52, v53
  v_cvt_pk_bf16_f32 v51, v54, v55
  buffer_store_dwordx4 v[48:51], v2, s[16:19], s82 offen sc1
  s_add_u32 s82, s82, 73728
  v_cvt_pk_bf16_f32 v18, v56, v57
  v_cvt_pk_bf16_f32 v19, v58, v59
  s_nop 0
  v_permlane32_swap_b32 v16, v18
  v_permlane32_swap_b32 v17, v19
  buffer_store_dwordx4 v[16:19], v174, s[16:19], s83 offen sc1
  s_add_u32 s83, s83, 147456
  s_setprio 2
  v_pk_fma_f32 v[64:65], v[100:101], v[104:105], v[64:65] op_sel:[0,0,0] op_sel_hi:[0,1,1]
  v_pk_fma_f32 v[66:67], v[100:101], v[106:107], v[66:67] op_sel:[0,0,0] op_sel_hi:[0,1,1]
  v_pk_fma_f32 v[68:69], v[100:101], v[108:109], v[68:69] op_sel:[0,0,0] op_sel_hi:[0,1,1]
  v_pk_fma_f32 v[70:71], v[100:101], v[110:111], v[70:71] op_sel:[0,0,0] op_sel_hi:[0,1,1]
  v_pk_fma_f32 v[72:73], v[100:101], v[112:113], v[72:73] op_sel:[0,0,0] op_sel_hi:[0,1,1]
  v_pk_fma_f32 v[74:75], v[100:101], v[114:115], v[74:75] op_sel:[0,0,0] op_sel_hi:[0,1,1]
  v_pk_mul_f32 v[136:137], v[100:101], v[64:65] op_sel:[1,0] op_sel_hi:[1,1]
  v_pk_mul_f32 v[138:139], v[100:101], v[66:67] op_sel:[1,0] op_sel_hi:[1,1]
  v_pk_mul_f32 v[140:141], v[100:101], v[68:69] op_sel:[1,0] op_sel_hi:[1,1]
  v_pk_mul_f32 v[142:143], v[100:101], v[70:71] op_sel:[1,0] op_sel_hi:[1,1]
  s_waitcnt lgkmcnt(0)
  s_add_u32 m0, s74, 81920
  s_add_u32 s86, s71, 184320
  buffer_load_dwordx4 v3, s[40:43], s86 offen lds
  v_pk_mul_f32 v[144:145], v[100:101], v[72:73] op_sel:[1,0] op_sel_hi:[1,1]
  v_pk_mul_f32 v[146:147], v[100:101], v[74:75] op_sel:[1,0] op_sel_hi:[1,1]
  v_exp_f32 v136, v136
  v_exp_f32 v137, v137
  v_exp_f32 v138, v138
  v_exp_f32 v139, v139
  v_exp_f32 v140, v140
  v_exp_f32 v141, v141
  v_exp_f32 v142, v142
  v_exp_f32 v143, v143
  v_exp_f32 v144, v144
  v_exp_f32 v145, v145
  v_exp_f32 v146, v146
  v_exp_f32 v147, v147
  v_pk_fma_f32 v[136:137], v[136:137], v[118:119], v[118:119] op_sel:[0,0,0] op_sel_hi:[1,0,0]
  v_pk_fma_f32 v[138:139], v[138:139], v[118:119], v[118:119] op_sel:[0,0,0] op_sel_hi:[1,0,0]
  v_pk_fma_f32 v[140:141], v[140:141], v[118:119], v[118:119] op_sel:[0,0,0] op_sel_hi:[1,0,0]
  v_pk_fma_f32 v[142:143], v[142:143], v[118:119], v[118:119] op_sel:[0,0,0] op_sel_hi:[1,0,0]
  v_pk_fma_f32 v[144:145], v[144:145], v[118:119], v[118:119] op_sel:[0,0,0] op_sel_hi:[1,0,0]
  v_pk_fma_f32 v[146:147], v[146:147], v[118:119], v[118:119] op_sel:[0,0,0] op_sel_hi:[1,0,0]
  v_rcp_f32 v136, v136
  v_rcp_f32 v137, v137
  v_rcp_f32 v138, v138
  v_rcp_f32 v139, v139
  v_rcp_f32 v140, v140
  v_rcp_f32 v141, v141
  v_rcp_f32 v142, v142
  v_rcp_f32 v143, v143
  v_rcp_f32 v144, v144
  v_rcp_f32 v145, v145
  v_rcp_f32 v146, v146
  v_rcp_f32 v147, v147
  v_pk_mul_f32 v[64:65], v[64:65], v[136:137] op_sel:[0,0] op_sel_hi:[1,1]
  v_pk_mul_f32 v[66:67], v[66:67], v[138:139] op_sel:[0,0] op_sel_hi:[1,1]
  v_pk_mul_f32 v[68:69], v[68:69], v[140:141] op_sel:[0,0] op_sel_hi:[1,1]
  v_pk_mul_f32 v[70:71], v[70:71], v[142:143] op_sel:[0,0] op_sel_hi:[1,1]
  v_pk_mul_f32 v[72:73], v[72:73], v[144:145] op_sel:[0,0] op_sel_hi:[1,1]
  s_add_u32 m0, s74, 82944
  s_add_u32 s86, s71, 194560
  buffer_load_dwordx4 v3, s[40:43], s86 offen lds
  v_pk_mul_f32 v[74:75], v[74:75], v[146:147] op_sel:[0,0] op_sel_hi:[1,1]
  v_cvt_pk_bf16_f32 v64, v64, v65
  v_cvt_pk_bf16_f32 v65, v66, v67
  v_cvt_pk_bf16_f32 v66, v68, v69
  v_cvt_pk_bf16_f32 v67, v70, v71
  buffer_store_dwordx4 v[64:67], v2, s[16:19], s82 offen sc1
  s_add_u32 s82, s82, 73728
  v_cvt_pk_bf16_f32 v20, v72, v73
  v_cvt_pk_bf16_f32 v21, v74, v75
  s_setprio 1
  s_waitcnt vmcnt(3)
  v_mov_b32 v24, 162816
  v_mov_b32 v25, 1
  s_mov_b64 exec, 1
  ds_add_rtn_u32 v25, v24, v25
  v_mov_b32 v24, s70
  s_add_u32 s86, s34, 0
  s_waitcnt lgkmcnt(0)
  v_cmp_eq_u32 vcc, 7, v25
  s_cbranch_vccz L_nofl_37
  s_mov_b64 exec, 0xff
  buffer_store_dwordx4 v[24:27], v2, s[16:19], s86 offen sc1
L_nofl_37:
  s_mov_b64 exec, -1
  v_pk_fma_f32 v[80:81], v[102:103], v[104:105], v[80:81] op_sel:[0,0,0] op_sel_hi:[0,1,1]
  v_pk_fma_f32 v[82:83], v[102:103], v[106:107], v[82:83] op_sel:[0,0,0] op_sel_hi:[0,1,1]
  v_pk_fma_f32 v[84:85], v[102:103], v[108:109], v[84:85] op_sel:[0,0,0] op_sel_hi:[0,1,1]
  v_pk_fma_f32 v[86:87], v[102:103], v[110:111], v[86:87] op_sel:[0,0,0] op_sel_hi:[0,1,1]
  v_pk_fma_f32 v[88:89], v[102:103], v[112:113], v[88:89] op_sel:[0,0,0] op_sel_hi:[0,1,1]
  v_pk_fma_f32 v[90:91], v[102:103], v[114:115], v[90:91] op_sel:[0,0,0] op_sel_hi:[0,1,1]
  v_pk_mul_f32 v[136:137], v[102:103], v[80:81] op_sel:[1,0] op_sel_hi:[1,1]
  v_pk_mul_f32 v[138:139], v[102:103], v[82:83] op_sel:[1,0] op_sel_hi:[1,1]
  v_pk_mul_f32 v[140:141], v[102:103], v[84:85] op_sel:[1,0] op_sel_hi:[1,1]
  v_pk_mul_f32 v[142:143], v[102:103], v[86:87] op_sel:[1,0] op_sel_hi:[1,1]
  v_pk_mul_f32 v[144:145], v[102:103], v[88:89] op_sel:[1,0] op_sel_hi:[1,1]
  v_pk_mul_f32 v[146:147], v[102:103], v[90:91] op_sel:[1,0] op_sel_hi:[1,1]
  v_exp_f32 v136, v136
  v_exp_f32 v137, v137
  v_exp_f32 v138, v138
  v_exp_f32 v139, v139
  v_exp_f32 v140, v140
  v_exp_f32 v141, v141
  v_exp_f32 v142, v142
  v_exp_f32 v143, v143
  v_exp_f32 v144, v144
  v_exp_f32 v145, v145
  v_exp_f32 v146, v146
  v_exp_f32 v147, v147
  v_pk_fma_f32 v[136:137], v[118:119], v[136:137], v[118:119] op_sel:[1,0,1] op_sel_hi:[1,1,1]
  v_pk_fma_f32 v[138:139], v[118:119], v[138:139], v[118:119] op_sel:[1,0,1] op_sel_hi:[1,1,1]
  v_pk_fma_f32 v[140:141], v[118:119], v[140:141], v[118:119] op_sel:[1,0,1] op_sel_hi:[1,1,1]
  v_pk_fma_f32 v[142:143], v[118:119], v[142:143], v[118:119] op_sel:[1,0,1] op_sel_hi:[1,1,1]
  v_pk_fma_f32 v[144:145], v[118:119], v[144:145], v[118:119] op_sel:[1,0,1] op_sel_hi:[1,1,1]
  v_pk_fma_f32 v[146:147], v[118:119], v[146:147], v[118:119] op_sel:[1,0,1] op_sel_hi:[1,1,1]
  v_rcp_f32 v136, v136
  v_rcp_f32 v137, v137
  v_rcp_f32 v138, v138
  v_rcp_f32 v139, v139
  v_rcp_f32 v140, v140
  v_rcp_f32 v141, v141
  v_rcp_f32 v142, v142
  v_rcp_f32 v143, v143
  v_rcp_f32 v144, v144
  v_rcp_f32 v145, v145
  v_rcp_f32 v146, v146
  v_rcp_f32 v147, v147
  v_pk_mul_f32 v[80:81], v[80:81], v[136:137] op_sel:[0,0] op_sel_hi:[1,1]
  v_pk_mul_f32 v[82:83], v[82:83], v[138:139] op_sel:[0,0] op_sel_hi:[1,1]
  v_pk_mul_f32 v[84:85], v[84:85], v[140:141] op_sel:[0,0] op_sel_hi:[1,1]
  v_pk_mul_f32 v[86:87], v[86:87], v[142:143] op_sel:[0,0] op_sel_hi:[1,1]
  v_pk_mul_f32 v[88:89], v[88:89], v[144:145] op_sel:[0,0] op_sel_hi:[1,1]
  v_pk_mul_f32 v[90:91], v[90:91], v[146:147] op_sel:[0,0] op_sel_hi:[1,1]
  v_cvt_pk_bf16_f32 v80, v80, v81
  v_cvt_pk_bf16_f32 v81, v82, v83
  v_cvt_pk_bf16_f32 v82, v84, v85
  v_cvt_pk_bf16_f32 v83, v86, v87
  buffer_store_dwordx4 v[80:83], v2, s[16:19], s82 offen sc1
  s_add_u32 s82, s82, 73728
  v_cvt_pk_bf16_f32 v22, v88, v89
  v_cvt_pk_bf16_f32 v23, v90, v91
  s_nop 0
  v_permlane32_swap_b32 v20, v22
  v_permlane32_swap_b32 v21, v23
  buffer_store_dwordx4 v[20:23], v174, s[16:19], s83 offen sc1
  s_add_u32 s83, s83, 147456
  s_setprio 0
  v_add_u32 v8, 98304, v7
  v_xor_b32 v9, 32, v8
  v_xor_b32 v10, 64, v8
  v_xor_b32 v11, 0x60, v8
  s_waitcnt vmcnt(20)
  ds_read_b64_tr_b16 v[194:195], v8 offset:0
  ds_read_b64_tr_b16 v[198:199], v9 offset:0
  ds_read_b64_tr_b16 v[202:203], v10 offset:0
  ds_read_b64_tr_b16 v[206:207], v11 offset:0
  s_waitcnt vmcnt(18)
  ds_read_b64_tr_b16 v[208:209], v8 offset:16384
  ds_read_b64_tr_b16 v[212:213], v9 offset:16384
  ds_read_b64_tr_b16 v[216:217], v10 offset:16384
  ds_read_b64_tr_b16 v[220:221], v11 offset:16384
  s_waitcnt vmcnt(16)
  ds_read_b64_tr_b16 v[210:211], v8 offset:32768
  ds_read_b64_tr_b16 v[214:215], v9 offset:32768
  ds_read_b64_tr_b16 v[218:219], v10 offset:32768
  ds_read_b64_tr_b16 v[222:223], v11 offset:32768
  s_waitcnt lgkmcnt(8)
  s_add_u32 m0, s74, 98304
  s_add_u32 s86, s71, 204800
  buffer_load_dwordx4 v3, s[40:43], s86 offen lds
  s_add_u32 m0, s74, 99328
  s_add_u32 s86, s71, 215040
  buffer_load_dwordx4 v3, s[40:43], s86 offen lds
  v_add_u32 v8, 0, v7
  v_xor_b32 v9, 32, v8
  v_xor_b32 v10, 64, v8
  v_xor_b32 v11, 0x60, v8
  s_waitcnt vmcnt(16)
  ds_read_b64_tr_b16 v[224:225], v8 offset:0
  ds_read_b64_tr_b16 v[228:229], v9 offset:0
  ds_read_b64_tr_b16 v[232:233], v10 offset:0
  ds_read_b64_tr_b16 v[236:237], v11 offset:0
  s_waitcnt vmcnt(14)
  ds_read_b64_tr_b16 v[226:227], v8 offset:16384
  ds_read_b64_tr_b16 v[230:231], v9 offset:16384
  ds_read_b64_tr_b16 v[234:235], v10 offset:16384
  ds_read_b64_tr_b16 v[238:239], v11 offset:16384
  s_waitcnt lgkmcnt(12)
  s_add_u32 m0, s74, 114688
  s_add_u32 s86, s72, 0
  buffer_load_dwordx4 v3, s[36:39], s86 offen lds
  s_add_u32 m0, s74, 115712
  s_add_u32 s86, s72, 25600
  buffer_load_dwordx4 v3, s[36:39], s86 offen lds
  s_waitcnt vmcnt(4)
  s_setprio 3
  v_mov_b32 v108, 162820
  v_mov_b32 v109, 1
  s_mov_b64 exec, 1
  ds_add_rtn_u32 v109, v108, v109
  v_mov_b32 v108, s70
  s_add_u32 s86, s34, 16384
  s_waitcnt lgkmcnt(0)
  v_cmp_eq_u32 vcc, 7, v109
  s_cbranch_vccz L_nofl_38
  s_mov_b64 exec, 0xff
  buffer_store_dwordx4 v[108:111], v2, s[16:19], s86 offen sc1
L_nofl_38:
  s_mov_b64 exec, -1
  s_setprio 0
  s_waitcnt lgkmcnt(9)
  s_add_u32 m0, s74, 131072
  s_add_u32 s86, s72, 10240
  buffer_load_dwordx4 v3, s[36:39], s86 offen lds
  s_add_u32 m0, s74, 132096
  s_add_u32 s86, s72, 35840
  buffer_load_dwordx4 v3, s[36:39], s86 offen lds
  s_mov_b32 s87, 9437184
  buffer_load_dword v13, v12, s[16:19], s87 offen sc1
  v_add_u32 v8, 49152, v7
  v_xor_b32 v9, 32, v8
  v_xor_b32 v10, 64, v8
  v_xor_b32 v11, 0x60, v8
  s_waitcnt vmcnt(17)
  ds_read_b64_tr_b16 v[240:241], v8 offset:0
  ds_read_b64_tr_b16 v[244:245], v9 offset:0
  ds_read_b64_tr_b16 v[248:249], v10 offset:0
  ds_read_b64_tr_b16 v[252:253], v11 offset:0
  s_waitcnt vmcnt(14)
  ds_read_b64_tr_b16 v[242:243], v8 offset:16384
  ds_read_b64_tr_b16 v[246:247], v9 offset:16384
  ds_read_b64_tr_b16 v[250:251], v10 offset:16384
  ds_read_b64_tr_b16 v[254:255], v11 offset:16384
  s_waitcnt vmcnt(10)
  ds_read_b64_tr_b16 v[160:161], v8 offset:32768
  ds_read_b64_tr_b16 v[164:165], v9 offset:32768
  ds_read_b64_tr_b16 v[168:169], v10 offset:32768
  ds_read_b64_tr_b16 v[172:173], v11 offset:32768
  s_waitcnt vmcnt(5)
  ds_read_b64_tr_b16 v[162:163], v8 offset:49152
  ds_read_b64_tr_b16 v[166:167], v9 offset:49152
  ds_read_b64_tr_b16 v[170:171], v10 offset:49152
  ds_read_b64_tr_b16 v[174:175], v11 offset:49152
  s_waitcnt lgkmcnt(14)
  s_add_u32 m0, s74, 0
  s_add_u32 s86, s72, 51200
  buffer_load_dwordx4 v3, s[36:39], s86 offen lds
  s_add_u32 m0, s74, 1024
  s_add_u32 s86, s72, 76800
  buffer_load_dwordx4 v3, s[36:39], s86 offen lds
  s_bfe_u32 s81, s63, 0x10001
  v_xor_b32 v154, v6, v5
  v_xor_b32 v154, s81, v154
  v_lshlrev_b32 v154, 3, v154
  v_lshl_add_u32 v154, v5, 7, v154
  s_add_u32 s81, s74, 49152
  v_add_u32 v154, s81, v154
  s_lshl_b32 s81, s67, 2
  v_and_or_b32 v155, v5, 1, s81
  v_xor_b32 v155, v155, v6
  v_lshlrev_b32 v155, 3, v155
  v_lshl_add_u32 v155, v6, 7, v155
  v_lshlrev_b32 v157, 12, v5
  s_lshl_b32 s81, s66, 14
  s_add_u32 s81, s81, 49152
  v_add3_u32 v155, v155, v157, s81
  s_lshl_b32 s81, s67, 2
  v_add_u32 v157, s81, v5
  v_mul_u32_u24 v156, 2560, v157
  v_lshl_add_u32 v156, v6, 3, v156
  v_and_b32 v157, 1, v1
  v_lshlrev_b32 v157, 4, v157
  v_mov_b32 v153, 0x3f80
  v_lshlrev_b32 v157, v157, v153
  s_mov_b32 s88, 0x30003
  s_mov_b32 s89, 0x30003
  v_cndmask_b32 v136, 0, v157, s[88:89]
  v_cndmask_b32 v138, 0, v157, s[88:89]
  s_mov_b32 s88, 0xc000c
  s_mov_b32 s89, 0xc000c
  v_cndmask_b32 v137, 0, v157, s[88:89]
  v_cndmask_b32 v139, 0, v157, s[88:89]
  s_mov_b32 s88, 0x300030
  s_mov_b32 s89, 0x300030
  v_cndmask_b32 v140, 0, v157, s[88:89]
  v_cndmask_b32 v142, 0, v157, s[88:89]
  s_mov_b32 s88, 0xc000c0
  s_mov_b32 s89, 0xc000c0
  v_cndmask_b32 v141, 0, v157, s[88:89]
  v_cndmask_b32 v143, 0, v157, s[88:89]
  s_mov_b32 s88, 0x3000300
  s_mov_b32 s89, 0x3000300
  v_cndmask_b32 v144, 0, v157, s[88:89]
  v_cndmask_b32 v146, 0, v157, s[88:89]
  s_mov_b32 s88, 0xc000c00
  s_mov_b32 s89, 0xc000c00
  v_cndmask_b32 v145, 0, v157, s[88:89]
  v_cndmask_b32 v147, 0, v157, s[88:89]
  s_mov_b32 s88, 0x30003000
  s_mov_b32 s89, 0x30003000
  v_cndmask_b32 v148, 0, v157, s[88:89]
  v_cndmask_b32 v150, 0, v157, s[88:89]
  s_mov_b32 s88, 0xc000c000
  s_mov_b32 s89, 0xc000c000
  v_cndmask_b32 v149, 0, v157, s[88:89]
  v_cndmask_b32 v151, 0, v157, s[88:89]
  buffer_load_dwordx2 v[152:153], v156, s[4:7], s28 offen
  buffer_load_dwordx2 v[158:159], v156, s[4:7], s29 offen
  buffer_load_dwordx2 v[14:15], v156, s[4:7], s30 offen
  s_waitcnt vmcnt(5)
  v_cmp_ne_u32 vcc, s70, v13
  s_cbranch_vccnz L_slow_39
L_back_40:
  buffer_load_dwordx4 v[112:115], v2, s[16:19], s44 offen offset:0 sc1
  buffer_load_dwordx4 v[116:119], v2, s[16:19], s44 offen offset:1024 sc1
  buffer_load_dwordx4 v[120:123], v2, s[16:19], s44 offen offset:2048 sc1
  buffer_load_dwordx4 v[124:127], v2, s[16:19], s44 offen offset:3072 sc1
  s_add_u32 s80, s44, 4096
  buffer_load_dwordx4 v[128:131], v2, s[16:19], s80 offen offset:0 sc1
  s_waitcnt lgkmcnt(14)
  s_setprio 3
  s_waitcnt vmcnt(4)
  v_mfma_f32_16x16x32_bf16 v[16:19], v[176:179], v[112:115], 0
  v_mfma_f32_16x16x32_bf16 v[20:23], v[180:183], v[112:115], 0
  s_waitcnt lgkmcnt(14)
  s_add_u32 m0, s74, 16384
  s_add_u32 s86, s72, 61440
  buffer_load_dwordx4 v3, s[36:39], s86 offen lds
  v_mfma_f32_16x16x32_bf16 v[24:27], v[184:187], v[112:115], 0
  v_mfma_f32_16x16x32_bf16 v[28:31], v[188:191], v[112:115], 0
  buffer_load_dwordx4 v[112:115], v2, s[16:19], s80 offen offset:1024 sc1
  s_waitcnt lgkmcnt(14)
  s_waitcnt vmcnt(5)
  v_mfma_f32_16x16x32_bf16 v[16:19], v[192:195], v[116:119], v[16:19]
  v_mfma_f32_16x16x32_bf16 v[20:23], v[196:199], v[116:119], v[20:23]
  v_mfma_f32_16x16x32_bf16 v[24:27], v[200:203], v[116:119], v[24:27]
  v_mfma_f32_16x16x32_bf16 v[28:31], v[204:207], v[116:119], v[28:31]
  buffer_load_dwordx4 v[116:119], v2, s[16:19], s45 offen offset:0 sc1
  s_waitcnt lgkmcnt(14)
  s_waitcnt vmcnt(5)
  v_mfma_f32_16x16x32_bf16 v[16:19], v[208:211], v[120:123], v[16:19]
  v_mfma_f32_16x16x32_bf16 v[20:23], v[212:215], v[120:123], v[20:23]
  s_add_u32 m0, s74, 17408
  s_add_u32 s86, s72, 87040
  buffer_load_dwordx4 v3, s[36:39], s86 offen lds
  v_mfma_f32_16x16x32_bf16 v[24:27], v[216:219], v[120:123], v[24:27]
  v_mfma_f32_16x16x32_bf16 v[28:31], v[220:223], v[120:123], v[28:31]
  buffer_load_dwordx4 v[120:123], v2, s[16:19], s45 offen offset:1024 sc1
  s_waitcnt lgkmcnt(14)
  s_setprio 2
  s_waitcnt vmcnt(6)
  v_mfma_f32_16x16x32_bf16 v[16:19], v[224:227], v[124:127], v[16:19]
  v_mfma_f32_16x16x32_bf16 v[20:23], v[228:231], v[124:127], v[20:23]
  v_mfma_f32_16x16x32_bf16 v[24:27], v[232:235], v[124:127], v[24:27]
  v_mfma_f32_16x16x32_bf16 v[28:31], v[236:239], v[124:127], v[28:31]
  buffer_load_dwordx4 v[124:127], v2, s[16:19], s45 offen offset:2048 sc1
  s_waitcnt lgkmcnt(8)
  s_waitcnt vmcnt(6)
  v_mfma_f32_16x16x32_bf16 v[16:19], v[240:243], v[128:131], v[16:19]
  v_mfma_f32_16x16x32_bf16 v[20:23], v[244:247], v[128:131], v[20:23]
  s_waitcnt lgkmcnt(12)
  s_add_u32 m0, s74, 49152
  s_add_u32 s86, s72, 20480
  buffer_load_dwordx4 v4, s[36:39], s86 offen lds
  v_mfma_f32_16x16x32_bf16 v[24:27], v[248:251], v[128:131], v[24:27]
  v_mfma_f32_16x16x32_bf16 v[28:31], v[252:255], v[128:131], v[28:31]
  buffer_load_dwordx4 v[128:131], v2, s[16:19], s45 offen offset:3072 sc1
  s_waitcnt lgkmcnt(0)
  s_waitcnt vmcnt(6)
  v_mfma_f32_16x16x32_bf16 v[16:19], v[160:163], v[112:115], v[16:19]
  v_mfma_f32_16x16x32_bf16 v[20:23], v[164:167], v[112:115], v[20:23]
  v_mfma_f32_16x16x32_bf16 v[24:27], v[168:171], v[112:115], v[24:27]
  v_mfma_f32_16x16x32_bf16 v[28:31], v[172:175], v[112:115], v[28:31]
  s_add_u32 s80, s45, 4096
  buffer_load_dwordx4 v[112:115], v2, s[16:19], s80 offen offset:0 sc1
  s_setprio 1
  s_waitcnt vmcnt(6)
  v_mfma_f32_16x16x32_bf16 v[32:35], v[176:179], v[116:119], 0
  v_mfma_f32_16x16x32_bf16 v[36:39], v[180:183], v[116:119], 0
  s_add_u32 m0, s74, 50176
  s_add_u32 s86, s72, 71680
  buffer_load_dwordx4 v4, s[36:39], s86 offen lds
  v_mfma_f32_16x16x32_bf16 v[40:43], v[184:187], v[116:119], 0
  v_mfma_f32_16x16x32_bf16 v[44:47], v[188:191], v[116:119], 0
  buffer_load_dwordx4 v[116:119], v2, s[16:19], s80 offen offset:1024 sc1
  s_waitcnt vmcnt(6)
  v_mfma_f32_16x16x32_bf16 v[32:35], v[192:195], v[120:123], v[32:35]
  v_mfma_f32_16x16x32_bf16 v[36:39], v[196:199], v[120:123], v[36:39]
  v_mfma_f32_16x16x32_bf16 v[40:43], v[200:203], v[120:123], v[40:43]
  v_mfma_f32_16x16x32_bf16 v[44:47], v[204:207], v[120:123], v[44:47]
  buffer_load_dwordx4 v[120:123], v2, s[16:19], s46 offen offset:0 sc1
  s_waitcnt vmcnt(6)
  v_mfma_f32_16x16x32_bf16 v[32:35], v[208:211], v[124:127], v[32:35]
  v_mfma_f32_16x16x32_bf16 v[36:39], v[212:215], v[124:127], v[36:39]
  v_mfma_f32_16x16x32_bf16 v[40:43], v[216:219], v[124:127], v[40:43]
  v_mfma_f32_16x16x32_bf16 v[44:47], v[220:223], v[124:127], v[44:47]
  buffer_load_dwordx4 v[124:127], v2, s[16:19], s46 offen offset:1024 sc1
  s_setprio 0
  s_waitcnt vmcnt(5)
  v_mfma_f32_16x16x32_bf16 v[32:35], v[224:227], v[128:131], v[32:35]
  v_mfma_f32_16x16x32_bf16 v[36:39], v[228:231], v[128:131], v[36:39]
  v_mfma_f32_16x16x32_bf16 v[40:43], v[232:235], v[128:131], v[40:43]
  v_mfma_f32_16x16x32_bf16 v[44:47], v[236:239], v[128:131], v[44:47]
  buffer_load_dwordx4 v[128:131], v2, s[16:19], s46 offen offset:2048 sc1
  s_waitcnt vmcnt(5)
  v_mfma_f32_16x16x32_bf16 v[32:35], v[240:243], v[112:115], v[32:35]
  v_mfma_f32_16x16x32_bf16 v[36:39], v[244:247], v[112:115], v[36:39]
  v_mfma_f32_16x16x32_bf16 v[40:43], v[248:251], v[112:115], v[40:43]
  v_mfma_f32_16x16x32_bf16 v[44:47], v[252:255], v[112:115], v[44:47]
  s_mov_b32 s87, 9453568
  buffer_load_dword v13, v12, s[16:19], s87 offen sc1
  buffer_load_dwordx4 v[112:115], v2, s[16:19], s46 offen offset:3072 sc1
  s_waitcnt vmcnt(5)
  v_mfma_f32_16x16x32_bf16 v[32:35], v[160:163], v[116:119], v[32:35]
  v_mfma_f32_16x16x32_bf16 v[36:39], v[164:167], v[116:119], v[36:39]
  v_mfma_f32_16x16x32_bf16 v[40:43], v[168:171], v[116:119], v[40:43]
  v_mfma_f32_16x16x32_bf16 v[44:47], v[172:175], v[116:119], v[44:47]
  s_add_u32 s80, s46, 4096
  buffer_load_dwordx4 v[116:119], v2, s[16:19], s80 offen offset:0 sc1
  s_setprio 3
  s_waitcnt vmcnt(5)
  v_mfma_f32_16x16x32_bf16 v[48:51], v[176:179], v[120:123], 0
  v_mfma_f32_16x16x32_bf16 v[52:55], v[180:183], v[120:123], 0
  v_mfma_f32_16x16x32_bf16 v[56:59], v[184:187], v[120:123], 0
  v_mfma_f32_16x16x32_bf16 v[60:63], v[188:191], v[120:123], 0
  buffer_load_dwordx4 v[120:123], v2, s[16:19], s80 offen offset:1024 sc1
  s_waitcnt vmcnt(5)
  v_mfma_f32_16x16x32_bf16 v[48:51], v[192:195], v[124:127], v[48:51]
  v_mfma_f32_16x16x32_bf16 v[52:55], v[196:199], v[124:127], v[52:55]
  v_mfma_f32_16x16x32_bf16 v[56:59], v[200:203], v[124:127], v[56:59]
  v_mfma_f32_16x16x32_bf16 v[60:63], v[204:207], v[124:127], v[60:63]
  s_waitcnt vmcnt(3)
  v_cmp_ne_u32 vcc, s70, v13
  s_cbranch_vccnz L_slow_42
L_back_43:
  buffer_load_dwordx4 v[124:127], v2, s[16:19], s47 offen offset:0 sc1
  s_waitcnt vmcnt(5)
  v_mfma_f32_16x16x32_bf16 v[48:51], v[208:211], v[128:131], v[48:51]
  v_mfma_f32_16x16x32_bf16 v[52:55], v[212:215], v[128:131], v[52:55]
  v_mfma_f32_16x16x32_bf16 v[56:59], v[216:219], v[128:131], v[56:59]
  v_mfma_f32_16x16x32_bf16 v[60:63], v[220:223], v[128:131], v[60:63]
  buffer_load_dwordx4 v[128:131], v2, s[16:19], s47 offen offset:1024 sc1
  s_setprio 2
  s_waitcnt vmcnt(4)
  v_mfma_f32_16x16x32_bf16 v[48:51], v[224:227], v[112:115], v[48:51]
  v_mfma_f32_16x16x32_bf16 v[52:55], v[228:231], v[112:115], v[52:55]
  v_mfma_f32_16x16x32_bf16 v[56:59], v[232:235], v[112:115], v[56:59]
  v_mfma_f32_16x16x32_bf16 v[60:63], v[236:239], v[112:115], v[60:63]
  buffer_load_dwordx4 v[112:115], v2, s[16:19], s47 offen offset:2048 sc1
  s_waitcnt vmcnt(4)
  v_mfma_f32_16x16x32_bf16 v[48:51], v[240:243], v[116:119], v[48:51]
  v_mfma_f32_16x16x32_bf16 v[52:55], v[244:247], v[116:119], v[52:55]
  v_mfma_f32_16x16x32_bf16 v[56:59], v[248:251], v[116:119], v[56:59]
  v_mfma_f32_16x16x32_bf16 v[60:63], v[252:255], v[116:119], v[60:63]
  buffer_load_dwordx4 v[116:119], v2, s[16:19], s47 offen offset:3072 sc1
  s_waitcnt vmcnt(4)
  v_mfma_f32_16x16x32_bf16 v[48:51], v[160:163], v[120:123], v[48:51]
  v_mfma_f32_16x16x32_bf16 v[52:55], v[164:167], v[120:123], v[52:55]
  v_mfma_f32_16x16x32_bf16 v[56:59], v[168:171], v[120:123], v[56:59]
  v_mfma_f32_16x16x32_bf16 v[60:63], v[172:175], v[120:123], v[60:63]
  s_add_u32 s80, s47, 4096
  buffer_load_dwordx4 v[120:123], v2, s[16:19], s80 offen offset:0 sc1
  s_setprio 1
  s_waitcnt vmcnt(4)
  v_mfma_f32_16x16x32_bf16 v[64:67], v[176:179], v[124:127], 0
  v_mfma_f32_16x16x32_bf16 v[68:71], v[180:183], v[124:127], 0
  v_mfma_f32_16x16x32_bf16 v[72:75], v[184:187], v[124:127], 0
  v_mfma_f32_16x16x32_bf16 v[76:79], v[188:191], v[124:127], 0
  buffer_load_dwordx4 v[124:127], v2, s[16:19], s80 offen offset:1024 sc1
  s_waitcnt vmcnt(4)
  v_mfma_f32_16x16x32_bf16 v[64:67], v[192:195], v[128:131], v[64:67]
  v_mfma_f32_16x16x32_bf16 v[68:71], v[196:199], v[128:131], v[68:71]
  v_mfma_f32_16x16x32_bf16 v[72:75], v[200:203], v[128:131], v[72:75]
  v_mfma_f32_16x16x32_bf16 v[76:79], v[204:207], v[128:131], v[76:79]
  buffer_load_dwordx4 v[128:131], v2, s[16:19], s48 offen offset:0 sc1
  s_waitcnt vmcnt(4)
  v_mfma_f32_16x16x32_bf16 v[64:67], v[208:211], v[112:115], v[64:67]
  v_mfma_f32_16x16x32_bf16 v[68:71], v[212:215], v[112:115], v[68:71]
  v_mfma_f32_16x16x32_bf16 v[72:75], v[216:219], v[112:115], v[72:75]
  v_mfma_f32_16x16x32_bf16 v[76:79], v[220:223], v[112:115], v[76:79]
  buffer_load_dwordx4 v[112:115], v2, s[16:19], s48 offen offset:1024 sc1
  s_setprio 0
  s_waitcnt vmcnt(4)
  v_mfma_f32_16x16x32_bf16 v[64:67], v[224:227], v[116:119], v[64:67]
  v_mfma_f32_16x16x32_bf16 v[68:71], v[228:231], v[116:119], v[68:71]
  v_mfma_f32_16x16x32_bf16 v[72:75], v[232:235], v[116:119], v[72:75]
  v_mfma_f32_16x16x32_bf16 v[76:79], v[236:239], v[116:119], v[76:79]
  buffer_load_dwordx4 v[116:119], v2, s[16:19], s48 offen offset:2048 sc1
  s_waitcnt vmcnt(4)
  v_mfma_f32_16x16x32_bf16 v[64:67], v[240:243], v[120:123], v[64:67]
  v_mfma_f32_16x16x32_bf16 v[68:71], v[244:247], v[120:123], v[68:71]
  v_mfma_f32_16x16x32_bf16 v[72:75], v[248:251], v[120:123], v[72:75]
  v_mfma_f32_16x16x32_bf16 v[76:79], v[252:255], v[120:123], v[76:79]
  buffer_load_dwordx4 v[120:123], v2, s[16:19], s49 offen offset:0 sc1
  s_waitcnt vmcnt(4)
  v_mfma_f32_16x16x32_bf16 v[64:67], v[160:163], v[124:127], v[64:67]
  v_mfma_f32_16x16x32_bf16 v[68:71], v[164:167], v[124:127], v[68:71]
  v_mfma_f32_16x16x32_bf16 v[72:75], v[168:171], v[124:127], v[72:75]
  v_mfma_f32_16x16x32_bf16 v[76:79], v[172:175], v[124:127], v[76:79]
  buffer_load_dwordx4 v[124:127], v2, s[16:19], s49 offen offset:1024 sc1
  s_setprio 3
  s_waitcnt vmcnt(4)
  v_mfma_f32_16x16x32_bf16 v[80:83], v[176:179], v[128:131], 0
  v_mfma_f32_16x16x32_bf16 v[84:87], v[180:183], v[128:131], 0
  v_mfma_f32_16x16x32_bf16 v[88:91], v[184:187], v[128:131], 0
  v_mfma_f32_16x16x32_bf16 v[92:95], v[188:191], v[128:131], 0
  buffer_load_dwordx4 v[128:131], v2, s[16:19], s49 offen offset:2048 sc1
  s_waitcnt vmcnt(4)
  v_mfma_f32_16x16x32_bf16 v[80:83], v[192:195], v[112:115], v[80:83]
  v_mfma_f32_16x16x32_bf16 v[84:87], v[196:199], v[112:115], v[84:87]
  v_mfma_f32_16x16x32_bf16 v[88:91], v[200:203], v[112:115], v[88:91]
  v_mfma_f32_16x16x32_bf16 v[92:95], v[204:207], v[112:115], v[92:95]
  buffer_load_dwordx4 v[112:115], v2, s[16:19], s48 offen offset:3072 sc1
  s_waitcnt vmcnt(4)
  v_mfma_f32_16x16x32_bf16 v[80:83], v[208:211], v[116:119], v[80:83]
  v_mfma_f32_16x16x32_bf16 v[84:87], v[212:215], v[116:119], v[84:87]
  v_mfma_f32_16x16x32_bf16 v[88:91], v[216:219], v[116:119], v[88:91]
  v_mfma_f32_16x16x32_bf16 v[92:95], v[220:223], v[116:119], v[92:95]
  s_add_u32 s80, s48, 4096
  buffer_load_dwordx4 v[116:119], v2, s[16:19], s80 offen offset:0 sc1
  s_setprio 2
  s_waitcnt vmcnt(4)
  v_mfma_f32_16x16x32_bf16 v[96:99], v[176:179], v[120:123], 0
  v_add_u32 v8, 114688, v7
  v_xor_b32 v9, 32, v8
  v_mfma_f32_16x16x32_bf16 v[100:103], v[180:183], v[120:123], 0
  v_xor_b32 v10, 64, v8
  v_xor_b32 v11, 0x60, v8
  v_mfma_f32_16x16x32_bf16 v[104:107], v[184:187], v[120:123], 0
  v_mfma_f32_16x16x32_bf16 v[108:111], v[188:191], v[120:123], 0
  buffer_load_dwordx4 v[120:123], v2, s[16:19], s80 offen offset:1024 sc1
  s_waitcnt vmcnt(4)
  v_mfma_f32_16x16x32_bf16 v[96:99], v[192:195], v[124:127], v[96:99]
  s_waitcnt vmcnt(46)
  ds_read_b64_tr_b16 v[176:177], v8 offset:0
  v_mfma_f32_16x16x32_bf16 v[100:103], v[196:199], v[124:127], v[100:103]
  ds_read_b64_tr_b16 v[180:181], v9 offset:0
  v_mfma_f32_16x16x32_bf16 v[104:107], v[200:203], v[124:127], v[104:107]
  ds_read_b64_tr_b16 v[184:185], v10 offset:0
  v_mfma_f32_16x16x32_bf16 v[108:111], v[204:207], v[124:127], v[108:111]
  ds_read_b64_tr_b16 v[188:189], v11 offset:0
  s_mov_b32 s87, 9486336
  buffer_load_dword v13, v12, s[16:19], s87 offen sc1
  buffer_load_dwordx4 v[124:127], v2, s[16:19], s49 offen offset:3072 sc1
  s_waitcnt vmcnt(5)
  v_mfma_f32_16x16x32_bf16 v[96:99], v[208:211], v[128:131], v[96:99]
  s_waitcnt vmcnt(46)
  ds_read_b64_tr_b16 v[178:179], v8 offset:16384
  v_mfma_f32_16x16x32_bf16 v[100:103], v[212:215], v[128:131], v[100:103]
  ds_read_b64_tr_b16 v[182:183], v9 offset:16384
  v_mfma_f32_16x16x32_bf16 v[104:107], v[216:219], v[128:131], v[104:107]
  ds_read_b64_tr_b16 v[186:187], v10 offset:16384
  v_mfma_f32_16x16x32_bf16 v[108:111], v[220:223], v[128:131], v[108:111]
  ds_read_b64_tr_b16 v[190:191], v11 offset:16384
  s_add_u32 s80, s49, 4096
  buffer_load_dwordx4 v[128:131], v2, s[16:19], s80 offen offset:0 sc1
  s_setprio 1
  s_waitcnt vmcnt(5)
  v_mfma_f32_16x16x32_bf16 v[80:83], v[224:227], v[112:115], v[80:83]
  v_add_u32 v8, 0, v7
  v_xor_b32 v9, 32, v8
  v_mfma_f32_16x16x32_bf16 v[84:87], v[228:231], v[112:115], v[84:87]
  v_xor_b32 v10, 64, v8
  v_xor_b32 v11, 0x60, v8
  v_mfma_f32_16x16x32_bf16 v[88:91], v[232:235], v[112:115], v[88:91]
  s_waitcnt vmcnt(44)
  ds_read_b64_tr_b16 v[192:193], v8 offset:0
  v_mfma_f32_16x16x32_bf16 v[92:95], v[236:239], v[112:115], v[92:95]
  ds_read_b64_tr_b16 v[196:197], v9 offset:0
  buffer_load_dwordx4 v[112:115], v2, s[16:19], s80 offen offset:1024 sc1
  s_waitcnt vmcnt(5)
  v_mfma_f32_16x16x32_bf16 v[80:83], v[240:243], v[116:119], v[80:83]
  ds_read_b64_tr_b16 v[200:201], v10 offset:0
  v_mfma_f32_16x16x32_bf16 v[84:87], v[244:247], v[116:119], v[84:87]
  ds_read_b64_tr_b16 v[204:205], v11 offset:0
  v_mfma_f32_16x16x32_bf16 v[88:91], v[248:251], v[116:119], v[88:91]
  s_waitcnt vmcnt(33)
  ds_read_b64_tr_b16 v[194:195], v8 offset:16384
  v_mfma_f32_16x16x32_bf16 v[92:95], v[252:255], v[116:119], v[92:95]
  ds_read_b64_tr_b16 v[198:199], v9 offset:16384
  s_waitcnt vmcnt(3)
  v_cmp_ne_u32 vcc, s70, v13
  s_cbranch_vccnz L_slow_45
L_back_46:
  s_add_u32 s80, s44, 4096
  buffer_load_dwordx4 v[116:119], v2, s[16:19], s80 offen offset:2048 sc1
  s_waitcnt vmcnt(5)
  v_mfma_f32_16x16x32_bf16 v[80:83], v[160:163], v[120:123], v[80:83]
  ds_read_b64_tr_b16 v[202:203], v10 offset:16384
  v_mfma_f32_16x16x32_bf16 v[84:87], v[164:167], v[120:123], v[84:87]
  ds_read_b64_tr_b16 v[206:207], v11 offset:16384
  v_mfma_f32_16x16x32_bf16 v[88:91], v[168:171], v[120:123], v[88:91]
  v_add_u32 v8, 49152, v7
  v_xor_b32 v9, 32, v8
  v_mfma_f32_16x16x32_bf16 v[92:95], v[172:175], v[120:123], v[92:95]
  v_xor_b32 v10, 64, v8
  v_xor_b32 v11, 0x60, v8
  buffer_load_dwordx4 v[120:123], v2, s[16:19], s80 offen offset:3072 sc1
  s_setprio 0
  s_waitcnt vmcnt(4)
  v_mfma_f32_16x16x32_bf16 v[96:99], v[224:227], v[124:127], v[96:99]
  s_waitcnt vmcnt(29)
  ds_read_b64_tr_b16 v[208:209], v8 offset:0
  v_mfma_f32_16x16x32_bf16 v[100:103], v[228:231], v[124:127], v[100:103]
  ds_read_b64_tr_b16 v[212:213], v9 offset:0
  v_mfma_f32_16x16x32_bf16 v[104:107], v[232:235], v[124:127], v[104:107]
  ds_read_b64_tr_b16 v[216:217], v10 offset:0
  v_mfma_f32_16x16x32_bf16 v[108:111], v[236:239], v[124:127], v[108:111]
  ds_read_b64_tr_b16 v[220:221], v11 offset:0
  s_add_u32 s80, s44, 8192
  buffer_load_dwordx4 v[124:127], v2, s[16:19], s80 offen offset:0 sc1
  s_waitcnt vmcnt(4)
  v_mfma_f32_16x16x32_bf16 v[96:99], v[240:243], v[128:131], v[96:99]
  v_mfma_f32_16x16x32_bf16 v[100:103], v[244:247], v[128:131], v[100:103]
  v_mfma_f32_16x16x32_bf16 v[104:107], v[248:251], v[128:131], v[104:107]
  v_mfma_f32_16x16x32_bf16 v[108:111], v[252:255], v[128:131], v[108:111]
  s_add_u32 s80, s45, 4096
  buffer_load_dwordx4 v[128:131], v2, s[16:19], s80 offen offset:2048 sc1
  s_waitcnt vmcnt(4)
  v_mfma_f32_16x16x32_bf16 v[96:99], v[160:163], v[112:115], v[96:99]
  v_mfma_f32_16x16x32_bf16 v[100:103], v[164:167], v[112:115], v[100:103]
  v_mfma_f32_16x16x32_bf16 v[104:107], v[168:171], v[112:115], v[104:107]
  v_mfma_f32_16x16x32_bf16 v[108:111], v[172:175], v[112:115], v[108:111]
  buffer_load_dwordx4 v[112:115], v2, s[16:19], s80 offen offset:3072 sc1
  s_waitcnt lgkmcnt(12)
  s_setprio 3
  s_waitcnt vmcnt(4)
  v_mfma_f32_16x16x32_bf16 v[16:19], v[176:179], v[116:119], v[16:19]
  v_xor_b32 v240, 32, v154
  v_xor_b32 v243, 8, v155
  v_mfma_f32_16x16x32_bf16 v[20:23], v[180:183], v[116:119], v[20:23]
  v_xor_b32 v241, 64, v154
  v_xor_b32 v244, 16, v155
  v_mfma_f32_16x16x32_bf16 v[24:27], v[184:187], v[116:119], v[24:27]
  v_xor_b32 v242, 96, v154
  v_xor_b32 v245, 24, v155
  v_mfma_f32_16x16x32_bf16 v[28:31], v[188:191], v[116:119], v[28:31]
  s_waitcnt vmcnt(49)
  v_lshlrev_b32 v224, 16, v152
  v_and_b32 v225, 0xffff0000, v152
  s_add_u32 s80, s45, 8192
  buffer_load_dwordx4 v[116:119], v2, s[16:19], s80 offen offset:0 sc1
  s_waitcnt lgkmcnt(4)
  s_waitcnt vmcnt(4)
  v_mfma_f32_16x16x32_bf16 v[16:19], v[192:195], v[120:123], v[16:19]
  v_lshlrev_b32 v226, 16, v153
  v_and_b32 v227, 0xffff0000, v153
  v_mfma_f32_16x16x32_bf16 v[20:23], v[196:199], v[120:123], v[20:23]
  s_waitcnt vmcnt(49)
  v_lshlrev_b32 v228, 16, v158
  v_and_b32 v229, 0xffff0000, v158
  v_mfma_f32_16x16x32_bf16 v[24:27], v[200:203], v[120:123], v[24:27]
  v_lshlrev_b32 v230, 16, v159
  v_and_b32 v231, 0xffff0000, v159
  v_mfma_f32_16x16x32_bf16 v[28:31], v[204:207], v[120:123], v[28:31]
  s_waitcnt vmcnt(48)
  v_lshlrev_b32 v232, 16, v14
  v_and_b32 v233, 0xffff0000, v14
  s_add_u32 s80, s46, 4096
  buffer_load_dwordx4 v[120:123], v2, s[16:19], s80 offen offset:2048 sc1
  s_waitcnt lgkmcnt(0)
  s_waitcnt vmcnt(4)
  v_mfma_f32_16x16x16_bf16 v[16:19], v[208:209], v[124:125], v[16:19]
  v_lshlrev_b32 v234, 16, v15
  v_and_b32 v235, 0xffff0000, v15
  v_mfma_f32_16x16x16_bf16 v[20:23], v[212:213], v[124:125], v[20:23]
  v_mfma_f32_16x16x16_bf16 v[24:27], v[216:217], v[124:125], v[24:27]
  v_mfma_f32_16x16x16_bf16 v[28:31], v[220:221], v[124:125], v[28:31]
  v_mfma_f32_16x16x16_bf16 v[64:67], v[208:209], v[126:127], v[64:67]
  v_mfma_f32_16x16x16_bf16 v[68:71], v[212:213], v[126:127], v[68:71]
  v_mfma_f32_16x16x16_bf16 v[72:75], v[216:217], v[126:127], v[72:75]
  v_mfma_f32_16x16x16_bf16 v[76:79], v[220:221], v[126:127], v[76:79]
  buffer_load_dwordx4 v[124:127], v2, s[16:19], s80 offen offset:3072 sc1
  s_setprio 3
  s_waitcnt vmcnt(4)
  v_mfma_f32_16x16x32_bf16 v[32:35], v[176:179], v[128:131], v[32:35]
  v_mfma_f32_16x16x32_bf16 v[36:39], v[180:183], v[128:131], v[36:39]
  v_mfma_f32_16x16x32_bf16 v[40:43], v[184:187], v[128:131], v[40:43]
  v_cvt_pk_bf16_f32 v16, v16, v17
  v_cvt_pk_bf16_f32 v17, v18, v19
  ds_write_b64 v154, v[16:17] offset:0
  v_mfma_f32_16x16x32_bf16 v[44:47], v[188:191], v[128:131], v[44:47]
  v_cvt_pk_bf16_f32 v20, v20, v21
  v_cvt_pk_bf16_f32 v21, v22, v23
  ds_write_b64 v240, v[20:21] offset:512
  s_add_u32 s80, s46, 8192
  buffer_load_dwordx4 v[128:131], v2, s[16:19], s80 offen offset:0 sc1
  s_waitcnt vmcnt(4)
  v_mfma_f32_16x16x32_bf16 v[32:35], v[192:195], v[112:115], v[32:35]
  v_cvt_pk_bf16_f32 v24, v24, v25
  v_cvt_pk_bf16_f32 v25, v26, v27
  ds_write_b64 v241, v[24:25] offset:1024
  v_mfma_f32_16x16x32_bf16 v[36:39], v[196:199], v[112:115], v[36:39]
  v_cvt_pk_bf16_f32 v28, v28, v29
  v_cvt_pk_bf16_f32 v29, v30, v31
  ds_write_b64 v242, v[28:29] offset:1536
  v_mfma_f32_16x16x32_bf16 v[40:43], v[200:203], v[112:115], v[40:43]
  v_mfma_f32_16x16x32_bf16 v[44:47], v[204:207], v[112:115], v[44:47]
  s_add_u32 s80, s47, 4096
  buffer_load_dwordx4 v[112:115], v2, s[16:19], s80 offen offset:2048 sc1
  s_waitcnt vmcnt(4)
  v_mfma_f32_16x16x16_bf16 v[32:35], v[208:209], v[116:117], v[32:35]
  v_mfma_f32_16x16x16_bf16 v[36:39], v[212:213], v[116:117], v[36:39]
  v_mfma_f32_16x16x16_bf16 v[40:43], v[216:217], v[116:117], v[40:43]
  v_mfma_f32_16x16x16_bf16 v[44:47], v[220:221], v[116:117], v[44:47]
  v_mfma_f32_16x16x16_bf16 v[80:83], v[208:209], v[118:119], v[80:83]
  v_mfma_f32_16x16x16_bf16 v[84:87], v[212:213], v[118:119], v[84:87]
  v_mfma_f32_16x16x16_bf16 v[88:91], v[216:217], v[118:119], v[88:91]
  v_mfma_f32_16x16x16_bf16 v[92:95], v[220:221], v[118:119], v[92:95]
  buffer_load_dwordx4 v[116:119], v2, s[16:19], s80 offen offset:3072 sc1
  s_setprio 2
  s_waitcnt vmcnt(4)
  v_mfma_f32_16x16x32_bf16 v[48:51], v[176:179], v[120:123], v[48:51]
  v_mfma_f32_16x16x32_bf16 v[52:55], v[180:183], v[120:123], v[52:55]
  v_mfma_f32_16x16x32_bf16 v[56:59], v[184:187], v[120:123], v[56:59]
  v_cvt_pk_bf16_f32 v32, v32, v33
  v_cvt_pk_bf16_f32 v33, v34, v35
  ds_write_b64 v154, v[32:33] offset:16384
  v_mfma_f32_16x16x32_bf16 v[60:63], v[188:191], v[120:123], v[60:63]
  v_cvt_pk_bf16_f32 v36, v36, v37
  v_cvt_pk_bf16_f32 v37, v38, v39
  ds_write_b64 v240, v[36:37] offset:16896
  s_add_u32 s80, s48, 4096
  buffer_load_dwordx4 v[120:123], v2, s[16:19], s80 offen offset:2048 sc1
  s_waitcnt vmcnt(4)
  v_mfma_f32_16x16x32_bf16 v[48:51], v[192:195], v[124:127], v[48:51]
  v_cvt_pk_bf16_f32 v40, v40, v41
  v_cvt_pk_bf16_f32 v41, v42, v43
  ds_write_b64 v241, v[40:41] offset:17408
  v_mfma_f32_16x16x32_bf16 v[52:55], v[196:199], v[124:127], v[52:55]
  v_cvt_pk_bf16_f32 v44, v44, v45
  v_cvt_pk_bf16_f32 v45, v46, v47
  ds_write_b64 v242, v[44:45] offset:17920
  v_mfma_f32_16x16x32_bf16 v[56:59], v[200:203], v[124:127], v[56:59]
  v_mfma_f32_16x16x32_bf16 v[60:63], v[204:207], v[124:127], v[60:63]
  buffer_load_dwordx4 v[124:127], v2, s[16:19], s80 offen offset:3072 sc1
  s_waitcnt vmcnt(4)
  v_mfma_f32_16x16x16_bf16 v[48:51], v[208:209], v[128:129], v[48:51]
  v_mfma_f32_16x16x16_bf16 v[52:55], v[212:213], v[128:129], v[52:55]
  s_nop 0
  v_mfma_f32_16x16x16_bf16 v[56:59], v[216:217], v[128:129], v[56:59]
  v_mfma_f32_16x16x16_bf16 v[60:63], v[220:221], v[128:129], v[60:63]
  v_mfma_f32_16x16x16_bf16 v[96:99], v[208:209], v[130:131], v[96:99]
  v_mfma_f32_16x16x16_bf16 v[100:103], v[212:213], v[130:131], v[100:103]
  v_mfma_f32_16x16x16_bf16 v[104:107], v[216:217], v[130:131], v[104:107]
  v_mfma_f32_16x16x16_bf16 v[108:111], v[220:221], v[130:131], v[108:111]
  s_add_u32 s80, s49, 4096
  buffer_load_dwordx4 v[128:131], v2, s[16:19], s80 offen offset:2048 sc1
  s_setprio 1
  s_waitcnt vmcnt(4)
  v_mfma_f32_16x16x32_bf16 v[64:67], v[176:179], v[112:115], v[64:67]
  v_mfma_f32_16x16x32_bf16 v[68:71], v[180:183], v[112:115], v[68:71]
  v_mfma_f32_16x16x32_bf16 v[72:75], v[184:187], v[112:115], v[72:75]
  v_cvt_pk_bf16_f32 v48, v48, v49
  v_cvt_pk_bf16_f32 v49, v50, v51
  ds_write_b64 v154, v[48:49] offset:32768
  v_mfma_f32_16x16x32_bf16 v[76:79], v[188:191], v[112:115], v[76:79]
  v_cvt_pk_bf16_f32 v52, v52, v53
  v_cvt_pk_bf16_f32 v53, v54, v55
  ds_write_b64 v240, v[52:53] offset:33280
  buffer_load_dwordx4 v[112:115], v2, s[16:19], s80 offen offset:3072 sc1
  s_waitcnt vmcnt(4)
  v_mfma_f32_16x16x32_bf16 v[64:67], v[192:195], v[116:119], v[64:67]
  v_cvt_pk_bf16_f32 v56, v56, v57
  v_cvt_pk_bf16_f32 v57, v58, v59
  ds_write_b64 v241, v[56:57] offset:33792
  v_mfma_f32_16x16x32_bf16 v[68:71], v[196:199], v[116:119], v[68:71]
  v_cvt_pk_bf16_f32 v60, v60, v61
  v_cvt_pk_bf16_f32 v61, v62, v63
  ds_write_b64 v242, v[60:61] offset:34304
  v_mfma_f32_16x16x32_bf16 v[72:75], v[200:203], v[116:119], v[72:75]
  v_mfma_f32_16x16x32_bf16 v[76:79], v[204:207], v[116:119], v[76:79]
  s_waitcnt vmcnt(3)
  v_mfma_f32_16x16x32_bf16 v[80:83], v[176:179], v[120:123], v[80:83]
  v_mfma_f32_16x16x32_bf16 v[84:87], v[180:183], v[120:123], v[84:87]
  v_mfma_f32_16x16x32_bf16 v[88:91], v[184:187], v[120:123], v[88:91]
  v_cvt_pk_bf16_f32 v64, v64, v65
  v_cvt_pk_bf16_f32 v65, v66, v67
  ds_write_b64 v154, v[64:65] offset:49152
  v_add_u32 v154, 0x10000, v154
  v_mfma_f32_16x16x32_bf16 v[92:95], v[188:191], v[120:123], v[92:95]
  v_cvt_pk_bf16_f32 v68, v68, v69
  v_cvt_pk_bf16_f32 v69, v70, v71
  ds_write_b64 v240, v[68:69] offset:49664
  v_add_u32 v240, 0x10000, v240
  s_setprio 0
  s_waitcnt vmcnt(2)
  v_mfma_f32_16x16x32_bf16 v[80:83], v[192:195], v[124:127], v[80:83]
  v_cvt_pk_bf16_f32 v72, v72, v73
  v_cvt_pk_bf16_f32 v73, v74, v75
  ds_write_b64 v241, v[72:73] offset:50176
  v_add_u32 v241, 0x10000, v241
  v_mfma_f32_16x16x32_bf16 v[84:87], v[196:199], v[124:127], v[84:87]
  v_cvt_pk_bf16_f32 v76, v76, v77
  v_cvt_pk_bf16_f32 v77, v78, v79
  ds_write_b64 v242, v[76:77] offset:50688
  v_add_u32 v242, 0x10000, v242
  v_mfma_f32_16x16x32_bf16 v[88:91], v[200:203], v[124:127], v[88:91]
  v_mfma_f32_16x16x32_bf16 v[92:95], v[204:207], v[124:127], v[92:95]
  s_waitcnt vmcnt(1)
  v_mfma_f32_16x16x32_bf16 v[96:99], v[176:179], v[128:131], v[96:99]
  v_mfma_f32_16x16x32_bf16 v[100:103], v[180:183], v[128:131], v[100:103]
  v_mfma_f32_16x16x32_bf16 v[104:107], v[184:187], v[128:131], v[104:107]
  v_cvt_pk_bf16_f32 v80, v80, v81
  v_cvt_pk_bf16_f32 v81, v82, v83
  ds_write_b64 v154, v[80:81] offset:0
  v_mfma_f32_16x16x32_bf16 v[108:111], v[188:191], v[128:131], v[108:111]
  v_cvt_pk_bf16_f32 v84, v84, v85
  v_cvt_pk_bf16_f32 v85, v86, v87
  ds_write_b64 v240, v[84:85] offset:512
  s_waitcnt vmcnt(0)
  v_mfma_f32_16x16x32_bf16 v[96:99], v[192:195], v[112:115], v[96:99]
  v_cvt_pk_bf16_f32 v88, v88, v89
  v_cvt_pk_bf16_f32 v89, v90, v91
  ds_write_b64 v241, v[88:89] offset:1024
  v_mfma_f32_16x16x32_bf16 v[100:103], v[196:199], v[112:115], v[100:103]
  v_cvt_pk_bf16_f32 v92, v92, v93
  v_cvt_pk_bf16_f32 v93, v94, v95
  ds_write_b64 v242, v[92:93] offset:1536
  v_mfma_f32_16x16x32_bf16 v[104:107], v[200:203], v[112:115], v[104:107]
  v_mfma_f32_16x16x32_bf16 v[108:111], v[204:207], v[112:115], v[108:111]
  v_cvt_pk_bf16_f32 v96, v96, v97
  v_cvt_pk_bf16_f32 v97, v98, v99
  ds_write_b64 v154, v[96:97] offset:16384
  v_cvt_pk_bf16_f32 v100, v100, v101
  v_cvt_pk_bf16_f32 v101, v102, v103
  ds_write_b64 v240, v[100:101] offset:16896
  s_nop 0
  v_cvt_pk_bf16_f32 v104, v104, v105
  v_cvt_pk_bf16_f32 v105, v106, v107
  ds_write_b64 v241, v[104:105] offset:17408
  v_cvt_pk_bf16_f32 v108, v108, v109
  v_cvt_pk_bf16_f32 v109, v110, v111
  ds_write_b64 v242, v[108:109] offset:17920
  s_waitcnt lgkmcnt(0)
  s_barrier
  ds_read_b64 v[16:17], v155 offset:0
  ds_read_b64 v[18:19], v155 offset:2048
  ds_read_b64 v[20:21], v243 offset:0
  ds_read_b64 v[22:23], v243 offset:2048
  ds_read_b64 v[24:25], v244 offset:0
  ds_read_b64 v[26:27], v244 offset:2048
  ds_read_b64 v[28:29], v245 offset:0
  ds_read_b64 v[30:31], v245 offset:2048
  s_waitcnt lgkmcnt(6)
  v_mfma_f32_16x16x32_bf16 v[224:227], v[136:139], v[16:19], v[224:227]
  ds_read_b64 v[48:49], v155 offset:32768
  ds_read_b64 v[50:51], v155 offset:34816
  v_add_u32 v155, 0x10000, v155
  s_waitcnt lgkmcnt(6)
  v_mfma_f32_16x16x32_bf16 v[224:227], v[140:143], v[20:23], v[224:227]
  ds_read_b64 v[52:53], v243 offset:32768
  ds_read_b64 v[54:55], v243 offset:34816
  v_add_u32 v243, 0x10000, v243
  s_waitcnt lgkmcnt(6)
  v_mfma_f32_16x16x32_bf16 v[224:227], v[144:147], v[24:27], v[224:227]
  ds_read_b64 v[56:57], v244 offset:32768
  ds_read_b64 v[58:59], v244 offset:34816
  v_add_u32 v244, 0x10000, v244
  s_waitcnt lgkmcnt(6)
  v_mfma_f32_16x16x32_bf16 v[224:227], v[148:151], v[28:31], v[224:227]
  ds_read_b64 v[60:61], v245 offset:32768
  ds_read_b64 v[62:63], v245 offset:34816
  v_add_u32 v245, 0x10000, v245
  s_waitcnt lgkmcnt(6)
  v_mfma_f32_16x16x32_bf16 v[228:231], v[136:139], v[48:51], v[228:231]
  ds_read_b64 v[80:81], v155 offset:0
  ds_read_b64 v[82:83], v155 offset:2048
  s_waitcnt lgkmcnt(6)
  v_mfma_f32_16x16x32_bf16 v[228:231], v[140:143], v[52:55], v[228:231]
  ds_read_b64 v[84:85], v243 offset:0
  ds_read_b64 v[86:87], v243 offset:2048
  s_waitcnt lgkmcnt(6)
  v_mfma_f32_16x16x32_bf16 v[228:231], v[144:147], v[56:59], v[228:231]
  ds_read_b64 v[88:89], v244 offset:0
  ds_read_b64 v[90:91], v244 offset:2048
  v_cvt_pk_bf16_f32 v224, v224, v225
  v_cvt_pk_bf16_f32 v225, v226, v227
  buffer_store_dwordx2 v[224:225], v156, s[24:27], s28 offen sc1
  s_waitcnt lgkmcnt(6)
  v_mfma_f32_16x16x32_bf16 v[228:231], v[148:151], v[60:63], v[228:231]
  ds_read_b64 v[92:93], v245 offset:0
  ds_read_b64 v[94:95], v245 offset:2048
  s_waitcnt lgkmcnt(6)
  v_mfma_f32_16x16x32_bf16 v[232:235], v[136:139], v[80:83], v[232:235]
  s_waitcnt lgkmcnt(4)
  v_mfma_f32_16x16x32_bf16 v[232:235], v[140:143], v[84:87], v[232:235]
  s_waitcnt lgkmcnt(2)
  v_mfma_f32_16x16x32_bf16 v[232:235], v[144:147], v[88:91], v[232:235]
  v_cvt_pk_bf16_f32 v228, v228, v229
  v_cvt_pk_bf16_f32 v229, v230, v231
  buffer_store_dwordx2 v[228:229], v156, s[24:27], s29 offen sc1
  s_waitcnt lgkmcnt(0)
  v_mfma_f32_16x16x32_bf16 v[232:235], v[148:151], v[92:95], v[232:235]
  s_nop 7
  v_cvt_pk_bf16_f32 v232, v232, v233
  v_cvt_pk_bf16_f32 v233, v234, v235
  buffer_store_dwordx2 v[232:233], v156, s[24:27], s30 offen sc1
  s_endpgm
L_slow_31:
  s_mov_b32 s86, 0
L_lp_33:
  s_add_u32 s86, s86, 1
  s_cmp_gt_u32 s86, 262144
  s_cbranch_scc1 L_back_32
  s_sleep 1
  buffer_load_dword v208, off, s[20:23], 0 sc1
  s_waitcnt vmcnt(0)
  v_cmp_eq_u32 vcc, 0, v208
  s_cbranch_vccnz L_lp_33
  s_branch L_back_32
L_slow_34:
  s_mov_b32 s86, 0
L_lp_36:
  s_add_u32 s86, s86, 1
  s_cmp_gt_u32 s86, 262144
  s_cbranch_scc1 L_back_35
  s_sleep 1
  buffer_load_dwordx4 v[226:229], v222, s[16:19], 0 offen sc1
  s_waitcnt vmcnt(0)
  v_cmp_ne_u32 vcc, s70, v227
  v_cmp_ne_u32 s[88:89], s70, v229
  s_nop 1
  s_or_b64 vcc, vcc, s[88:89]
  s_cbranch_vccnz L_lp_36
  s_branch L_back_35
L_slow_39:
  s_mov_b32 s86, 0
L_lp_41:
  s_add_u32 s86, s86, 1
  s_cmp_gt_u32 s86, 262144
  s_cbranch_scc1 L_back_40
  s_sleep 1
  buffer_load_dword v13, v12, s[16:19], s87 offen sc1
  s_waitcnt vmcnt(0)
  v_cmp_ne_u32 vcc, s70, v13
  s_cbranch_vccnz L_lp_41
  s_branch L_back_40
L_slow_42:
  s_mov_b32 s86, 0
L_lp_44:
  s_add_u32 s86, s86, 1
  s_cmp_gt_u32 s86, 262144
  s_cbranch_scc1 L_back_43
  s_sleep 1
  buffer_load_dword v13, v12, s[16:19], s87 offen sc1
  s_waitcnt vmcnt(0)
  v_cmp_ne_u32 vcc, s70, v13
  s_cbranch_vccnz L_lp_44
  s_branch L_back_43
L_slow_45:
  s_mov_b32 s86, 0
L_lp_47:
  s_add_u32 s86, s86, 1
  s_cmp_gt_u32 s86, 262144
  s_cbranch_scc1 L_back_46
  s_sleep 1
  buffer_load_dword v13, v12, s[16:19], s87 offen sc1
  s_waitcnt vmcnt(0)
  v_cmp_ne_u32 vcc, s70, v13
  s_cbranch_vccnz L_lp_47
  s_branch L_back_46
L_exit:
  s_endpgm
.section .rodata,"a"
.p2align 6
.amdhsa_kernel parallel_sum__sliding_local_dilated__dense_activation_silu__prompt_kernel
  .amdhsa_next_free_vgpr 256
  .amdhsa_next_free_sgpr 102
  .amdhsa_accum_offset 256
  .amdhsa_group_segment_fixed_size 0
  .amdhsa_kernarg_size 72
  .amdhsa_user_sgpr_count 2
  .amdhsa_user_sgpr_kernarg_segment_ptr 1
  .amdhsa_system_sgpr_workgroup_id_x 1
.end_amdhsa_kernel
```
